```python
import torch

def _softmax(x, axis=-1):
    return torch.softmax(x, dim=axis)
def _gelu(x):
    return torch.nn.functional.gelu(x, approximate="tanh")
def _silu(x):
    return torch.nn.functional.silu(x)
def _sigmoid(x):
    return torch.sigmoid(x)
def _layernorm(x, axis=-1, eps=1e-5):
    m = x.mean(dim=axis, keepdim=True)
    v = x.var(dim=axis, keepdim=True, unbiased=False)
    return (x - m) / torch.sqrt(v + eps)
def _scatter_add(tgt, idx, src, axis=0):
    return tgt.clone().index_add_(axis, idx, src)
def _segment_sum(src, seg, n):
    out = torch.zeros((n,) + src.shape[1:], dtype=src.dtype)
    return out.index_add_(0, seg, src)
def _pad(x, pw):
    flat = tuple(v for pair in reversed(pw) for v in pair)
    return torch.nn.functional.pad(x, flat)

kernel_name = 'gather_scatter__hybrid_graph_tf_graphgps__graph'

def setup_inputs():

    _w = (lambda a: (lambda t: t.to(torch.bfloat16) if t.is_floating_point() else t)(torch.as_tensor(a)))
    N, deg, D = 10000, 16, 128
    E = N * deg
    src = (lambda lo, hi, *s: torch.randint(lo, hi, s))(0, N, E).to(torch.int64)
    dst = (lambda lo, hi, *s: torch.randint(lo, hi, s))(0, N, E).to(torch.int64)
    deg_cnt = torch.bincount(dst, minlength=N).to(float) + 1.0
    sc = 1.0 / float(D) ** 0.5
    return {
        "x": _w((lambda *s: torch.randn(*s, dtype=torch.bfloat16) * 0.05)(N, D)),
        "src": _w(src),
        "dst": _w(dst),
        "deg_inv": _w((1.0 / deg_cnt).to(float)),
        "w_msg": _w((lambda *s: torch.randn(*s, dtype=torch.bfloat16) * 0.2)(D, D) * sc),
        "wq": _w((lambda *s: torch.randn(*s, dtype=torch.bfloat16) * 1.6)(D, D) * sc),
        "wk": _w((lambda *s: torch.randn(*s, dtype=torch.bfloat16) * 1.6)(D, D) * sc),
        "wv": _w((lambda *s: torch.randn(*s, dtype=torch.bfloat16) * 0.2)(D, D) * sc),
        "w_out": _w((lambda *s: torch.randn(*s, dtype=torch.bfloat16) * 0.2)(D, D) * sc),
    }

def reference(x, src, dst, deg_inv, w_msg, wq, wk, wv, w_out):
    N, D = x.shape[0], x.shape[1]
    h = _layernorm(x, axis=-1)
    m_e = torch.einsum('nd,de->ne', h, w_msg)
    h_local = _segment_sum(m_e[src], dst, N) * deg_inv[:, None]
    q = torch.einsum('nd,de->ne', h, wq)
    k = torch.einsum('nd,de->ne', h, wk)
    v = torch.einsum('nd,de->ne', h, wv)
    logits = torch.einsum('id,jd->ij', q, k) / (float(D) ** 0.5)
    attn = _softmax(logits, axis=-1)
    h_global = torch.einsum('ij,jd->id', attn, v)
    y = torch.einsum('nd,de->ne', h_local + h_global, w_out)
    return x + y
```

```asm
; @launch grid=(256,1,1) block=(256,1,1) lds=163840
.amdgcn_target "amdgcn-amd-amdhsa--gfx950"
.text
.globl gather_scatter__hybrid_graph_tf_graphgps__graph_kernel
.p2align 8
.type gather_scatter__hybrid_graph_tf_graphgps__graph_kernel,@function
gather_scatter__hybrid_graph_tf_graphgps__graph_kernel:
    s_cmp_ge_u32 s2, 256
    s_cbranch_scc1 L2_end
    s_load_dwordx2 s[4:5], s[0:1], 88
    s_cmp_ge_u32 s2, 250
    s_cbranch_scc1 LH
    s_load_dwordx2 s[16:17], s[0:1], 0
    s_load_dwordx4 s[60:63], s[0:1], 40
    s_load_dwordx2 s[20:21], s[0:1], 72
    s_load_dwordx2 s[24:25], s[0:1], 24
    s_getpc_b64 s[42:43]
L2_pc:
    s_lshr_b32 s35, s2, 3
    v_and_b32 v2, 7, v0
    v_lshl_add_u32 v2, s35, 3, v2
    v_lshlrev_b32 v2, 7, v2
    v_mov_b32 v3, L2_slow-L2_pc
    v_cmp_gt_u32 vcc, v3, v2
    v_add_u32 v3, L2_epi-L2_slow, v2
    s_nop 0
    v_cndmask_b32 v2, v3, v2, vcc
    v_min_u32 v2, LH-L2_pc, v2
    v_mov_b32 v3, s43
    v_add_co_u32 v2, vcc, s42, v2
    s_nop 1
    v_addc_co_u32 v3, vcc, 0, v3, vcc
    global_load_dword v160, v[2:3], off
    v_lshrrev_b32 v1, 6, v0
    v_and_b32 v0, 63, v0
    s_lshr_b32 s28, s2, 4
    v_readfirstlane_b32 s3, v1
    s_lshl_b32 s28, s28, 3
    s_and_b32 s35, s2, 7
    s_add_u32 s28, s28, s35
    s_bfe_u32 s29, s2, 0x10003
    s_xor_b32 s56, s2, 8
    s_sub_u32 s35, s2, 242
    s_cmp_lt_u32 s35, 6
    s_cbranch_scc0 L2_ids
    s_and_b32 s29, s2, 1
    s_xor_b32 s56, s2, 1
    s_lshr_b32 s35, s35, 1
    s_add_u32 s28, s35, 122
L2_ids:
    v_and_b32 v24, 15, v0
    v_lshrrev_b32 v25, 4, v0
    v_lshlrev_b32 v20, 4, v0
    v_add_u32 v21, 4096, v20
    s_lshl_b32 s30, s3, 15
    s_mul_i32 s36, s28, 20480
    s_mul_i32 s35, s29, 10
    s_add_u32 s35, s35, s3
    s_add_u32 s84, s35, 0
    s_sub_u32 s41, s84, 20
    s_cselect_b32 s84, s84, s41
    s_lshl_b32 s84, s84, 10
    s_add_u32 s85, s35, 4
    s_sub_u32 s41, s85, 20
    s_cselect_b32 s85, s85, s41
    s_lshl_b32 s85, s85, 10
    s_add_u32 s86, s35, 8
    s_sub_u32 s41, s86, 20
    s_cselect_b32 s86, s86, s41
    s_lshl_b32 s86, s86, 10
    s_add_u32 s87, s35, 12
    s_sub_u32 s41, s87, 20
    s_cselect_b32 s87, s87, s41
    s_lshl_b32 s87, s87, 10
    s_add_u32 s88, s35, 16
    s_sub_u32 s41, s88, 20
    s_cselect_b32 s88, s88, s41
    s_lshl_b32 s88, s88, 10
    v_lshrrev_b32 v2, 1, v24
    v_xor_b32 v2, v2, v25
    v_lshlrev_b32 v2, 5, v2
    v_and_b32 v3, 1, v24
    v_lshl_or_b32 v2, v3, 4, v2
    v_lshl_or_b32 v218, v25, 8, v2
    v_xor_b32 v219, 0x80, v218
    s_and_b32 s41, s3, 1
    s_lshl_b32 s41, s41, 7
    v_xor_b32 v4, s41, v218
    v_lshlrev_b32 v220, 6, v25
    v_xor_b32 v220, v220, v20
    s_lshl_b32 s50, s3, 13
    s_add_u32 s51, s50, 4096
    s_waitcnt lgkmcnt(0)
    s_mov_b32 s18, 2560000
    s_mov_b32 s19, 0x00020000
    s_add_u32 s41, s36, s84
    buffer_load_dwordx4 v[32:35], v20, s[16:19], s41 offen
    s_add_u32 s41, s36, s85
    buffer_load_dwordx4 v[36:39], v20, s[16:19], s41 offen
    s_add_u32 s41, s36, s86
    buffer_load_dwordx4 v[40:43], v20, s[16:19], s41 offen
    s_add_u32 s41, s36, s87
    buffer_load_dwordx4 v[44:47], v20, s[16:19], s41 offen
    s_add_u32 s41, s36, s88
    buffer_load_dwordx4 v[48:51], v20, s[16:19], s41 offen
    s_add_u32 s48, s4, 2752512
    s_addc_u32 s49, s5, 0
    s_load_dword s59, s[48:49], 0
    s_mov_b32 s12, s4
    s_mov_b32 s13, s5
    s_mov_b32 s14, 6094848
    s_mov_b32 s15, 0x00020000
    s_mov_b32 s8, s4
    s_mov_b32 s9, s5
    s_mov_b32 s10, 2560000
    s_mov_b32 s11, 0x00020000
    s_mov_b32 s22, 2560000
    s_mov_b32 s23, 0x00020000
    s_mov_b32 s26, 20000
    s_mov_b32 s27, 0x00020000
    s_lshl_b32 s35, s29, 2
    s_add_u32 s38, s35, s3
    s_mul_i32 s31, s38, 319488
    s_lshl_b32 s40, s3, 13
    s_add_u32 s40, s40, 2621440
    s_lshl_b32 s39, s28, 3
    s_add_u32 s39, s39, s35
    s_xor_b32 s35, s29, 1
    s_mul_i32 s37, s35, 15
    v_xor_b32 v3, s37, v24
    s_mul_i32 s37, s35, 3
    s_xor_b32 s48, s37, s3
    s_add_u32 s39, s39, s48
    s_mul_i32 s49, s35, 16384
    s_add_u32 s42, s36, s49
    s_add_u32 s49, s49, 131072
    s_lshl_b32 s37, s35, 13
    s_sub_u32 s37, 4096, s37
    s_mul_i32 s34, s35, 4
    s_mul_i32 s34, s34, s3
    s_add_u32 s34, s34, s3
    s_mul_i32 s45, s3, 8192
    s_add_u32 s45, s45, 131072
    v_lshrrev_b32 v5, 1, v25
    v_and_b32 v6, 1, v25
    v_lshrrev_b32 v2, 2, v24
    v_and_b32 v7, 3, v24
    v_lshlrev_b32 v5, 5, v5
    v_lshl_add_u32 v200, v2, 3, v7
    v_lshl_or_b32 v31, v6, 4, v5
    s_add_u32 s41, s30, 8192
    v_and_b32 v233, 7, v3
    v_and_b32 v9, 7, v24
    v_and_b32 v205, 7, v200
    v_lshl_add_u32 v232, v3, 8, s49
    v_lshl_add_u32 v8, v24, 8, s30
    v_lshl_add_u32 v204, v200, 8, s41
    v_lshl_or_b32 v232, v233, 5, v232
    v_lshl_or_b32 v8, v9, 5, v8
    v_lshl_or_b32 v204, v205, 5, v204
    v_xor_b32 v232, v232, v31
    v_xor_b32 v8, v8, v31
    v_xor_b32 v204, v204, v31
    v_xor_b32 v233, 64, v232
    v_xor_b32 v9, 64, v8
    v_xor_b32 v205, 64, v204
    v_xor_b32 v234, 128, v232
    v_xor_b32 v10, 128, v8
    v_xor_b32 v206, 128, v204
    v_xor_b32 v235, 192, v232
    v_xor_b32 v11, 192, v8
    v_xor_b32 v207, 192, v204
    v_xor_b32 v208, 0x480, v204
    v_xor_b32 v209, 0x480, v205
    v_xor_b32 v210, 0x480, v206
    v_xor_b32 v211, 0x480, v207
    v_lshlrev_b32 v5, 4, v7
    v_lshl_add_u32 v5, v25, 11, v5
    v_mul_u32_u24 v6, 0x140, v2
    s_lshl_b32 s41, s3, 6
    v_add_u32 v5, v5, v6
    v_xor_b32 v212, s41, v5
    v_add_u32 v213, 1024, v212
    v_add_u32 v214, 65536, v212
    v_add_u32 v215, 66560, v212
    v_lshl_add_u32 v2, v25, 2, v2
    v_lshl_add_u32 v5, v7, 3, s30
    v_and_b32 v6, 7, v2
    v_lshl_add_u32 v5, v2, 8, v5
    v_lshl_or_b32 v5, v6, 5, v5
    v_xor_b32 v12, s41, v5
    v_xor_b32 v13, 32, v12
    v_xor_b32 v14, 64, v12
    v_xor_b32 v15, 96, v12
    v_xor_b32 v16, 128, v12
    v_xor_b32 v17, 160, v12
    v_xor_b32 v18, 192, v12
    v_xor_b32 v19, 224, v12
    v_lshlrev_b32 v3, 8, v3
    v_lshl_add_u32 v3, v25, 4, v3
    s_lshl_b32 s44, s3, 6
    s_add_u32 s44, s44, s42
    s_mul_i32 s43, s37, 3
    s_add_u32 s44, s44, s43
    v_add_u32 v29, s44, v3
    v_mov_b32 v3, 0x7fffff00
    v_cmp_lt_u32 vcc, 7, v24
    v_add_u32 v30, s37, v29
    v_subrev_u32 v28, s37, v29
    v_cndmask_b32 v28, v3, v28, vcc
    v_sub_u32 v2, 9, v24
    s_cmp_eq_u32 s29, 1
    s_cselect_b64 vcc, -1, 0
    s_mul_i32 s44, s39, 10
    v_cndmask_b32 v5, v2, v24, vcc
    v_cmp_gt_u32 vcc, 10, v24
    v_add_lshl_u32 v2, v5, s44, 1
    v_sub_u32 v5, 15, v5
    v_lshlrev_b32 v5, v5, 1
    v_cndmask_b32 v26, v3, v2, vcc
    v_cndmask_b32 v27, 0, v5, vcc
    v_lshlrev_b32 v23, 2, v0
    s_lshl_b32 s39, s39, 5
    s_add_u32 s39, s39, 2785280
    v_add_u32 v1, s30, v20
    v_add_u32 v6, 65536, v20
    s_lshl_b32 s44, s3, 2
    v_add_u32 v5, 151552, v20
    v_add_u32 v2, s44, v5
    s_mul_i32 s41, s38, 156
    s_mul_i32 s41, s41, 52429
    s_lshr_b32 s41, s41, 18
    v_add_u32 v216, s41, v0
    v_min_u32 v216, 249, v216
    v_cmp_gt_u32 vcc, 33, v0
    v_mov_b32 v7, 249
    s_nop 0
    v_cndmask_b32 v216, v7, v216, vcc
    v_lshlrev_b32 v216, 7, v216
    s_xor_b32 s44, s38, 4
    s_mul_i32 s41, s44, 156
    s_mul_i32 s41, s41, 52429
    s_lshr_b32 s41, s41, 18
    v_add_u32 v22, s41, v0
    v_min_u32 v22, 249, v22
    v_cmp_gt_u32 vcc, 33, v0
    v_and_b32 v7, 7, v0
    v_min_u32 v7, 5, v7
    v_add_u32 v7, 250, v7
    v_cndmask_b32 v22, v7, v22, vcc
    v_lshlrev_b32 v22, 7, v22
    s_lshl_b32 s57, s28, 1
    s_add_u32 s57, s57, s29
    s_lshl_b32 s57, s57, 7
    s_lshl_b32 s44, s3, 2
    s_add_u32 s57, s57, s44
    s_add_u32 s57, s57, 2686976
    s_mov_b32 s58, 2686976
    s_sub_u32 s35, s45, s30
    v_add_u32 v244, s35, v8
    v_add_u32 v245, s35, v9
    v_add_u32 v246, s35, v10
    v_add_u32 v247, s35, v11
    v_add_u32 v248, s35, v12
    v_add_u32 v249, s35, v13
    v_add_u32 v250, s35, v14
    v_add_u32 v251, s35, v15
    v_add_u32 v252, s35, v16
    v_add_u32 v253, s35, v17
    v_add_u32 v254, s35, v18
    v_add_u32 v255, s35, v19
    v_cmp_eq_u32 vcc, 0, v24
    s_mov_b32 s41, 0x3c000000
    v_mov_b32 v217, 0x3727c5ac
    v_mov_b32 v221, 0x3f80
    v_mov_b32 v31, 0xffff
    v_cndmask_b32 v31, 0, v31, vcc
    s_mov_b32 s43, 0xffff0000
    s_cmp_lt_u32 s3, 2
    s_cselect_b32 s44, s86, 0x7ff00000
    s_mov_b32 s52, s60
    s_mov_b32 s53, s61
    s_mov_b32 s54, 32768
    s_mov_b32 s55, 0x00020000
    s_add_u32 m0, s30, 0
    s_nop 0
    buffer_load_dwordx4 v220, s[52:55], s50 offen offset:0 lds
    buffer_load_dwordx4 v220, s[52:55], s50 offen offset:1024 lds
    buffer_load_dwordx4 v220, s[52:55], s50 offen offset:2048 lds
    buffer_load_dwordx4 v220, s[52:55], s50 offen offset:3072 lds
    s_add_u32 m0, s30, 4096
    s_nop 0
    buffer_load_dwordx4 v220, s[52:55], s51 offen offset:0 lds
    buffer_load_dwordx4 v220, s[52:55], s51 offen offset:1024 lds
    buffer_load_dwordx4 v220, s[52:55], s51 offen offset:2048 lds
    buffer_load_dwordx4 v220, s[52:55], s51 offen offset:3072 lds
    s_mov_b32 s52, s62
    s_mov_b32 s53, s63
    s_mov_b32 s54, 32768
    s_mov_b32 s55, 0x00020000
    s_add_u32 m0, s30, 8192
    s_nop 0
    buffer_load_dwordx4 v218, s[52:55], s50 offen offset:0 lds
    buffer_load_dwordx4 v219, s[52:55], s50 offen offset:1024 lds
    buffer_load_dwordx4 v218, s[52:55], s50 offen offset:2048 lds
    buffer_load_dwordx4 v219, s[52:55], s50 offen offset:3072 lds
    s_add_u32 m0, s30, 12288
    s_nop 0
    buffer_load_dwordx4 v218, s[52:55], s51 offen offset:0 lds
    buffer_load_dwordx4 v219, s[52:55], s51 offen offset:1024 lds
    buffer_load_dwordx4 v218, s[52:55], s51 offen offset:2048 lds
    buffer_load_dwordx4 v219, s[52:55], s51 offen offset:3072 lds
    s_waitcnt vmcnt(20)
    v_lshlrev_b32 v64, 16, v32
    v_and_b32 v65, s43, v32
    v_lshlrev_b32 v66, 16, v33
    v_and_b32 v67, s43, v33
    v_lshlrev_b32 v68, 16, v34
    v_and_b32 v69, s43, v34
    v_lshlrev_b32 v70, 16, v35
    v_and_b32 v71, s43, v35
    s_waitcnt vmcnt(19)
    v_lshlrev_b32 v72, 16, v36
    v_and_b32 v73, s43, v36
    v_lshlrev_b32 v74, 16, v37
    v_and_b32 v75, s43, v37
    v_lshlrev_b32 v76, 16, v38
    v_and_b32 v77, s43, v38
    v_lshlrev_b32 v78, 16, v39
    v_and_b32 v79, s43, v39
    s_waitcnt vmcnt(18)
    v_lshlrev_b32 v80, 16, v40
    v_and_b32 v81, s43, v40
    v_lshlrev_b32 v82, 16, v41
    v_and_b32 v83, s43, v41
    v_lshlrev_b32 v84, 16, v42
    v_and_b32 v85, s43, v42
    v_lshlrev_b32 v86, 16, v43
    v_and_b32 v87, s43, v43
    v_pk_add_f32 v[136:137], v[64:65], v[66:67]
    v_pk_add_f32 v[138:139], v[72:73], v[74:75]
    v_pk_add_f32 v[140:141], v[80:81], v[82:83]
    v_pk_add_f32 v[146:147], v[68:69], v[70:71]
    v_pk_add_f32 v[148:149], v[76:77], v[78:79]
    v_pk_add_f32 v[150:151], v[84:85], v[86:87]
    v_pk_add_f32 v[136:137], v[136:137], v[146:147]
    v_pk_add_f32 v[138:139], v[138:139], v[148:149]
    v_pk_add_f32 v[140:141], v[140:141], v[150:151]
    v_add_f32 v136, v136, v137
    v_add_f32 v138, v138, v139
    v_add_f32 v140, v140, v141
    v_add_f32_dpp v136, v136, v136 row_ror:8 row_mask:0xf bank_mask:0xf
    v_add_f32_dpp v138, v138, v138 row_ror:8 row_mask:0xf bank_mask:0xf
    v_add_f32_dpp v140, v140, v140 row_ror:8 row_mask:0xf bank_mask:0xf
    v_add_f32_dpp v136, v136, v136 row_ror:4 row_mask:0xf bank_mask:0xf
    v_add_f32_dpp v138, v138, v138 row_ror:4 row_mask:0xf bank_mask:0xf
    v_add_f32_dpp v140, v140, v140 row_ror:4 row_mask:0xf bank_mask:0xf
    v_add_f32_dpp v136, v136, v136 row_ror:2 row_mask:0xf bank_mask:0xf
    v_add_f32_dpp v138, v138, v138 row_ror:2 row_mask:0xf bank_mask:0xf
    v_add_f32_dpp v140, v140, v140 row_ror:2 row_mask:0xf bank_mask:0xf
    v_add_f32_dpp v136, v136, v136 row_ror:1 row_mask:0xf bank_mask:0xf
    v_add_f32_dpp v138, v138, v138 row_ror:1 row_mask:0xf bank_mask:0xf
    v_add_f32_dpp v140, v140, v140 row_ror:1 row_mask:0xf bank_mask:0xf
    v_mul_f32 v136, s41, v136
    v_mul_f32 v138, s41, v138
    v_mul_f32 v140, s41, v140
    v_pk_add_f32 v[64:65], v[64:65], v[136:137] op_sel_hi:[1,0] neg_lo:[0,1] neg_hi:[0,1]
    v_pk_add_f32 v[72:73], v[72:73], v[138:139] op_sel_hi:[1,0] neg_lo:[0,1] neg_hi:[0,1]
    v_pk_add_f32 v[80:81], v[80:81], v[140:141] op_sel_hi:[1,0] neg_lo:[0,1] neg_hi:[0,1]
    v_pk_add_f32 v[66:67], v[66:67], v[136:137] op_sel_hi:[1,0] neg_lo:[0,1] neg_hi:[0,1]
    v_pk_add_f32 v[74:75], v[74:75], v[138:139] op_sel_hi:[1,0] neg_lo:[0,1] neg_hi:[0,1]
    v_pk_add_f32 v[82:83], v[82:83], v[140:141] op_sel_hi:[1,0] neg_lo:[0,1] neg_hi:[0,1]
    v_pk_add_f32 v[68:69], v[68:69], v[136:137] op_sel_hi:[1,0] neg_lo:[0,1] neg_hi:[0,1]
    v_pk_add_f32 v[76:77], v[76:77], v[138:139] op_sel_hi:[1,0] neg_lo:[0,1] neg_hi:[0,1]
    v_pk_add_f32 v[84:85], v[84:85], v[140:141] op_sel_hi:[1,0] neg_lo:[0,1] neg_hi:[0,1]
    v_pk_add_f32 v[70:71], v[70:71], v[136:137] op_sel_hi:[1,0] neg_lo:[0,1] neg_hi:[0,1]
    v_pk_add_f32 v[78:79], v[78:79], v[138:139] op_sel_hi:[1,0] neg_lo:[0,1] neg_hi:[0,1]
    v_pk_add_f32 v[86:87], v[86:87], v[140:141] op_sel_hi:[1,0] neg_lo:[0,1] neg_hi:[0,1]
    v_pk_mul_f32 v[146:147], v[64:65], v[64:65]
    v_pk_mul_f32 v[148:149], v[72:73], v[72:73]
    v_pk_mul_f32 v[150:151], v[80:81], v[80:81]
    v_pk_fma_f32 v[146:147], v[66:67], v[66:67], v[146:147]
    v_pk_fma_f32 v[148:149], v[74:75], v[74:75], v[148:149]
    v_pk_fma_f32 v[150:151], v[82:83], v[82:83], v[150:151]
    v_pk_fma_f32 v[146:147], v[68:69], v[68:69], v[146:147]
    v_pk_fma_f32 v[148:149], v[76:77], v[76:77], v[148:149]
    v_pk_fma_f32 v[150:151], v[84:85], v[84:85], v[150:151]
    v_pk_fma_f32 v[146:147], v[70:71], v[70:71], v[146:147]
    v_pk_fma_f32 v[148:149], v[78:79], v[78:79], v[148:149]
    v_pk_fma_f32 v[150:151], v[86:87], v[86:87], v[150:151]
    v_add_f32 v146, v146, v147
    v_add_f32 v148, v148, v149
    v_add_f32 v150, v150, v151
    v_add_f32_dpp v146, v146, v146 row_ror:8 row_mask:0xf bank_mask:0xf
    v_add_f32_dpp v148, v148, v148 row_ror:8 row_mask:0xf bank_mask:0xf
    v_add_f32_dpp v150, v150, v150 row_ror:8 row_mask:0xf bank_mask:0xf
    v_add_f32_dpp v146, v146, v146 row_ror:4 row_mask:0xf bank_mask:0xf
    v_add_f32_dpp v148, v148, v148 row_ror:4 row_mask:0xf bank_mask:0xf
    v_add_f32_dpp v150, v150, v150 row_ror:4 row_mask:0xf bank_mask:0xf
    v_add_f32_dpp v146, v146, v146 row_ror:2 row_mask:0xf bank_mask:0xf
    v_add_f32_dpp v148, v148, v148 row_ror:2 row_mask:0xf bank_mask:0xf
    v_add_f32_dpp v150, v150, v150 row_ror:2 row_mask:0xf bank_mask:0xf
    v_add_f32_dpp v146, v146, v146 row_ror:1 row_mask:0xf bank_mask:0xf
    v_add_f32_dpp v148, v148, v148 row_ror:1 row_mask:0xf bank_mask:0xf
    v_add_f32_dpp v150, v150, v150 row_ror:1 row_mask:0xf bank_mask:0xf
    v_fma_f32 v146, v146, s41, v217
    v_fma_f32 v148, v148, s41, v217
    v_fma_f32 v150, v150, s41, v217
    v_rsq_f32 v146, v146
    v_rsq_f32 v148, v148
    v_rsq_f32 v150, v150
    v_pk_mul_f32 v[64:65], v[64:65], v[146:147] op_sel_hi:[1,0]
    v_pk_mul_f32 v[72:73], v[72:73], v[148:149] op_sel_hi:[1,0]
    v_pk_mul_f32 v[80:81], v[80:81], v[150:151] op_sel_hi:[1,0]
    v_pk_mul_f32 v[66:67], v[66:67], v[146:147] op_sel_hi:[1,0]
    v_pk_mul_f32 v[74:75], v[74:75], v[148:149] op_sel_hi:[1,0]
    v_pk_mul_f32 v[82:83], v[82:83], v[150:151] op_sel_hi:[1,0]
    v_pk_mul_f32 v[68:69], v[68:69], v[146:147] op_sel_hi:[1,0]
    v_pk_mul_f32 v[76:77], v[76:77], v[148:149] op_sel_hi:[1,0]
    v_pk_mul_f32 v[84:85], v[84:85], v[150:151] op_sel_hi:[1,0]
    v_pk_mul_f32 v[70:71], v[70:71], v[146:147] op_sel_hi:[1,0]
    v_pk_mul_f32 v[78:79], v[78:79], v[148:149] op_sel_hi:[1,0]
    v_pk_mul_f32 v[86:87], v[86:87], v[150:151] op_sel_hi:[1,0]
    s_add_u32 s42, s84, 131072
    v_add_u32 v146, s42, v4
    v_cvt_pk_bf16_f32 v32, v64, v65
    v_cvt_pk_bf16_f32 v33, v66, v67
    v_cvt_pk_bf16_f32 v34, v68, v69
    v_cvt_pk_bf16_f32 v35, v70, v71
    v_bfi_b32 v64, v31, v221, v32
    v_mov_b32 v65, v33
    v_mov_b32 v66, v34
    v_mov_b32 v67, v35
    s_add_u32 s42, s36, s84
    buffer_store_dwordx4 v[64:67], v4, s[8:11], s42 offen sc1
    s_add_u32 s42, s85, 131072
    v_add_u32 v148, s42, v4
    v_cvt_pk_bf16_f32 v36, v72, v73
    v_cvt_pk_bf16_f32 v37, v74, v75
    v_cvt_pk_bf16_f32 v38, v76, v77
    v_cvt_pk_bf16_f32 v39, v78, v79
    v_bfi_b32 v72, v31, v221, v36
    v_mov_b32 v73, v37
    v_mov_b32 v74, v38
    v_mov_b32 v75, v39
    s_add_u32 s42, s36, s85
    buffer_store_dwordx4 v[72:75], v4, s[8:11], s42 offen sc1
    s_add_u32 s42, s86, 131072
    v_add_u32 v150, s42, v4
    v_cvt_pk_bf16_f32 v40, v80, v81
    v_cvt_pk_bf16_f32 v41, v82, v83
    v_cvt_pk_bf16_f32 v42, v84, v85
    v_cvt_pk_bf16_f32 v43, v86, v87
    v_bfi_b32 v80, v31, v221, v40
    v_mov_b32 v81, v41
    v_mov_b32 v82, v42
    v_mov_b32 v83, v43
    s_add_u32 s42, s36, s44
    buffer_store_dwordx4 v[80:83], v4, s[8:11], s42 offen sc1
    ds_write_b128 v146, v[32:35]
    ds_write_b128 v148, v[36:39]
    ds_write_b128 v150, v[40:43]
    s_waitcnt vmcnt(11)
    s_barrier
    ds_read_b64_tr_b16 a[32:33], v212 offset:0
    ds_read_b64_tr_b16 a[34:35], v213 offset:0
    ds_read_b64_tr_b16 a[36:37], v212 offset:32768
    ds_read_b64_tr_b16 a[38:39], v213 offset:32768
    ds_read_b64_tr_b16 a[40:41], v214 offset:0
    ds_read_b64_tr_b16 a[42:43], v215 offset:0
    ds_read_b64_tr_b16 a[44:45], v214 offset:32768
    ds_read_b64_tr_b16 a[46:47], v215 offset:32768
    ds_read_b64_tr_b16 a[48:49], v212 offset:8
    ds_read_b64_tr_b16 a[50:51], v213 offset:8
    ds_read_b64_tr_b16 a[52:53], v212 offset:32776
    ds_read_b64_tr_b16 a[54:55], v213 offset:32776
    ds_read_b64_tr_b16 a[56:57], v214 offset:8
    ds_read_b64_tr_b16 a[58:59], v215 offset:8
    ds_read_b64_tr_b16 a[60:61], v214 offset:32776
    ds_read_b64_tr_b16 a[62:63], v215 offset:32776
    s_waitcnt vmcnt(20)
    v_lshlrev_b32 v88, 16, v44
    v_and_b32 v89, s43, v44
    v_lshlrev_b32 v90, 16, v45
    v_and_b32 v91, s43, v45
    v_lshlrev_b32 v92, 16, v46
    v_and_b32 v93, s43, v46
    v_lshlrev_b32 v94, 16, v47
    v_and_b32 v95, s43, v47
    s_waitcnt vmcnt(19)
    v_lshlrev_b32 v96, 16, v48
    v_and_b32 v97, s43, v48
    v_lshlrev_b32 v98, 16, v49
    v_and_b32 v99, s43, v49
    v_lshlrev_b32 v100, 16, v50
    v_and_b32 v101, s43, v50
    v_lshlrev_b32 v102, 16, v51
    v_and_b32 v103, s43, v51
    v_pk_add_f32 v[142:143], v[88:89], v[90:91]
    v_pk_add_f32 v[144:145], v[96:97], v[98:99]
    v_pk_add_f32 v[152:153], v[92:93], v[94:95]
    v_pk_add_f32 v[154:155], v[100:101], v[102:103]
    v_pk_add_f32 v[142:143], v[142:143], v[152:153]
    v_pk_add_f32 v[144:145], v[144:145], v[154:155]
    v_add_f32 v142, v142, v143
    v_add_f32 v144, v144, v145
    s_nop 0
    v_add_f32_dpp v142, v142, v142 row_ror:8 row_mask:0xf bank_mask:0xf
    v_add_f32_dpp v144, v144, v144 row_ror:8 row_mask:0xf bank_mask:0xf
    s_nop 0
    v_add_f32_dpp v142, v142, v142 row_ror:4 row_mask:0xf bank_mask:0xf
    v_add_f32_dpp v144, v144, v144 row_ror:4 row_mask:0xf bank_mask:0xf
    s_nop 0
    v_add_f32_dpp v142, v142, v142 row_ror:2 row_mask:0xf bank_mask:0xf
    v_add_f32_dpp v144, v144, v144 row_ror:2 row_mask:0xf bank_mask:0xf
    s_nop 0
    v_add_f32_dpp v142, v142, v142 row_ror:1 row_mask:0xf bank_mask:0xf
    v_add_f32_dpp v144, v144, v144 row_ror:1 row_mask:0xf bank_mask:0xf
    v_mul_f32 v142, s41, v142
    v_mul_f32 v144, s41, v144
    v_pk_add_f32 v[88:89], v[88:89], v[142:143] op_sel_hi:[1,0] neg_lo:[0,1] neg_hi:[0,1]
    v_pk_add_f32 v[96:97], v[96:97], v[144:145] op_sel_hi:[1,0] neg_lo:[0,1] neg_hi:[0,1]
    v_pk_add_f32 v[90:91], v[90:91], v[142:143] op_sel_hi:[1,0] neg_lo:[0,1] neg_hi:[0,1]
    v_pk_add_f32 v[98:99], v[98:99], v[144:145] op_sel_hi:[1,0] neg_lo:[0,1] neg_hi:[0,1]
    v_pk_add_f32 v[92:93], v[92:93], v[142:143] op_sel_hi:[1,0] neg_lo:[0,1] neg_hi:[0,1]
    v_pk_add_f32 v[100:101], v[100:101], v[144:145] op_sel_hi:[1,0] neg_lo:[0,1] neg_hi:[0,1]
    v_pk_add_f32 v[94:95], v[94:95], v[142:143] op_sel_hi:[1,0] neg_lo:[0,1] neg_hi:[0,1]
    v_pk_add_f32 v[102:103], v[102:103], v[144:145] op_sel_hi:[1,0] neg_lo:[0,1] neg_hi:[0,1]
    v_pk_mul_f32 v[152:153], v[88:89], v[88:89]
    v_pk_mul_f32 v[154:155], v[96:97], v[96:97]
    v_pk_fma_f32 v[152:153], v[90:91], v[90:91], v[152:153]
    v_pk_fma_f32 v[154:155], v[98:99], v[98:99], v[154:155]
    v_pk_fma_f32 v[152:153], v[92:93], v[92:93], v[152:153]
    v_pk_fma_f32 v[154:155], v[100:101], v[100:101], v[154:155]
    v_pk_fma_f32 v[152:153], v[94:95], v[94:95], v[152:153]
    v_pk_fma_f32 v[154:155], v[102:103], v[102:103], v[154:155]
    v_add_f32 v152, v152, v153
    v_add_f32 v154, v154, v155
    s_nop 0
    v_add_f32_dpp v152, v152, v152 row_ror:8 row_mask:0xf bank_mask:0xf
    v_add_f32_dpp v154, v154, v154 row_ror:8 row_mask:0xf bank_mask:0xf
    s_nop 0
    v_add_f32_dpp v152, v152, v152 row_ror:4 row_mask:0xf bank_mask:0xf
    v_add_f32_dpp v154, v154, v154 row_ror:4 row_mask:0xf bank_mask:0xf
    s_nop 0
    v_add_f32_dpp v152, v152, v152 row_ror:2 row_mask:0xf bank_mask:0xf
    v_add_f32_dpp v154, v154, v154 row_ror:2 row_mask:0xf bank_mask:0xf
    s_nop 0
    v_add_f32_dpp v152, v152, v152 row_ror:1 row_mask:0xf bank_mask:0xf
    v_add_f32_dpp v154, v154, v154 row_ror:1 row_mask:0xf bank_mask:0xf
    v_fma_f32 v152, v152, s41, v217
    v_fma_f32 v154, v154, s41, v217
    v_rsq_f32 v152, v152
    v_rsq_f32 v154, v154
    v_pk_mul_f32 v[88:89], v[88:89], v[152:153] op_sel_hi:[1,0]
    v_pk_mul_f32 v[96:97], v[96:97], v[154:155] op_sel_hi:[1,0]
    v_pk_mul_f32 v[90:91], v[90:91], v[152:153] op_sel_hi:[1,0]
    v_pk_mul_f32 v[98:99], v[98:99], v[154:155] op_sel_hi:[1,0]
    v_pk_mul_f32 v[92:93], v[92:93], v[152:153] op_sel_hi:[1,0]
    v_pk_mul_f32 v[100:101], v[100:101], v[154:155] op_sel_hi:[1,0]
    v_pk_mul_f32 v[94:95], v[94:95], v[152:153] op_sel_hi:[1,0]
    v_pk_mul_f32 v[102:103], v[102:103], v[154:155] op_sel_hi:[1,0]
    s_add_u32 s42, s87, 131072
    v_add_u32 v152, s42, v4
    v_cvt_pk_bf16_f32 v44, v88, v89
    v_cvt_pk_bf16_f32 v45, v90, v91
    v_cvt_pk_bf16_f32 v46, v92, v93
    v_cvt_pk_bf16_f32 v47, v94, v95
    s_add_u32 s42, s88, 131072
    v_add_u32 v154, s42, v4
    v_cvt_pk_bf16_f32 v48, v96, v97
    v_cvt_pk_bf16_f32 v49, v98, v99
    v_cvt_pk_bf16_f32 v50, v100, v101
    v_cvt_pk_bf16_f32 v51, v102, v103
    ds_write_b128 v152, v[44:47]
    ds_write_b128 v154, v[48:51]
    s_waitcnt lgkmcnt(0)
    s_add_u32 s59, s59, 0x9e3779b1
    s_barrier
    ds_read_b128 v[32:35], v232
    ds_read_b128 v[36:39], v233
    ds_read_b128 v[40:43], v234
    ds_read_b128 v[44:47], v235
    v_add_u32 v232, s37, v232
    v_add_u32 v233, s37, v233
    v_add_u32 v234, s37, v234
    v_add_u32 v235, s37, v235
    ds_read_b128 v[48:51], v232
    ds_read_b128 v[52:55], v233
    ds_read_b128 v[56:59], v234
    ds_read_b128 v[60:63], v235
    v_add_u32 v232, s37, v232
    v_add_u32 v233, s37, v233
    v_add_u32 v234, s37, v234
    v_add_u32 v235, s37, v235
    s_waitcnt lgkmcnt(4)
    v_mfma_f32_16x16x32_bf16 v[144:147], a[32:35], v[32:35], 0
    ds_read_b128 v[64:67], v232
    ds_read_b128 v[68:71], v233
    v_mfma_f32_16x16x32_bf16 v[144:147], a[36:39], v[36:39], v[144:147]
    ds_read_b128 v[72:75], v234
    ds_read_b128 v[76:79], v235
    v_mfma_f32_16x16x32_bf16 v[144:147], a[40:43], v[40:43], v[144:147]
    v_add_u32 v232, s37, v232
    v_add_u32 v233, s37, v233
    v_mfma_f32_16x16x32_bf16 v[144:147], a[44:47], v[44:47], v[144:147]
    v_add_u32 v234, s37, v234
    v_add_u32 v235, s37, v235
    v_mfma_f32_16x16x32_bf16 v[148:151], a[48:51], v[32:35], 0
    v_mfma_f32_16x16x32_bf16 v[148:151], a[52:55], v[36:39], v[148:151]
    v_mfma_f32_16x16x32_bf16 v[148:151], a[56:59], v[40:43], v[148:151]
    v_mfma_f32_16x16x32_bf16 v[148:151], a[60:63], v[44:47], v[148:151]
    s_waitcnt lgkmcnt(4)
    v_mfma_f32_16x16x32_bf16 v[152:155], a[32:35], v[48:51], 0
    ds_read_b128 v[80:83], v232
    ds_read_b128 v[84:87], v233
    v_mfma_f32_16x16x32_bf16 v[152:155], a[36:39], v[52:55], v[152:155]
    ds_read_b128 v[88:91], v234
    ds_read_b128 v[92:95], v235
    v_mfma_f32_16x16x32_bf16 v[152:155], a[40:43], v[56:59], v[152:155]
    v_add_u32 v232, s37, v232
    v_add_u32 v233, s37, v233
    v_mfma_f32_16x16x32_bf16 v[152:155], a[44:47], v[60:63], v[152:155]
    v_add_u32 v234, s37, v234
    v_add_u32 v235, s37, v235
    v_mfma_f32_16x16x32_bf16 v[156:159], a[48:51], v[48:51], 0
    v_cvt_pk_bf16_f32 v144, v144, v145
    v_cvt_pk_bf16_f32 v145, v146, v147
    v_mfma_f32_16x16x32_bf16 v[156:159], a[52:55], v[52:55], v[156:159]
    v_cvt_pk_bf16_f32 v146, v148, v149
    v_cvt_pk_bf16_f32 v147, v150, v151
    v_mfma_f32_16x16x32_bf16 v[156:159], a[56:59], v[56:59], v[156:159]
    ds_write_b128 v1, v[144:147] offset:16384
    v_mfma_f32_16x16x32_bf16 v[156:159], a[60:63], v[60:63], v[156:159]
    s_waitcnt lgkmcnt(5)
    v_mfma_f32_16x16x32_bf16 v[160:163], a[32:35], v[64:67], 0
    ds_read_b128 v[96:99], v232
    ds_read_b128 v[100:103], v233
    v_mfma_f32_16x16x32_bf16 v[160:163], a[36:39], v[68:71], v[160:163]
    ds_read_b128 v[104:107], v234
    ds_read_b128 v[108:111], v235
    v_mfma_f32_16x16x32_bf16 v[160:163], a[40:43], v[72:75], v[160:163]
    v_cvt_pk_bf16_f32 v152, v152, v153
    v_cvt_pk_bf16_f32 v153, v154, v155
    v_mfma_f32_16x16x32_bf16 v[160:163], a[44:47], v[76:79], v[160:163]
    v_cvt_pk_bf16_f32 v154, v156, v157
    v_cvt_pk_bf16_f32 v155, v158, v159
    v_mfma_f32_16x16x32_bf16 v[164:167], a[48:51], v[64:67], 0
    v_mfma_f32_16x16x32_bf16 v[164:167], a[52:55], v[68:71], v[164:167]
    v_mfma_f32_16x16x32_bf16 v[164:167], a[56:59], v[72:75], v[164:167]
    v_mfma_f32_16x16x32_bf16 v[164:167], a[60:63], v[76:79], v[164:167]
    v_mov_b32 v7, s59
    s_waitcnt vmcnt(0)
    buffer_store_dword v7, off, s[12:15], s57 sc1
    ds_write_b128 v1, v[152:155] offset:17408
    s_waitcnt lgkmcnt(6)
    v_mfma_f32_16x16x32_bf16 v[168:171], a[32:35], v[80:83], 0
    buffer_load_dwordx4 v[220:223], v28, s[16:19], 0 offen
    v_mfma_f32_16x16x32_bf16 v[168:171], a[36:39], v[84:87], v[168:171]
    buffer_load_dwordx4 v[224:227], v29, s[16:19], 0 offen
    v_mfma_f32_16x16x32_bf16 v[168:171], a[40:43], v[88:91], v[168:171]
    buffer_load_dwordx4 v[228:231], v30, s[16:19], 0 offen
    v_mfma_f32_16x16x32_bf16 v[168:171], a[44:47], v[92:95], v[168:171]
    buffer_load_ushort v26, v26, s[24:27], 0 offen
    v_mfma_f32_16x16x32_bf16 v[172:175], a[48:51], v[80:83], 0
    v_cvt_pk_bf16_f32 v160, v160, v161
    v_cvt_pk_bf16_f32 v161, v162, v163
    v_mfma_f32_16x16x32_bf16 v[172:175], a[52:55], v[84:87], v[172:175]
    v_cvt_pk_bf16_f32 v162, v164, v165
    v_cvt_pk_bf16_f32 v163, v166, v167
    v_mfma_f32_16x16x32_bf16 v[172:175], a[56:59], v[88:91], v[172:175]
    ds_write_b128 v1, v[160:163] offset:18432
    v_mfma_f32_16x16x32_bf16 v[172:175], a[60:63], v[92:95], v[172:175]
    s_waitcnt lgkmcnt(2)
    v_mfma_f32_16x16x32_bf16 v[176:179], a[32:35], v[96:99], 0
    s_waitcnt vmcnt(8)
    ds_read_b128 a[0:3], v204
    ds_read_b128 a[4:7], v205
    v_mfma_f32_16x16x32_bf16 v[176:179], a[36:39], v[100:103], v[176:179]
    ds_read_b128 a[8:11], v206
    ds_read_b128 a[12:15], v207
    v_mfma_f32_16x16x32_bf16 v[176:179], a[40:43], v[104:107], v[176:179]
    ds_read_b128 a[16:19], v208
    ds_read_b128 a[20:23], v209
    v_mfma_f32_16x16x32_bf16 v[176:179], a[44:47], v[108:111], v[176:179]
    ds_read_b128 a[24:27], v210
    ds_read_b128 a[28:31], v211
    v_mfma_f32_16x16x32_bf16 v[180:183], a[48:51], v[96:99], 0
    v_cvt_pk_bf16_f32 v168, v168, v169
    v_cvt_pk_bf16_f32 v169, v170, v171
    v_mfma_f32_16x16x32_bf16 v[180:183], a[52:55], v[100:103], v[180:183]
    v_cvt_pk_bf16_f32 v170, v172, v173
    v_cvt_pk_bf16_f32 v171, v174, v175
    v_mfma_f32_16x16x32_bf16 v[180:183], a[56:59], v[104:107], v[180:183]
    ds_write_b128 v1, v[168:171] offset:19456
    v_mfma_f32_16x16x32_bf16 v[180:183], a[60:63], v[108:111], v[180:183]
    v_cvt_pk_bf16_f32 v176, v176, v177
    v_cvt_pk_bf16_f32 v177, v178, v179
    s_nop 5
    v_cvt_pk_bf16_f32 v178, v180, v181
    v_cvt_pk_bf16_f32 v179, v182, v183
    ds_write_b128 v1, v[176:179] offset:20480
    s_waitcnt lgkmcnt(0)
    s_barrier
    v_lshlrev_b32 v7, 4, v25
    ds_read_b128 a[64:67], v7 offset:8192
    ds_read_b128 a[68:71], v7 offset:8256
    ds_read_b128 a[72:75], v7 offset:8320
    ds_read_b128 a[76:79], v7 offset:8384
    ds_read_b128 v[32:35], v20 offset:16384
    ds_read_b128 v[36:39], v20 offset:49152
    ds_read_b128 v[40:43], v6 offset:16384
    ds_read_b128 v[44:47], v6 offset:49152
    ds_read_b128 v[48:51], v20 offset:17408
    ds_read_b128 v[52:55], v20 offset:50176
    ds_read_b128 v[56:59], v6 offset:17408
    ds_read_b128 v[60:63], v6 offset:50176
    s_mov_b32 s41, 0x3e0293ee
    s_mov_b32 s44, 0xbe0293ee
    s_waitcnt lgkmcnt(4)
    v_mfma_f32_16x16x32_bf16 v[184:187], a[64:67], v[32:35], 0
    ds_read_b128 v[64:67], v20 offset:18432
    ds_read_b128 v[68:71], v20 offset:51200
    v_mfma_f32_16x16x32_bf16 v[184:187], a[68:71], v[36:39], v[184:187]
    ds_read_b128 v[72:75], v6 offset:18432
    ds_read_b128 v[76:79], v6 offset:51200
    v_mfma_f32_16x16x32_bf16 v[184:187], a[72:75], v[40:43], v[184:187]
    v_mfma_f32_16x16x32_bf16 v[184:187], a[76:79], v[44:47], v[184:187]
    v_mfma_f32_16x16x32_bf16 v[144:147], a[0:3], v[32:35], 0
    v_mfma_f32_16x16x32_bf16 v[144:147], a[4:7], v[36:39], v[144:147]
    v_mfma_f32_16x16x32_bf16 v[144:147], a[8:11], v[40:43], v[144:147]
    v_mfma_f32_16x16x32_bf16 v[144:147], a[12:15], v[44:47], v[144:147]
    v_mfma_f32_16x16x32_bf16 v[148:151], a[16:19], v[32:35], 0
    v_mfma_f32_16x16x32_bf16 v[148:151], a[20:23], v[36:39], v[148:151]
    v_mfma_f32_16x16x32_bf16 v[148:151], a[24:27], v[40:43], v[148:151]
    v_mfma_f32_16x16x32_bf16 v[148:151], a[28:31], v[44:47], v[148:151]
    s_waitcnt lgkmcnt(4)
    v_mfma_f32_16x16x32_bf16 v[188:191], a[64:67], v[48:51], 0
    ds_read_b128 v[80:83], v20 offset:19456
    ds_read_b128 v[84:87], v20 offset:52224
    v_mfma_f32_16x16x32_bf16 v[188:191], a[68:71], v[52:55], v[188:191]
    ds_read_b128 v[88:91], v6 offset:19456
    ds_read_b128 v[92:95], v6 offset:52224
    v_mfma_f32_16x16x32_bf16 v[188:191], a[72:75], v[56:59], v[188:191]
    v_mul_f32 v184, s44, v184
    v_mul_f32 v185, v144, v144
    v_mfma_f32_16x16x32_bf16 v[188:191], a[76:79], v[60:63], v[188:191]
    v_mul_f32 v186, v145, v145
    v_fmac_f32 v185, v146, v146
    v_mfma_f32_16x16x32_bf16 v[152:155], a[0:3], v[48:51], 0
    v_fmac_f32 v186, v147, v147
    v_fmac_f32 v185, v148, v148
    v_mfma_f32_16x16x32_bf16 v[152:155], a[4:7], v[52:55], v[152:155]
    v_fmac_f32 v186, v149, v149
    v_fmac_f32 v185, v150, v150
    v_mfma_f32_16x16x32_bf16 v[152:155], a[8:11], v[56:59], v[152:155]
    v_fmac_f32 v186, v151, v151
    v_fma_f32 v144, v144, s41, v184
    v_mfma_f32_16x16x32_bf16 v[152:155], a[12:15], v[60:63], v[152:155]
    v_fma_f32 v145, v145, s41, v184
    v_fma_f32 v146, v146, s41, v184
    v_mfma_f32_16x16x32_bf16 v[156:159], a[16:19], v[48:51], 0
    v_fma_f32 v147, v147, s41, v184
    v_fma_f32 v148, v148, s41, v184
    v_mfma_f32_16x16x32_bf16 v[156:159], a[20:23], v[52:55], v[156:159]
    v_fma_f32 v149, v149, s41, v184
    v_fma_f32 v150, v150, s41, v184
    v_mfma_f32_16x16x32_bf16 v[156:159], a[24:27], v[56:59], v[156:159]
    v_fma_f32 v151, v151, s41, v184
    v_add_f32 v185, v185, v186
    v_mfma_f32_16x16x32_bf16 v[156:159], a[28:31], v[60:63], v[156:159]
    v_cvt_pk_bf16_f32 v144, v144, v145
    v_cvt_pk_bf16_f32 v145, v146, v147
    v_cvt_pk_bf16_f32 v146, v148, v149
    v_cvt_pk_bf16_f32 v147, v150, v151
    ds_write_b128 v1, v[144:147] offset:24576
    s_waitcnt lgkmcnt(5)
    v_mfma_f32_16x16x32_bf16 v[192:195], a[64:67], v[64:67], 0
    ds_read_b128 v[96:99], v20 offset:20480
    ds_read_b128 v[100:103], v20 offset:53248
    v_mfma_f32_16x16x32_bf16 v[192:195], a[68:71], v[68:71], v[192:195]
    ds_read_b128 v[104:107], v6 offset:20480
    ds_read_b128 v[108:111], v6 offset:53248
    v_mfma_f32_16x16x32_bf16 v[192:195], a[72:75], v[72:75], v[192:195]
    buffer_load_dwordx4 v[236:239], v216, s[12:15], s58 offen sc1
    v_mfma_f32_16x16x32_bf16 v[192:195], a[76:79], v[76:79], v[192:195]
    v_mul_f32 v188, s44, v188
    v_mul_f32 v189, v152, v152
    v_mfma_f32_16x16x32_bf16 v[160:163], a[0:3], v[64:67], 0
    v_mul_f32 v190, v153, v153
    v_fmac_f32 v189, v154, v154
    v_mfma_f32_16x16x32_bf16 v[160:163], a[4:7], v[68:71], v[160:163]
    v_fmac_f32 v190, v155, v155
    v_fmac_f32 v189, v156, v156
    v_mfma_f32_16x16x32_bf16 v[160:163], a[8:11], v[72:75], v[160:163]
    v_fmac_f32 v190, v157, v157
    v_fmac_f32 v189, v158, v158
    v_mfma_f32_16x16x32_bf16 v[160:163], a[12:15], v[76:79], v[160:163]
    v_fmac_f32 v190, v159, v159
    v_fma_f32 v152, v152, s41, v188
    v_mfma_f32_16x16x32_bf16 v[164:167], a[16:19], v[64:67], 0
    v_fma_f32 v153, v153, s41, v188
    v_fma_f32 v154, v154, s41, v188
    v_mfma_f32_16x16x32_bf16 v[164:167], a[20:23], v[68:71], v[164:167]
    v_fma_f32 v155, v155, s41, v188
    v_fma_f32 v156, v156, s41, v188
    v_mfma_f32_16x16x32_bf16 v[164:167], a[24:27], v[72:75], v[164:167]
    v_fma_f32 v157, v157, s41, v188
    v_fma_f32 v158, v158, s41, v188
    v_mfma_f32_16x16x32_bf16 v[164:167], a[28:31], v[76:79], v[164:167]
    v_fma_f32 v159, v159, s41, v188
    v_add_f32 v189, v189, v190
    v_cvt_pk_bf16_f32 v152, v152, v153
    v_cvt_pk_bf16_f32 v153, v154, v155
    v_cvt_pk_bf16_f32 v154, v156, v157
    v_cvt_pk_bf16_f32 v155, v158, v159
    v_max_f32 v185, v185, v189
    ds_write_b128 v1, v[152:155] offset:25600
    s_waitcnt lgkmcnt(6)
    v_mfma_f32_16x16x32_bf16 v[196:199], a[64:67], v[80:83], 0
    v_mfma_f32_16x16x32_bf16 v[196:199], a[68:71], v[84:87], v[196:199]
    v_mfma_f32_16x16x32_bf16 v[196:199], a[72:75], v[88:91], v[196:199]
    v_mul_f32 v192, s44, v192
    v_mul_f32 v193, v160, v160
    v_mfma_f32_16x16x32_bf16 v[196:199], a[76:79], v[92:95], v[196:199]
    v_mul_f32 v194, v161, v161
    v_fmac_f32 v193, v162, v162
    v_mfma_f32_16x16x32_bf16 v[168:171], a[0:3], v[80:83], 0
    v_fmac_f32 v194, v163, v163
    v_fmac_f32 v193, v164, v164
    v_mfma_f32_16x16x32_bf16 v[168:171], a[4:7], v[84:87], v[168:171]
    v_fmac_f32 v194, v165, v165
    v_fmac_f32 v193, v166, v166
    v_mfma_f32_16x16x32_bf16 v[168:171], a[8:11], v[88:91], v[168:171]
    v_fmac_f32 v194, v167, v167
    v_fma_f32 v160, v160, s41, v192
    v_mfma_f32_16x16x32_bf16 v[168:171], a[12:15], v[92:95], v[168:171]
    v_fma_f32 v161, v161, s41, v192
    v_fma_f32 v162, v162, s41, v192
    v_mfma_f32_16x16x32_bf16 v[172:175], a[16:19], v[80:83], 0
    v_fma_f32 v163, v163, s41, v192
    v_fma_f32 v164, v164, s41, v192
    v_mfma_f32_16x16x32_bf16 v[172:175], a[20:23], v[84:87], v[172:175]
    v_fma_f32 v165, v165, s41, v192
    v_fma_f32 v166, v166, s41, v192
    v_mfma_f32_16x16x32_bf16 v[172:175], a[24:27], v[88:91], v[172:175]
    v_fma_f32 v167, v167, s41, v192
    v_add_f32 v193, v193, v194
    v_mfma_f32_16x16x32_bf16 v[172:175], a[28:31], v[92:95], v[172:175]
    v_cvt_pk_bf16_f32 v160, v160, v161
    v_cvt_pk_bf16_f32 v161, v162, v163
    v_cvt_pk_bf16_f32 v162, v164, v165
    v_cvt_pk_bf16_f32 v163, v166, v167
    v_max_f32 v185, v185, v193
    ds_write_b128 v1, v[160:163] offset:26624
    s_waitcnt lgkmcnt(2)
    v_mfma_f32_16x16x32_bf16 v[200:203], a[64:67], v[96:99], 0
    v_mfma_f32_16x16x32_bf16 v[200:203], a[68:71], v[100:103], v[200:203]
    v_mfma_f32_16x16x32_bf16 v[200:203], a[72:75], v[104:107], v[200:203]
    v_mul_f32 v196, s44, v196
    v_mul_f32 v197, v168, v168
    v_mfma_f32_16x16x32_bf16 v[200:203], a[76:79], v[108:111], v[200:203]
    v_mul_f32 v198, v169, v169
    v_fmac_f32 v197, v170, v170
    v_mfma_f32_16x16x32_bf16 v[176:179], a[0:3], v[96:99], 0
    v_fmac_f32 v198, v171, v171
    v_fmac_f32 v197, v172, v172
    v_mfma_f32_16x16x32_bf16 v[176:179], a[4:7], v[100:103], v[176:179]
    v_fmac_f32 v198, v173, v173
    v_fmac_f32 v197, v174, v174
    v_mfma_f32_16x16x32_bf16 v[176:179], a[8:11], v[104:107], v[176:179]
    v_fmac_f32 v198, v175, v175
    v_fma_f32 v168, v168, s41, v196
    v_mfma_f32_16x16x32_bf16 v[176:179], a[12:15], v[108:111], v[176:179]
    v_fma_f32 v169, v169, s41, v196
    v_fma_f32 v170, v170, s41, v196
    v_mfma_f32_16x16x32_bf16 v[180:183], a[16:19], v[96:99], 0
    v_fma_f32 v171, v171, s41, v196
    v_fma_f32 v172, v172, s41, v196
    v_mfma_f32_16x16x32_bf16 v[180:183], a[20:23], v[100:103], v[180:183]
    v_fma_f32 v173, v173, s41, v196
    v_fma_f32 v174, v174, s41, v196
    v_mfma_f32_16x16x32_bf16 v[180:183], a[24:27], v[104:107], v[180:183]
    v_fma_f32 v175, v175, s41, v196
    v_add_f32 v197, v197, v198
    v_mfma_f32_16x16x32_bf16 v[180:183], a[28:31], v[108:111], v[180:183]
    v_cvt_pk_bf16_f32 v168, v168, v169
    v_cvt_pk_bf16_f32 v169, v170, v171
    v_cvt_pk_bf16_f32 v170, v172, v173
    v_cvt_pk_bf16_f32 v171, v174, v175
    v_max_f32 v185, v185, v197
    ds_write_b128 v1, v[168:171] offset:27648
    s_waitcnt vmcnt(0)
    v_xor_b32 v240, s59, v236
    v_xor_b32 v241, s59, v237
    v_xor_b32 v242, s59, v238
    v_xor_b32 v243, s59, v239
    v_or3_b32 v240, v240, v241, v242
    v_or_b32 v240, v240, v243
    v_cmp_ne_u32 vcc, 0, v240
    s_mov_b32 s33, 0
    s_nop 3
    s_cbranch_vccz L2_isready
    v_mul_f32 v200, s44, v200
    v_mul_f32 v201, v176, v176
    v_mul_f32 v202, v177, v177
    v_fmac_f32 v201, v178, v178
    v_fmac_f32 v202, v179, v179
    v_fmac_f32 v201, v180, v180
    v_fmac_f32 v202, v181, v181
    v_fmac_f32 v201, v182, v182
    v_fmac_f32 v202, v183, v183
    v_fma_f32 v176, v176, s41, v200
    v_fma_f32 v177, v177, s41, v200
    v_fma_f32 v178, v178, s41, v200
    v_fma_f32 v179, v179, s41, v200
    v_fma_f32 v180, v180, s41, v200
    v_fma_f32 v181, v181, s41, v200
    v_fma_f32 v182, v182, s41, v200
    v_fma_f32 v183, v183, s41, v200
    v_add_f32 v201, v201, v202
    v_cvt_pk_bf16_f32 v176, v176, v177
    v_cvt_pk_bf16_f32 v177, v178, v179
    v_cvt_pk_bf16_f32 v178, v180, v181
    v_cvt_pk_bf16_f32 v179, v182, v183
    v_max_f32 v185, v185, v201
    ds_write_b128 v1, v[176:179] offset:28672
    ds_write_b32 v2, v185
    s_branch L2_posted
L2_isready:
    s_mov_b32 s33, 1
    v_mul_f32 v200, s44, v200
    s_add_u32 m0, s30, 0
    s_nop 0
    buffer_load_dwordx4 v20, s[8:11], s31 offen offset:0 sc1 lds
    v_mul_f32 v201, v176, v176
    v_mul_f32 v202, v177, v177
    v_fmac_f32 v201, v178, v178
    buffer_load_dwordx4 v20, s[8:11], s31 offen offset:1024 sc1 lds
    v_fmac_f32 v202, v179, v179
    v_fmac_f32 v201, v180, v180
    v_fmac_f32 v202, v181, v181
    buffer_load_dwordx4 v20, s[8:11], s31 offen offset:2048 sc1 lds
    v_fmac_f32 v201, v182, v182
    v_fmac_f32 v202, v183, v183
    v_fma_f32 v176, v176, s41, v200
    buffer_load_dwordx4 v20, s[8:11], s31 offen offset:3072 sc1 lds
    v_fma_f32 v177, v177, s41, v200
    v_fma_f32 v178, v178, s41, v200
    v_fma_f32 v179, v179, s41, v200
    s_add_u32 m0, s30, 4096
    s_nop 0
    buffer_load_dwordx4 v21, s[8:11], s31 offen offset:0 sc1 lds
    v_fma_f32 v180, v180, s41, v200
    v_fma_f32 v181, v181, s41, v200
    v_fma_f32 v182, v182, s41, v200
    buffer_load_dwordx4 v21, s[8:11], s31 offen offset:1024 sc1 lds
    v_fma_f32 v183, v183, s41, v200
    v_add_f32 v201, v201, v202
    v_cvt_pk_bf16_f32 v176, v176, v177
    buffer_load_dwordx4 v21, s[8:11], s31 offen offset:2048 sc1 lds
    v_cvt_pk_bf16_f32 v177, v178, v179
    v_cvt_pk_bf16_f32 v178, v180, v181
    v_cvt_pk_bf16_f32 v179, v182, v183
    buffer_load_dwordx4 v21, s[8:11], s31 offen offset:3072 sc1 lds
    s_add_u32 s31, s31, 8192
    v_max_f32 v185, v185, v201
    ds_write_b128 v1, v[176:179] offset:28672
    ds_write_b32 v2, v185
L2_posted:
    s_waitcnt lgkmcnt(0)
    s_barrier
    ds_read_b128 v[188:191], v5
    ds_read_b128 a[160:163], v20 offset:24576
    ds_read_b128 a[164:167], v20 offset:57344
    ds_read_b128 a[168:171], v6 offset:24576
    ds_read_b128 a[172:175], v6 offset:57344
    ds_read_b128 a[176:179], v20 offset:25600
    ds_read_b128 a[180:183], v20 offset:58368
    ds_read_b128 a[184:187], v6 offset:25600
    ds_read_b128 a[188:191], v6 offset:58368
    ds_read_b128 a[192:195], v20 offset:26624
    ds_read_b128 a[196:199], v20 offset:59392
    ds_read_b128 a[200:203], v6 offset:26624
    ds_read_b128 a[204:207], v6 offset:59392
    ds_read_b128 a[208:211], v20 offset:27648
    ds_read_b128 a[212:215], v20 offset:60416
    ds_read_b128 a[216:219], v6 offset:27648
    ds_read_b128 a[220:223], v6 offset:60416
    ds_read_b128 a[224:227], v20 offset:28672
    ds_read_b128 a[228:231], v20 offset:61440
    ds_read_b128 a[232:235], v6 offset:28672
    ds_read_b128 a[236:239], v6 offset:61440
    s_cmp_eq_u32 s33, 1
    s_cbranch_scc1 L2_fired
    buffer_load_dwordx4 v[236:239], v216, s[12:15], s58 offen sc1
    s_waitcnt vmcnt(0)
    s_mov_b32 s49, 0x40000
L2_rdy_a:
    v_xor_b32 v236, s59, v236
    v_xor_b32 v237, s59, v237
    v_xor_b32 v238, s59, v238
    v_xor_b32 v239, s59, v239
    v_or3_b32 v236, v236, v237, v238
    v_or_b32 v236, v236, v239
    v_cmp_ne_u32 vcc, 0, v236
    s_sub_u32 s49, s49, 1
    s_cselect_b64 vcc, 0, vcc
    s_cbranch_vccz L2_go_a
    buffer_load_dwordx4 v[236:239], v216, s[12:15], s58 offen sc1
    s_waitcnt vmcnt(0)
    s_branch L2_rdy_a
L2_go_a:
    s_add_u32 m0, s30, 0
    s_nop 0
    buffer_load_dwordx4 v20, s[8:11], s31 offen offset:0 sc1 lds
    buffer_load_dwordx4 v20, s[8:11], s31 offen offset:1024 sc1 lds
    buffer_load_dwordx4 v20, s[8:11], s31 offen offset:2048 sc1 lds
    buffer_load_dwordx4 v20, s[8:11], s31 offen offset:3072 sc1 lds
    s_add_u32 m0, s30, 4096
    s_nop 0
    buffer_load_dwordx4 v21, s[8:11], s31 offen offset:0 sc1 lds
    buffer_load_dwordx4 v21, s[8:11], s31 offen offset:1024 sc1 lds
    buffer_load_dwordx4 v21, s[8:11], s31 offen offset:2048 sc1 lds
    buffer_load_dwordx4 v21, s[8:11], s31 offen offset:3072 sc1 lds
    s_add_u32 s31, s31, 8192
L2_fired:
    s_add_u32 m0, s30, 8192
    s_nop 0
    buffer_load_dwordx4 v20, s[8:11], s31 offen offset:0 sc1 lds
    buffer_load_dwordx4 v20, s[8:11], s31 offen offset:1024 sc1 lds
    buffer_load_dwordx4 v20, s[8:11], s31 offen offset:2048 sc1 lds
    buffer_load_dwordx4 v20, s[8:11], s31 offen offset:3072 sc1 lds
    s_waitcnt lgkmcnt(15)
    v_add_f32 v188, v188, v189
    v_add_f32 v190, v190, v191
    v_add_f32 v188, v188, v190
    v_mov_b32 v189, v188
    s_add_u32 m0, s30, 12288
    s_nop 0
    buffer_load_dwordx4 v21, s[8:11], s31 offen offset:0 sc1 lds
    v_permlane32_swap_b32 v188, v189
    v_add_f32 v188, v188, v189
    v_mov_b32 v189, v188
    buffer_load_dwordx4 v21, s[8:11], s31 offen offset:1024 sc1 lds
    s_nop 0
    v_permlane16_swap_b32 v188, v189
    v_add_f32 v188, v188, v189
    v_mov_b32 v189, 0x45387e74
    v_cmp_nle_f32 vcc, v188, v189
    buffer_load_dwordx4 v21, s[8:11], s31 offen offset:2048 sc1 lds
    buffer_load_dwordx4 v21, s[8:11], s31 offen offset:3072 sc1 lds
    s_add_u32 s31, s31, 8192
    s_waitcnt vmcnt(8)
    ds_read_b128 v[32:35], v8 offset:0
    ds_read_b128 v[36:39], v9 offset:0
    ds_read_b128 v[40:43], v10 offset:0
    ds_read_b128 v[44:47], v11 offset:0
    ds_read_b128 v[48:51], v8 offset:4096
    ds_read_b128 v[52:55], v9 offset:4096
    ds_read_b128 v[56:59], v10 offset:4096
    ds_read_b128 v[60:63], v11 offset:4096
    ds_read_b64_tr_b16 v[96:97], v12 offset:0
    ds_read_b64_tr_b16 v[98:99], v12 offset:4096
    ds_read_b64_tr_b16 v[100:101], v13 offset:0
    ds_read_b64_tr_b16 v[102:103], v13 offset:4096
    s_waitcnt lgkmcnt(12)
    s_barrier
    s_mov_b32 s33, 8
    s_waitcnt lgkmcnt(8)
    v_mfma_f32_16x16x32_bf16 v[160:163], v[32:35], a[160:163], 0
    s_add_u32 m0, s30, 16384
    s_nop 0
    buffer_load_dwordx4 v20, s[8:11], s31 offen offset:0 sc1 lds
    ds_read_b64_tr_b16 v[104:105], v14 offset:0
    ds_read_b64_tr_b16 v[106:107], v14 offset:4096
    v_mfma_f32_16x16x32_bf16 v[160:163], v[36:39], a[164:167], v[160:163]
    buffer_load_dwordx4 v20, s[8:11], s31 offen offset:1024 sc1 lds
    ds_read_b64_tr_b16 v[108:109], v15 offset:0
    ds_read_b64_tr_b16 v[110:111], v15 offset:4096
    v_mfma_f32_16x16x32_bf16 v[160:163], v[40:43], a[168:171], v[160:163]
    buffer_load_dwordx4 v20, s[8:11], s31 offen offset:2048 sc1 lds
    ds_read_b64_tr_b16 v[112:113], v16 offset:0
    ds_read_b64_tr_b16 v[114:115], v16 offset:4096
    v_mfma_f32_16x16x32_bf16 v[160:163], v[44:47], a[172:175], v[160:163]
    buffer_load_dwordx4 v20, s[8:11], s31 offen offset:3072 sc1 lds
    ds_read_b64_tr_b16 v[116:117], v17 offset:0
    ds_read_b64_tr_b16 v[118:119], v17 offset:4096
    s_waitcnt lgkmcnt(12)
    v_mfma_f32_16x16x32_bf16 v[164:167], v[48:51], a[160:163], 0
    s_add_u32 m0, s30, 20480
    s_nop 0
    buffer_load_dwordx4 v21, s[8:11], s31 offen offset:0 sc1 lds
    ds_read_b64_tr_b16 v[120:121], v18 offset:0
    ds_read_b64_tr_b16 v[122:123], v18 offset:4096
    v_mfma_f32_16x16x32_bf16 v[164:167], v[52:55], a[164:167], v[164:167]
    buffer_load_dwordx4 v21, s[8:11], s31 offen offset:1024 sc1 lds
    ds_read_b64_tr_b16 v[124:125], v19 offset:0
    ds_read_b64_tr_b16 v[126:127], v19 offset:4096
    v_mfma_f32_16x16x32_bf16 v[164:167], v[56:59], a[168:171], v[164:167]
    buffer_load_dwordx4 v21, s[8:11], s31 offen offset:2048 sc1 lds
    v_mfma_f32_16x16x32_bf16 v[164:167], v[60:63], a[172:175], v[164:167]
    buffer_load_dwordx4 v21, s[8:11], s31 offen offset:3072 sc1 lds
    s_add_u32 s31, s31, 8192
    s_cbranch_vccnz L2_slow
    v_mfma_f32_16x16x32_bf16 v[168:171], v[32:35], a[176:179], 0
    s_waitcnt vmcnt(8)
    v_exp_f32 v160, v160
    v_mfma_f32_16x16x32_bf16 v[168:171], v[36:39], a[180:183], v[168:171]
    ds_read_b128 v[64:67], v8 offset:8192
    ds_read_b128 v[68:71], v9 offset:8192
    v_mfma_f32_16x16x32_bf16 v[168:171], v[40:43], a[184:187], v[168:171]
    v_exp_f32 v161, v161
    v_mfma_f32_16x16x32_bf16 v[168:171], v[44:47], a[188:191], v[168:171]
    ds_read_b128 v[72:75], v10 offset:8192
    v_cvt_pk_bf16_f32 v176, v160, v161
    v_exp_f32 v162, v162
    ds_read_b128 v[76:79], v11 offset:8192
    ds_read_b128 v[80:83], v8 offset:12288
    v_exp_f32 v163, v163
    ds_read_b128 v[84:87], v9 offset:12288
    v_cvt_pk_bf16_f32 v177, v162, v163
    v_mfma_f32_16x16x32_bf16 v[172:175], v[48:51], a[176:179], 0
    v_exp_f32 v164, v164
    v_mfma_f32_16x16x32_bf16 v[172:175], v[52:55], a[180:183], v[172:175]
    ds_read_b128 v[88:91], v10 offset:12288
    ds_read_b128 v[92:95], v11 offset:12288
    v_mfma_f32_16x16x32_bf16 v[172:175], v[56:59], a[184:187], v[172:175]
    v_exp_f32 v165, v165
    v_mfma_f32_16x16x32_bf16 v[172:175], v[60:63], a[188:191], v[172:175]
    v_cvt_pk_bf16_f32 v178, v164, v165
    v_exp_f32 v166, v166
    s_waitcnt lgkmcnt(8)
    v_exp_f32 v167, v167
    ds_read_b64_tr_b16 v[128:129], v12 offset:8192
    v_cvt_pk_bf16_f32 v179, v166, v167
    v_mfma_f32_16x16x32_bf16 v[160:163], v[32:35], a[192:195], 0
    s_add_u32 m0, s30, 24576
    v_exp_f32 v168, v168
    v_mfma_f32_16x16x32_bf16 v[160:163], v[36:39], a[196:199], v[160:163]
    buffer_load_dwordx4 v20, s[8:11], s31 offen offset:0 sc1 lds
    v_mfma_f32_16x16x32_bf16 v[160:163], v[40:43], a[200:203], v[160:163]
    v_exp_f32 v169, v169
    v_mfma_f32_16x16x32_bf16 v[160:163], v[44:47], a[204:207], v[160:163]
    ds_read_b64_tr_b16 v[130:131], v12 offset:12288
    v_cvt_pk_bf16_f32 v180, v168, v169
    v_mfma_f32_16x16x32_bf16 a[0:3], v[96:99], v[176:179], 0
    v_exp_f32 v170, v170
    v_mfma_f32_16x16x32_bf16 a[4:7], v[100:103], v[176:179], 0
    buffer_load_dwordx4 v20, s[8:11], s31 offen offset:1024 sc1 lds
    v_mfma_f32_16x16x32_bf16 a[8:11], v[104:107], v[176:179], 0
    v_exp_f32 v171, v171
    v_mfma_f32_16x16x32_bf16 a[12:15], v[108:111], v[176:179], 0
    ds_read_b64_tr_b16 v[132:133], v13 offset:8192
    v_cvt_pk_bf16_f32 v181, v170, v171
    v_mfma_f32_16x16x32_bf16 v[164:167], v[48:51], a[192:195], 0
    v_exp_f32 v172, v172
    v_mfma_f32_16x16x32_bf16 v[164:167], v[52:55], a[196:199], v[164:167]
    buffer_load_dwordx4 v20, s[8:11], s31 offen offset:2048 sc1 lds
    v_mfma_f32_16x16x32_bf16 v[164:167], v[56:59], a[200:203], v[164:167]
    v_exp_f32 v173, v173
    v_mfma_f32_16x16x32_bf16 v[164:167], v[60:63], a[204:207], v[164:167]
    ds_read_b64_tr_b16 v[134:135], v13 offset:12288
    v_cvt_pk_bf16_f32 v182, v172, v173
    v_mfma_f32_16x16x32_bf16 a[16:19], v[112:115], v[176:179], 0
    v_exp_f32 v174, v174
    v_mfma_f32_16x16x32_bf16 a[20:23], v[116:119], v[176:179], 0
    buffer_load_dwordx4 v20, s[8:11], s31 offen offset:3072 sc1 lds
    v_mfma_f32_16x16x32_bf16 a[24:27], v[120:123], v[176:179], 0
    v_exp_f32 v175, v175
    v_mfma_f32_16x16x32_bf16 a[28:31], v[124:127], v[176:179], 0
    ds_read_b64_tr_b16 v[136:137], v14 offset:8192
    v_cvt_pk_bf16_f32 v183, v174, v175
    v_mfma_f32_16x16x32_bf16 v[168:171], v[32:35], a[208:211], 0
    s_add_u32 m0, s30, 28672
    v_exp_f32 v160, v160
    v_mfma_f32_16x16x32_bf16 v[168:171], v[36:39], a[212:215], v[168:171]
    buffer_load_dwordx4 v21, s[8:11], s31 offen offset:0 sc1 lds
    v_mfma_f32_16x16x32_bf16 v[168:171], v[40:43], a[216:219], v[168:171]
    v_exp_f32 v161, v161
    v_mfma_f32_16x16x32_bf16 v[168:171], v[44:47], a[220:223], v[168:171]
    ds_read_b64_tr_b16 v[138:139], v14 offset:12288
    v_cvt_pk_bf16_f32 v232, v160, v161
    v_mfma_f32_16x16x32_bf16 a[32:35], v[96:99], v[180:183], 0
    v_exp_f32 v162, v162
    v_mfma_f32_16x16x32_bf16 a[36:39], v[100:103], v[180:183], 0
    buffer_load_dwordx4 v21, s[8:11], s31 offen offset:1024 sc1 lds
    v_mfma_f32_16x16x32_bf16 a[40:43], v[104:107], v[180:183], 0
    v_exp_f32 v163, v163
    v_mfma_f32_16x16x32_bf16 a[44:47], v[108:111], v[180:183], 0
    ds_read_b64_tr_b16 v[140:141], v15 offset:8192
    v_cvt_pk_bf16_f32 v233, v162, v163
    v_mfma_f32_16x16x32_bf16 v[172:175], v[48:51], a[208:211], 0
    v_exp_f32 v164, v164
    v_mfma_f32_16x16x32_bf16 v[172:175], v[52:55], a[212:215], v[172:175]
    buffer_load_dwordx4 v21, s[8:11], s31 offen offset:2048 sc1 lds
    v_mfma_f32_16x16x32_bf16 v[172:175], v[56:59], a[216:219], v[172:175]
    v_exp_f32 v165, v165
    v_mfma_f32_16x16x32_bf16 v[172:175], v[60:63], a[220:223], v[172:175]
    ds_read_b64_tr_b16 v[142:143], v15 offset:12288
    v_cvt_pk_bf16_f32 v234, v164, v165
    v_mfma_f32_16x16x32_bf16 a[48:51], v[112:115], v[180:183], 0
    v_exp_f32 v166, v166
    v_mfma_f32_16x16x32_bf16 a[52:55], v[116:119], v[180:183], 0
    buffer_load_dwordx4 v21, s[8:11], s31 offen offset:3072 sc1 lds
    v_mfma_f32_16x16x32_bf16 a[56:59], v[120:123], v[180:183], 0
    s_add_u32 s31, s31, 8192
    v_exp_f32 v167, v167
    v_mfma_f32_16x16x32_bf16 a[60:63], v[124:127], v[180:183], 0
    ds_read_b64_tr_b16 v[144:145], v16 offset:8192
    v_cvt_pk_bf16_f32 v235, v166, v167
    v_mfma_f32_16x16x32_bf16 v[160:163], v[32:35], a[224:227], 0
    s_add_u32 m0, s30, 0
    v_exp_f32 v168, v168
    v_mfma_f32_16x16x32_bf16 v[160:163], v[36:39], a[228:231], v[160:163]
    buffer_load_dwordx4 v20, s[8:11], s31 offen offset:0 sc1 lds
    v_mfma_f32_16x16x32_bf16 v[160:163], v[40:43], a[232:235], v[160:163]
    v_exp_f32 v169, v169
    v_mfma_f32_16x16x32_bf16 v[160:163], v[44:47], a[236:239], v[160:163]
    ds_read_b64_tr_b16 v[146:147], v16 offset:12288
    v_cvt_pk_bf16_f32 v236, v168, v169
    v_mfma_f32_16x16x32_bf16 a[64:67], v[96:99], v[232:235], 0
    v_exp_f32 v170, v170
    v_mfma_f32_16x16x32_bf16 a[68:71], v[100:103], v[232:235], 0
    buffer_load_dwordx4 v20, s[8:11], s31 offen offset:1024 sc1 lds
    v_mfma_f32_16x16x32_bf16 a[72:75], v[104:107], v[232:235], 0
    v_exp_f32 v171, v171
    v_mfma_f32_16x16x32_bf16 a[76:79], v[108:111], v[232:235], 0
    ds_read_b64_tr_b16 v[148:149], v17 offset:8192
    v_cvt_pk_bf16_f32 v237, v170, v171
    v_mfma_f32_16x16x32_bf16 v[164:167], v[48:51], a[224:227], 0
    v_exp_f32 v172, v172
    v_mfma_f32_16x16x32_bf16 v[164:167], v[52:55], a[228:231], v[164:167]
    buffer_load_dwordx4 v20, s[8:11], s31 offen offset:2048 sc1 lds
    v_mfma_f32_16x16x32_bf16 v[164:167], v[56:59], a[232:235], v[164:167]
    v_exp_f32 v173, v173
    v_mfma_f32_16x16x32_bf16 v[164:167], v[60:63], a[236:239], v[164:167]
    ds_read_b64_tr_b16 v[150:151], v17 offset:12288
    v_cvt_pk_bf16_f32 v238, v172, v173
    v_mfma_f32_16x16x32_bf16 a[80:83], v[112:115], v[232:235], 0
    v_exp_f32 v174, v174
    v_mfma_f32_16x16x32_bf16 a[84:87], v[116:119], v[232:235], 0
    buffer_load_dwordx4 v20, s[8:11], s31 offen offset:3072 sc1 lds
    v_mfma_f32_16x16x32_bf16 a[88:91], v[120:123], v[232:235], 0
    s_waitcnt lgkmcnt(12)
    s_waitcnt vmcnt(12)
    v_exp_f32 v175, v175
    v_mfma_f32_16x16x32_bf16 a[92:95], v[124:127], v[232:235], 0
    ds_read_b64_tr_b16 v[152:153], v18 offset:8192
    v_cvt_pk_bf16_f32 v239, v174, v175
    v_mfma_f32_16x16x32_bf16 v[168:171], v[64:67], a[160:163], 0
    v_exp_f32 v160, v160
    v_mfma_f32_16x16x32_bf16 v[168:171], v[68:71], a[164:167], v[168:171]
    ds_read_b128 v[32:35], v8 offset:16384
    ds_read_b128 v[36:39], v9 offset:16384
    v_mfma_f32_16x16x32_bf16 v[168:171], v[72:75], a[168:171], v[168:171]
    v_exp_f32 v161, v161
    v_mfma_f32_16x16x32_bf16 v[168:171], v[76:79], a[172:175], v[168:171]
    ds_read_b64_tr_b16 v[154:155], v18 offset:12288
    v_cvt_pk_bf16_f32 v176, v160, v161
    v_mfma_f32_16x16x32_bf16 a[96:99], v[96:99], v[236:239], 0
    v_exp_f32 v162, v162
    v_mfma_f32_16x16x32_bf16 a[100:103], v[100:103], v[236:239], 0
    ds_read_b128 v[40:43], v10 offset:16384
    ds_read_b128 v[44:47], v11 offset:16384
    v_mfma_f32_16x16x32_bf16 a[104:107], v[104:107], v[236:239], 0
    v_exp_f32 v163, v163
    v_mfma_f32_16x16x32_bf16 a[108:111], v[108:111], v[236:239], 0
    ds_read_b64_tr_b16 v[156:157], v19 offset:8192
    v_cvt_pk_bf16_f32 v177, v162, v163
    v_mfma_f32_16x16x32_bf16 v[172:175], v[80:83], a[160:163], 0
    v_exp_f32 v164, v164
    v_mfma_f32_16x16x32_bf16 v[172:175], v[84:87], a[164:167], v[172:175]
    ds_read_b128 v[48:51], v8 offset:20480
    ds_read_b128 v[52:55], v9 offset:20480
    v_mfma_f32_16x16x32_bf16 v[172:175], v[88:91], a[168:171], v[172:175]
    v_exp_f32 v165, v165
    v_mfma_f32_16x16x32_bf16 v[172:175], v[92:95], a[172:175], v[172:175]
    ds_read_b64_tr_b16 v[158:159], v19 offset:12288
    v_cvt_pk_bf16_f32 v178, v164, v165
    v_mfma_f32_16x16x32_bf16 a[112:115], v[112:115], v[236:239], 0
    v_exp_f32 v166, v166
    v_mfma_f32_16x16x32_bf16 a[116:119], v[116:119], v[236:239], 0
    ds_read_b128 v[56:59], v10 offset:20480
    ds_read_b128 v[60:63], v11 offset:20480
    v_mfma_f32_16x16x32_bf16 a[120:123], v[120:123], v[236:239], 0
    v_exp_f32 v167, v167
    v_mfma_f32_16x16x32_bf16 a[124:127], v[124:127], v[236:239], 0
    v_cvt_pk_bf16_f32 v179, v166, v167
    s_waitcnt lgkmcnt(6)
    v_mfma_f32_16x16x32_bf16 v[160:163], v[32:35], a[160:163], 0
    v_exp_f32 v168, v168
    v_mfma_f32_16x16x32_bf16 v[160:163], v[36:39], a[164:167], v[160:163]
    v_mfma_f32_16x16x32_bf16 v[160:163], v[40:43], a[168:171], v[160:163]
    v_exp_f32 v169, v169
    v_mfma_f32_16x16x32_bf16 v[160:163], v[44:47], a[172:175], v[160:163]
    v_cvt_pk_bf16_f32 v180, v168, v169
    v_mfma_f32_16x16x32_bf16 a[128:131], v[96:99], v[176:179], 0
    v_exp_f32 v170, v170
    v_mfma_f32_16x16x32_bf16 a[132:135], v[100:103], v[176:179], 0
    v_mfma_f32_16x16x32_bf16 a[136:139], v[104:107], v[176:179], 0
    s_waitcnt lgkmcnt(0)
    v_exp_f32 v171, v171
    v_mfma_f32_16x16x32_bf16 a[140:143], v[108:111], v[176:179], 0
    ds_read_b64_tr_b16 v[96:97], v12 offset:16384
    v_cvt_pk_bf16_f32 v181, v170, v171
    v_mfma_f32_16x16x32_bf16 v[164:167], v[48:51], a[160:163], 0
    v_exp_f32 v172, v172
    v_mfma_f32_16x16x32_bf16 v[164:167], v[52:55], a[164:167], v[164:167]
    ds_read_b64_tr_b16 v[98:99], v12 offset:20480
    ds_read_b64_tr_b16 v[100:101], v13 offset:16384
    v_mfma_f32_16x16x32_bf16 v[164:167], v[56:59], a[168:171], v[164:167]
    v_exp_f32 v173, v173
    v_mfma_f32_16x16x32_bf16 v[164:167], v[60:63], a[172:175], v[164:167]
    ds_read_b64_tr_b16 v[102:103], v13 offset:20480
    v_cvt_pk_bf16_f32 v182, v172, v173
    v_mfma_f32_16x16x32_bf16 a[144:147], v[112:115], v[176:179], 0
    v_exp_f32 v174, v174
    v_mfma_f32_16x16x32_bf16 a[148:151], v[116:119], v[176:179], 0
    ds_read_b64_tr_b16 v[104:105], v14 offset:16384
    ds_read_b64_tr_b16 v[106:107], v14 offset:20480
    v_mfma_f32_16x16x32_bf16 a[152:155], v[120:123], v[176:179], 0
    v_exp_f32 v175, v175
    v_mfma_f32_16x16x32_bf16 a[156:159], v[124:127], v[176:179], 0
    ds_read_b64_tr_b16 v[108:109], v15 offset:16384
    v_cvt_pk_bf16_f32 v183, v174, v175
    v_mfma_f32_16x16x32_bf16 v[168:171], v[64:67], a[176:179], 0
    v_exp_f32 v160, v160
    v_mfma_f32_16x16x32_bf16 v[168:171], v[68:71], a[180:183], v[168:171]
    ds_read_b64_tr_b16 v[110:111], v15 offset:20480
    ds_read_b64_tr_b16 v[112:113], v16 offset:16384
    v_mfma_f32_16x16x32_bf16 v[168:171], v[72:75], a[184:187], v[168:171]
    v_exp_f32 v161, v161
    v_mfma_f32_16x16x32_bf16 v[168:171], v[76:79], a[188:191], v[168:171]
    ds_read_b64_tr_b16 v[114:115], v16 offset:20480
    v_cvt_pk_bf16_f32 v232, v160, v161
    v_exp_f32 v162, v162
    ds_read_b64_tr_b16 v[116:117], v17 offset:16384
    ds_read_b64_tr_b16 v[118:119], v17 offset:20480
    v_exp_f32 v163, v163
    ds_read_b64_tr_b16 v[120:121], v18 offset:16384
    v_cvt_pk_bf16_f32 v233, v162, v163
    v_mfma_f32_16x16x32_bf16 v[172:175], v[80:83], a[176:179], 0
    v_exp_f32 v164, v164
    v_mfma_f32_16x16x32_bf16 v[172:175], v[84:87], a[180:183], v[172:175]
    ds_read_b64_tr_b16 v[122:123], v18 offset:20480
    ds_read_b64_tr_b16 v[124:125], v19 offset:16384
    v_mfma_f32_16x16x32_bf16 v[172:175], v[88:91], a[184:187], v[172:175]
    v_exp_f32 v165, v165
    v_mfma_f32_16x16x32_bf16 v[172:175], v[92:95], a[188:191], v[172:175]
    ds_read_b64_tr_b16 v[126:127], v19 offset:20480
    v_cvt_pk_bf16_f32 v234, v164, v165
    v_exp_f32 v166, v166
    v_exp_f32 v167, v167
    s_nop 0
    v_cvt_pk_bf16_f32 v235, v166, v167
    v_mfma_f32_16x16x32_bf16 v[160:163], v[32:35], a[176:179], 0
    s_add_u32 m0, s30, 4096
    v_exp_f32 v168, v168
    v_mfma_f32_16x16x32_bf16 v[160:163], v[36:39], a[180:183], v[160:163]
    buffer_load_dwordx4 v21, s[8:11], s31 offen offset:0 sc1 lds
    v_mfma_f32_16x16x32_bf16 v[160:163], v[40:43], a[184:187], v[160:163]
    s_waitcnt lgkmcnt(12)
    v_exp_f32 v169, v169
    v_mfma_f32_16x16x32_bf16 v[160:163], v[44:47], a[188:191], v[160:163]
    v_cvt_pk_bf16_f32 v236, v168, v169
    v_mfma_f32_16x16x32_bf16 a[0:3], v[128:131], v[180:183], a[0:3]
    v_exp_f32 v170, v170
    v_mfma_f32_16x16x32_bf16 a[0:3], v[96:99], v[232:235], a[0:3]
    buffer_load_dwordx4 v21, s[8:11], s31 offen offset:1024 sc1 lds
    v_mfma_f32_16x16x32_bf16 a[4:7], v[132:135], v[180:183], a[4:7]
    v_exp_f32 v171, v171
    v_mfma_f32_16x16x32_bf16 a[4:7], v[100:103], v[232:235], a[4:7]
    v_cvt_pk_bf16_f32 v237, v170, v171
    v_mfma_f32_16x16x32_bf16 v[164:167], v[48:51], a[176:179], 0
    v_exp_f32 v172, v172
    v_mfma_f32_16x16x32_bf16 v[164:167], v[52:55], a[180:183], v[164:167]
    buffer_load_dwordx4 v21, s[8:11], s31 offen offset:2048 sc1 lds
    v_mfma_f32_16x16x32_bf16 v[164:167], v[56:59], a[184:187], v[164:167]
    s_waitcnt lgkmcnt(8)
    v_exp_f32 v173, v173
    v_mfma_f32_16x16x32_bf16 v[164:167], v[60:63], a[188:191], v[164:167]
    v_cvt_pk_bf16_f32 v238, v172, v173
    v_mfma_f32_16x16x32_bf16 a[8:11], v[136:139], v[180:183], a[8:11]
    v_exp_f32 v174, v174
    v_mfma_f32_16x16x32_bf16 a[8:11], v[104:107], v[232:235], a[8:11]
    buffer_load_dwordx4 v21, s[8:11], s31 offen offset:3072 sc1 lds
    v_mfma_f32_16x16x32_bf16 a[12:15], v[140:143], v[180:183], a[12:15]
    s_add_u32 s31, s31, 8192
    v_exp_f32 v175, v175
    v_mfma_f32_16x16x32_bf16 a[12:15], v[108:111], v[232:235], a[12:15]
    v_cvt_pk_bf16_f32 v239, v174, v175
    v_mfma_f32_16x16x32_bf16 v[168:171], v[64:67], a[192:195], 0
    s_mov_b32 s35, 2555904
    s_mov_b32 m0, s45
    v_exp_f32 v160, v160
    v_mfma_f32_16x16x32_bf16 v[168:171], v[68:71], a[196:199], v[168:171]
    buffer_load_dwordx4 v20, s[8:11], s35 offen offset:0 sc1 lds
    v_mfma_f32_16x16x32_bf16 v[168:171], v[72:75], a[200:203], v[168:171]
    s_waitcnt lgkmcnt(4)
    v_exp_f32 v161, v161
    v_mfma_f32_16x16x32_bf16 v[168:171], v[76:79], a[204:207], v[168:171]
    buffer_load_dwordx4 v20, s[8:11], s35 offen offset:1024 sc1 lds
    v_cvt_pk_bf16_f32 v176, v160, v161
    v_mfma_f32_16x16x32_bf16 a[16:19], v[144:147], v[180:183], a[16:19]
    v_exp_f32 v162, v162
    v_mfma_f32_16x16x32_bf16 a[16:19], v[112:115], v[232:235], a[16:19]
    buffer_load_dwordx4 v20, s[8:11], s35 offen offset:2048 sc1 lds
    v_mfma_f32_16x16x32_bf16 a[20:23], v[148:151], v[180:183], a[20:23]
    v_exp_f32 v163, v163
    v_mfma_f32_16x16x32_bf16 a[20:23], v[116:119], v[232:235], a[20:23]
    buffer_load_dwordx4 v20, s[8:11], s35 offen offset:3072 sc1 lds
    v_cvt_pk_bf16_f32 v177, v162, v163
    v_mfma_f32_16x16x32_bf16 v[172:175], v[80:83], a[192:195], 0
    v_exp_f32 v164, v164
    v_mfma_f32_16x16x32_bf16 v[172:175], v[84:87], a[196:199], v[172:175]
    v_mfma_f32_16x16x32_bf16 v[172:175], v[88:91], a[200:203], v[172:175]
    s_waitcnt lgkmcnt(0)
    v_exp_f32 v165, v165
    v_mfma_f32_16x16x32_bf16 v[172:175], v[92:95], a[204:207], v[172:175]
    v_cvt_pk_bf16_f32 v178, v164, v165
    v_mfma_f32_16x16x32_bf16 a[24:27], v[152:155], v[180:183], a[24:27]
    s_add_u32 m0, s30, 8192
    v_exp_f32 v166, v166
    v_mfma_f32_16x16x32_bf16 a[24:27], v[120:123], v[232:235], a[24:27]
    buffer_load_dwordx4 v20, s[8:11], s31 offen offset:0 sc1 lds
    v_mfma_f32_16x16x32_bf16 a[28:31], v[156:159], v[180:183], a[28:31]
    v_exp_f32 v167, v167
    v_mfma_f32_16x16x32_bf16 a[28:31], v[124:127], v[232:235], a[28:31]
    v_cvt_pk_bf16_f32 v179, v166, v167
    v_mfma_f32_16x16x32_bf16 v[160:163], v[32:35], a[192:195], 0
    v_exp_f32 v168, v168
    v_mfma_f32_16x16x32_bf16 v[160:163], v[36:39], a[196:199], v[160:163]
    buffer_load_dwordx4 v20, s[8:11], s31 offen offset:1024 sc1 lds
    v_mfma_f32_16x16x32_bf16 v[160:163], v[40:43], a[200:203], v[160:163]
    v_exp_f32 v169, v169
    v_mfma_f32_16x16x32_bf16 v[160:163], v[44:47], a[204:207], v[160:163]
    v_cvt_pk_bf16_f32 v180, v168, v169
    v_mfma_f32_16x16x32_bf16 a[32:35], v[128:131], v[236:239], a[32:35]
    v_exp_f32 v170, v170
    v_mfma_f32_16x16x32_bf16 a[32:35], v[96:99], v[176:179], a[32:35]
    buffer_load_dwordx4 v20, s[8:11], s31 offen offset:2048 sc1 lds
    v_mfma_f32_16x16x32_bf16 a[36:39], v[132:135], v[236:239], a[36:39]
    v_exp_f32 v171, v171
    v_mfma_f32_16x16x32_bf16 a[36:39], v[100:103], v[176:179], a[36:39]
    v_cvt_pk_bf16_f32 v181, v170, v171
    v_mfma_f32_16x16x32_bf16 v[164:167], v[48:51], a[192:195], 0
    v_exp_f32 v172, v172
    v_mfma_f32_16x16x32_bf16 v[164:167], v[52:55], a[196:199], v[164:167]
    buffer_load_dwordx4 v20, s[8:11], s31 offen offset:3072 sc1 lds
    v_mfma_f32_16x16x32_bf16 v[164:167], v[56:59], a[200:203], v[164:167]
    v_exp_f32 v173, v173
    v_mfma_f32_16x16x32_bf16 v[164:167], v[60:63], a[204:207], v[164:167]
    v_cvt_pk_bf16_f32 v182, v172, v173
    v_mfma_f32_16x16x32_bf16 a[40:43], v[136:139], v[236:239], a[40:43]
    s_add_u32 m0, s30, 12288
    v_exp_f32 v174, v174
    v_mfma_f32_16x16x32_bf16 a[40:43], v[104:107], v[176:179], a[40:43]
    buffer_load_dwordx4 v21, s[8:11], s31 offen offset:0 sc1 lds
    v_mfma_f32_16x16x32_bf16 a[44:47], v[140:143], v[236:239], a[44:47]
    v_exp_f32 v175, v175
    v_mfma_f32_16x16x32_bf16 a[44:47], v[108:111], v[176:179], a[44:47]
    v_cvt_pk_bf16_f32 v183, v174, v175
    v_mfma_f32_16x16x32_bf16 v[168:171], v[64:67], a[208:211], 0
    v_exp_f32 v160, v160
    v_mfma_f32_16x16x32_bf16 v[168:171], v[68:71], a[212:215], v[168:171]
    buffer_load_dwordx4 v21, s[8:11], s31 offen offset:1024 sc1 lds
    v_mfma_f32_16x16x32_bf16 v[168:171], v[72:75], a[216:219], v[168:171]
    s_waitcnt vmcnt(6)
    v_exp_f32 v161, v161
    v_mfma_f32_16x16x32_bf16 v[168:171], v[76:79], a[220:223], v[168:171]
    ds_read_b128 v[184:187], v244
    v_cvt_pk_bf16_f32 v232, v160, v161
    v_mfma_f32_16x16x32_bf16 a[48:51], v[144:147], v[236:239], a[48:51]
    v_exp_f32 v162, v162
    v_mfma_f32_16x16x32_bf16 a[48:51], v[112:115], v[176:179], a[48:51]
    buffer_load_dwordx4 v21, s[8:11], s31 offen offset:2048 sc1 lds
    v_mfma_f32_16x16x32_bf16 a[52:55], v[148:151], v[236:239], a[52:55]
    v_exp_f32 v163, v163
    v_mfma_f32_16x16x32_bf16 a[52:55], v[116:119], v[176:179], a[52:55]
    ds_read_b128 v[188:191], v245
    v_cvt_pk_bf16_f32 v233, v162, v163
    v_mfma_f32_16x16x32_bf16 v[172:175], v[80:83], a[208:211], 0
    v_exp_f32 v164, v164
    v_mfma_f32_16x16x32_bf16 v[172:175], v[84:87], a[212:215], v[172:175]
    buffer_load_dwordx4 v21, s[8:11], s31 offen offset:3072 sc1 lds
    v_mfma_f32_16x16x32_bf16 v[172:175], v[88:91], a[216:219], v[172:175]
    s_add_u32 s31, s31, 8192
    v_exp_f32 v165, v165
    v_mfma_f32_16x16x32_bf16 v[172:175], v[92:95], a[220:223], v[172:175]
    ds_read_b128 v[192:195], v246
    v_cvt_pk_bf16_f32 v234, v164, v165
    v_mfma_f32_16x16x32_bf16 a[56:59], v[152:155], v[236:239], a[56:59]
    s_add_u32 m0, s30, 16384
    v_exp_f32 v166, v166
    v_mfma_f32_16x16x32_bf16 a[56:59], v[120:123], v[176:179], a[56:59]
    buffer_load_dwordx4 v20, s[8:11], s31 offen offset:0 sc1 lds
    v_mfma_f32_16x16x32_bf16 a[60:63], v[156:159], v[236:239], a[60:63]
    v_exp_f32 v167, v167
    v_mfma_f32_16x16x32_bf16 a[60:63], v[124:127], v[176:179], a[60:63]
    ds_read_b128 v[196:199], v247
    v_cvt_pk_bf16_f32 v235, v166, v167
    v_mfma_f32_16x16x32_bf16 v[160:163], v[32:35], a[208:211], 0
    v_exp_f32 v168, v168
    v_mfma_f32_16x16x32_bf16 v[160:163], v[36:39], a[212:215], v[160:163]
    buffer_load_dwordx4 v20, s[8:11], s31 offen offset:1024 sc1 lds
    v_mfma_f32_16x16x32_bf16 v[160:163], v[40:43], a[216:219], v[160:163]
    v_exp_f32 v169, v169
    v_mfma_f32_16x16x32_bf16 v[160:163], v[44:47], a[220:223], v[160:163]
    ds_read_b64_tr_b16 a[240:241], v248
    v_cvt_pk_bf16_f32 v236, v168, v169
    v_mfma_f32_16x16x32_bf16 a[64:67], v[128:131], v[180:183], a[64:67]
    v_exp_f32 v170, v170
    v_mfma_f32_16x16x32_bf16 a[64:67], v[96:99], v[232:235], a[64:67]
    buffer_load_dwordx4 v20, s[8:11], s31 offen offset:2048 sc1 lds
    v_mfma_f32_16x16x32_bf16 a[68:71], v[132:135], v[180:183], a[68:71]
    v_exp_f32 v171, v171
    v_mfma_f32_16x16x32_bf16 a[68:71], v[100:103], v[232:235], a[68:71]
    ds_read_b64_tr_b16 a[242:243], v249
    v_cvt_pk_bf16_f32 v237, v170, v171
    v_mfma_f32_16x16x32_bf16 v[164:167], v[48:51], a[208:211], 0
    v_exp_f32 v172, v172
    v_mfma_f32_16x16x32_bf16 v[164:167], v[52:55], a[212:215], v[164:167]
    buffer_load_dwordx4 v20, s[8:11], s31 offen offset:3072 sc1 lds
    v_mfma_f32_16x16x32_bf16 v[164:167], v[56:59], a[216:219], v[164:167]
    v_exp_f32 v173, v173
    v_mfma_f32_16x16x32_bf16 v[164:167], v[60:63], a[220:223], v[164:167]
    ds_read_b64_tr_b16 a[244:245], v250
    v_cvt_pk_bf16_f32 v238, v172, v173
    v_mfma_f32_16x16x32_bf16 a[72:75], v[136:139], v[180:183], a[72:75]
    s_add_u32 m0, s30, 20480
    v_exp_f32 v174, v174
    v_mfma_f32_16x16x32_bf16 a[72:75], v[104:107], v[232:235], a[72:75]
    buffer_load_dwordx4 v21, s[8:11], s31 offen offset:0 sc1 lds
    v_mfma_f32_16x16x32_bf16 a[76:79], v[140:143], v[180:183], a[76:79]
    v_exp_f32 v175, v175
    v_mfma_f32_16x16x32_bf16 a[76:79], v[108:111], v[232:235], a[76:79]
    ds_read_b64_tr_b16 a[246:247], v251
    v_cvt_pk_bf16_f32 v239, v174, v175
    s_waitcnt lgkmcnt(4)
    s_cmp_ge_u32 s34, 4
    s_cbranch_scc1 L2_lqf_x
    s_cmp_eq_u32 s34, 0
    s_cbranch_scc1 L2_lqf_0
    s_cmp_eq_u32 s34, 1
    s_cbranch_scc1 L2_lqf_1
    s_cmp_eq_u32 s34, 2
    s_cbranch_scc1 L2_lqf_2
    v_mfma_f32_16x16x32_bf16 v[200:203], v[184:187], a[208:211], 0
    v_mfma_f32_16x16x32_bf16 v[200:203], v[188:191], a[212:215], v[200:203]
    v_mfma_f32_16x16x32_bf16 v[200:203], v[192:195], a[216:219], v[200:203]
    v_mfma_f32_16x16x32_bf16 v[200:203], v[196:199], a[220:223], v[200:203]
    s_branch L2_lqf_x
L2_lqf_2:
    s_nop 4
    v_mfma_f32_16x16x32_bf16 v[200:203], v[184:187], a[192:195], 0
    v_mfma_f32_16x16x32_bf16 v[200:203], v[188:191], a[196:199], v[200:203]
    v_mfma_f32_16x16x32_bf16 v[200:203], v[192:195], a[200:203], v[200:203]
    v_mfma_f32_16x16x32_bf16 v[200:203], v[196:199], a[204:207], v[200:203]
    s_branch L2_lqf_x
L2_lqf_1:
    s_nop 4
    v_mfma_f32_16x16x32_bf16 v[200:203], v[184:187], a[176:179], 0
    v_mfma_f32_16x16x32_bf16 v[200:203], v[188:191], a[180:183], v[200:203]
    v_mfma_f32_16x16x32_bf16 v[200:203], v[192:195], a[184:187], v[200:203]
    v_mfma_f32_16x16x32_bf16 v[200:203], v[196:199], a[188:191], v[200:203]
    s_branch L2_lqf_x
L2_lqf_0:
    s_nop 4
    v_mfma_f32_16x16x32_bf16 v[200:203], v[184:187], a[160:163], 0
    v_mfma_f32_16x16x32_bf16 v[200:203], v[188:191], a[164:167], v[200:203]
    v_mfma_f32_16x16x32_bf16 v[200:203], v[192:195], a[168:171], v[200:203]
    v_mfma_f32_16x16x32_bf16 v[200:203], v[196:199], a[172:175], v[200:203]
L2_lqf_x:
    v_mfma_f32_16x16x32_bf16 v[168:171], v[64:67], a[224:227], 0
    v_exp_f32 v160, v160
    v_mfma_f32_16x16x32_bf16 v[168:171], v[68:71], a[228:231], v[168:171]
    buffer_load_dwordx4 v21, s[8:11], s31 offen offset:1024 sc1 lds
    v_mfma_f32_16x16x32_bf16 v[168:171], v[72:75], a[232:235], v[168:171]
    v_exp_f32 v161, v161
    v_mfma_f32_16x16x32_bf16 v[168:171], v[76:79], a[236:239], v[168:171]
    ds_read_b64_tr_b16 a[248:249], v252
    v_cvt_pk_bf16_f32 v176, v160, v161
    v_mfma_f32_16x16x32_bf16 a[80:83], v[144:147], v[180:183], a[80:83]
    s_waitcnt vmcnt(18)
    v_exp_f32 v162, v162
    v_mfma_f32_16x16x32_bf16 a[80:83], v[112:115], v[232:235], a[80:83]
    buffer_load_dwordx4 v21, s[8:11], s31 offen offset:2048 sc1 lds
    v_mfma_f32_16x16x32_bf16 a[84:87], v[148:151], v[180:183], a[84:87]
    v_exp_f32 v163, v163
    v_mfma_f32_16x16x32_bf16 a[84:87], v[116:119], v[232:235], a[84:87]
    ds_read_b128 v[64:67], v8 offset:24576
    v_cvt_pk_bf16_f32 v177, v162, v163
    v_mfma_f32_16x16x32_bf16 v[172:175], v[80:83], a[224:227], 0
    v_exp_f32 v164, v164
    v_mfma_f32_16x16x32_bf16 v[172:175], v[84:87], a[228:231], v[172:175]
    buffer_load_dwordx4 v21, s[8:11], s31 offen offset:3072 sc1 lds
    v_mfma_f32_16x16x32_bf16 v[172:175], v[88:91], a[232:235], v[172:175]
    s_add_u32 s31, s31, 8192
    v_exp_f32 v165, v165
    v_mfma_f32_16x16x32_bf16 v[172:175], v[92:95], a[236:239], v[172:175]
    ds_read_b128 v[68:71], v9 offset:24576
    v_cvt_pk_bf16_f32 v178, v164, v165
    v_mfma_f32_16x16x32_bf16 a[88:91], v[152:155], v[180:183], a[88:91]
    v_exp_f32 v166, v166
    v_mfma_f32_16x16x32_bf16 a[88:91], v[120:123], v[232:235], a[88:91]
    ds_read_b64_tr_b16 a[250:251], v253
    ds_read_b64_tr_b16 a[252:253], v254
    v_mfma_f32_16x16x32_bf16 a[92:95], v[156:159], v[180:183], a[92:95]
    v_exp_f32 v167, v167
    v_mfma_f32_16x16x32_bf16 a[92:95], v[124:127], v[232:235], a[92:95]
    ds_read_b128 v[72:75], v10 offset:24576
    v_cvt_pk_bf16_f32 v179, v166, v167
    v_mfma_f32_16x16x32_bf16 v[160:163], v[32:35], a[224:227], 0
    v_exp_f32 v168, v168
    v_mfma_f32_16x16x32_bf16 v[160:163], v[36:39], a[228:231], v[160:163]
    ds_read_b128 v[80:83], v8 offset:28672
    ds_read_b128 v[84:87], v9 offset:28672
    v_mfma_f32_16x16x32_bf16 v[160:163], v[40:43], a[232:235], v[160:163]
    v_exp_f32 v169, v169
    v_mfma_f32_16x16x32_bf16 v[160:163], v[44:47], a[236:239], v[160:163]
    ds_read_b128 v[76:79], v11 offset:24576
    v_cvt_pk_bf16_f32 v180, v168, v169
    v_mfma_f32_16x16x32_bf16 a[96:99], v[128:131], v[236:239], a[96:99]
    v_exp_f32 v170, v170
    v_mfma_f32_16x16x32_bf16 a[96:99], v[96:99], v[176:179], a[96:99]
    ds_read_b128 v[88:91], v10 offset:28672
    ds_read_b128 v[92:95], v11 offset:28672
    v_mfma_f32_16x16x32_bf16 a[100:103], v[132:135], v[236:239], a[100:103]
    v_exp_f32 v171, v171
    v_mfma_f32_16x16x32_bf16 a[100:103], v[100:103], v[176:179], a[100:103]
    ds_read_b128 v[32:35], v8 offset:0
    v_cvt_pk_bf16_f32 v181, v170, v171
    v_mfma_f32_16x16x32_bf16 v[164:167], v[48:51], a[224:227], 0
    v_exp_f32 v172, v172
    v_mfma_f32_16x16x32_bf16 v[164:167], v[52:55], a[228:231], v[164:167]
    ds_read_b64_tr_b16 a[254:255], v255
    v_exp_f32 v200, v200
    v_mfma_f32_16x16x32_bf16 v[164:167], v[56:59], a[232:235], v[164:167]
    v_exp_f32 v173, v173
    v_mfma_f32_16x16x32_bf16 v[164:167], v[60:63], a[236:239], v[164:167]
    ds_read_b128 v[36:39], v9 offset:0
    v_cvt_pk_bf16_f32 v182, v172, v173
    v_mfma_f32_16x16x32_bf16 a[104:107], v[136:139], v[236:239], a[104:107]
    v_exp_f32 v174, v174
    v_mfma_f32_16x16x32_bf16 a[104:107], v[104:107], v[176:179], a[104:107]
    v_exp_f32 v201, v201
    v_exp_f32 v202, v202
    v_mfma_f32_16x16x32_bf16 a[108:111], v[140:143], v[236:239], a[108:111]
    s_waitcnt lgkmcnt(5)
    v_exp_f32 v175, v175
    v_mfma_f32_16x16x32_bf16 a[108:111], v[108:111], v[176:179], a[108:111]
    ds_read_b128 v[40:43], v10 offset:0
    v_cvt_pk_bf16_f32 v183, v174, v175
    v_mfma_f32_16x16x32_bf16 v[168:171], v[64:67], a[160:163], 0
    v_exp_f32 v160, v160
    v_mfma_f32_16x16x32_bf16 v[168:171], v[68:71], a[164:167], v[168:171]
    ds_read_b128 v[48:51], v8 offset:4096
    ds_read_b128 v[52:55], v9 offset:4096
    v_exp_f32 v203, v203
    v_mfma_f32_16x16x32_bf16 v[168:171], v[72:75], a[168:171], v[168:171]
    v_exp_f32 v161, v161
    v_mfma_f32_16x16x32_bf16 v[168:171], v[76:79], a[172:175], v[168:171]
    ds_read_b128 v[44:47], v11 offset:0
    v_cvt_pk_bf16_f32 v232, v160, v161
    v_mfma_f32_16x16x32_bf16 a[112:115], v[144:147], v[236:239], a[112:115]
    v_exp_f32 v162, v162
    v_mfma_f32_16x16x32_bf16 a[112:115], v[112:115], v[176:179], a[112:115]
    ds_read_b128 v[56:59], v10 offset:4096
    ds_read_b128 v[60:63], v11 offset:4096
    v_cvt_pk_bf16_f32 v200, v200, v201
    v_cvt_pk_bf16_f32 v201, v202, v203
    v_mfma_f32_16x16x32_bf16 a[116:119], v[148:151], v[236:239], a[116:119]
    s_waitcnt lgkmcnt(9)
    v_exp_f32 v163, v163
    v_mfma_f32_16x16x32_bf16 a[116:119], v[116:119], v[176:179], a[116:119]
    v_cvt_pk_bf16_f32 v233, v162, v163
    v_mfma_f32_16x16x32_bf16 v[172:175], v[80:83], a[160:163], 0
    v_exp_f32 v164, v164
    v_mfma_f32_16x16x32_bf16 v[172:175], v[84:87], a[164:167], v[172:175]
    v_mfma_f32_16x16x32_bf16 v[172:175], v[88:91], a[168:171], v[172:175]
    v_exp_f32 v165, v165
    v_mfma_f32_16x16x32_bf16 v[172:175], v[92:95], a[172:175], v[172:175]
    v_cvt_pk_bf16_f32 v234, v164, v165
    v_mfma_f32_16x16x32_bf16 a[120:123], v[152:155], v[236:239], a[120:123]
    v_exp_f32 v166, v166
    v_mfma_f32_16x16x32_bf16 a[120:123], v[120:123], v[176:179], a[120:123]
    v_mfma_f32_16x16x32_bf16 a[124:127], v[156:159], v[236:239], a[124:127]
    s_waitcnt lgkmcnt(2)
    v_exp_f32 v167, v167
    v_mfma_f32_16x16x32_bf16 a[124:127], v[124:127], v[176:179], a[124:127]
    v_cvt_pk_bf16_f32 v235, v166, v167
    s_waitcnt lgkmcnt(7)
    s_cmp_ge_u32 s34, 4
    s_cbranch_scc1 L2_lvf_x
    s_cmp_eq_u32 s34, 0
    s_cbranch_scc1 L2_lvf_0
    s_cmp_eq_u32 s34, 1
    s_cbranch_scc1 L2_lvf_1
    s_cmp_eq_u32 s34, 2
    s_cbranch_scc1 L2_lvf_2
    v_mfma_f32_16x16x16_bf16 a[96:99], a[240:241], v[200:201], a[96:99]
    v_mfma_f32_16x16x16_bf16 a[100:103], a[242:243], v[200:201], a[100:103]
    v_mfma_f32_16x16x16_bf16 a[104:107], a[244:245], v[200:201], a[104:107]
    v_mfma_f32_16x16x16_bf16 a[108:111], a[246:247], v[200:201], a[108:111]
    v_mfma_f32_16x16x16_bf16 a[112:115], a[248:249], v[200:201], a[112:115]
    v_mfma_f32_16x16x16_bf16 a[116:119], a[250:251], v[200:201], a[116:119]
    v_mfma_f32_16x16x16_bf16 a[120:123], a[252:253], v[200:201], a[120:123]
    v_mfma_f32_16x16x16_bf16 a[124:127], a[254:255], v[200:201], a[124:127]
    s_branch L2_lvf_x
L2_lvf_2:
    v_mfma_f32_16x16x16_bf16 a[64:67], a[240:241], v[200:201], a[64:67]
    v_mfma_f32_16x16x16_bf16 a[68:71], a[242:243], v[200:201], a[68:71]
    v_mfma_f32_16x16x16_bf16 a[72:75], a[244:245], v[200:201], a[72:75]
    v_mfma_f32_16x16x16_bf16 a[76:79], a[246:247], v[200:201], a[76:79]
    v_mfma_f32_16x16x16_bf16 a[80:83], a[248:249], v[200:201], a[80:83]
    v_mfma_f32_16x16x16_bf16 a[84:87], a[250:251], v[200:201], a[84:87]
    v_mfma_f32_16x16x16_bf16 a[88:91], a[252:253], v[200:201], a[88:91]
    v_mfma_f32_16x16x16_bf16 a[92:95], a[254:255], v[200:201], a[92:95]
    s_branch L2_lvf_x
L2_lvf_1:
    v_mfma_f32_16x16x16_bf16 a[32:35], a[240:241], v[200:201], a[32:35]
    v_mfma_f32_16x16x16_bf16 a[36:39], a[242:243], v[200:201], a[36:39]
    v_mfma_f32_16x16x16_bf16 a[40:43], a[244:245], v[200:201], a[40:43]
    v_mfma_f32_16x16x16_bf16 a[44:47], a[246:247], v[200:201], a[44:47]
    v_mfma_f32_16x16x16_bf16 a[48:51], a[248:249], v[200:201], a[48:51]
    v_mfma_f32_16x16x16_bf16 a[52:55], a[250:251], v[200:201], a[52:55]
    v_mfma_f32_16x16x16_bf16 a[56:59], a[252:253], v[200:201], a[56:59]
    v_mfma_f32_16x16x16_bf16 a[60:63], a[254:255], v[200:201], a[60:63]
    s_branch L2_lvf_x
L2_lvf_0:
    v_mfma_f32_16x16x16_bf16 a[0:3], a[240:241], v[200:201], a[0:3]
    v_mfma_f32_16x16x16_bf16 a[4:7], a[242:243], v[200:201], a[4:7]
    v_mfma_f32_16x16x16_bf16 a[8:11], a[244:245], v[200:201], a[8:11]
    v_mfma_f32_16x16x16_bf16 a[12:15], a[246:247], v[200:201], a[12:15]
    v_mfma_f32_16x16x16_bf16 a[16:19], a[248:249], v[200:201], a[16:19]
    v_mfma_f32_16x16x16_bf16 a[20:23], a[250:251], v[200:201], a[20:23]
    v_mfma_f32_16x16x16_bf16 a[24:27], a[252:253], v[200:201], a[24:27]
    v_mfma_f32_16x16x16_bf16 a[28:31], a[254:255], v[200:201], a[28:31]
L2_lvf_x:
.p2align 6
L2_loop_f:
    v_mfma_f32_16x16x32_bf16 v[160:163], v[32:35], a[160:163], 0
    v_exp_f32 v168, v168
    v_mfma_f32_16x16x32_bf16 v[160:163], v[36:39], a[164:167], v[160:163]
    v_mfma_f32_16x16x32_bf16 v[160:163], v[40:43], a[168:171], v[160:163]
    v_exp_f32 v169, v169
    v_mfma_f32_16x16x32_bf16 v[160:163], v[44:47], a[172:175], v[160:163]
    v_cvt_pk_bf16_f32 v236, v168, v169
    v_mfma_f32_16x16x32_bf16 a[128:131], v[128:131], v[180:183], a[128:131]
    v_exp_f32 v170, v170
    v_mfma_f32_16x16x32_bf16 a[128:131], v[96:99], v[232:235], a[128:131]
    v_mfma_f32_16x16x32_bf16 a[132:135], v[132:135], v[180:183], a[132:135]
    s_waitcnt lgkmcnt(0)
    v_exp_f32 v171, v171
    v_mfma_f32_16x16x32_bf16 a[132:135], v[100:103], v[232:235], a[132:135]
    ds_read_b64_tr_b16 v[128:129], v12 offset:24576
    v_cvt_pk_bf16_f32 v237, v170, v171
    v_mfma_f32_16x16x32_bf16 v[164:167], v[48:51], a[160:163], 0
    v_exp_f32 v172, v172
    v_mfma_f32_16x16x32_bf16 v[164:167], v[52:55], a[164:167], v[164:167]
    ds_read_b64_tr_b16 v[130:131], v12 offset:28672
    ds_read_b64_tr_b16 v[96:97], v12 offset:0
    v_mfma_f32_16x16x32_bf16 v[164:167], v[56:59], a[168:171], v[164:167]
    v_exp_f32 v173, v173
    v_mfma_f32_16x16x32_bf16 v[164:167], v[60:63], a[172:175], v[164:167]
    ds_read_b64_tr_b16 v[98:99], v12 offset:4096
    v_cvt_pk_bf16_f32 v238, v172, v173
    v_mfma_f32_16x16x32_bf16 a[136:139], v[136:139], v[180:183], a[136:139]
    v_exp_f32 v174, v174
    v_mfma_f32_16x16x32_bf16 a[136:139], v[104:107], v[232:235], a[136:139]
    ds_read_b64_tr_b16 v[132:133], v13 offset:24576
    ds_read_b64_tr_b16 v[134:135], v13 offset:28672
    v_mfma_f32_16x16x32_bf16 a[140:143], v[140:143], v[180:183], a[140:143]
    v_exp_f32 v175, v175
    v_mfma_f32_16x16x32_bf16 a[140:143], v[108:111], v[232:235], a[140:143]
    ds_read_b64_tr_b16 v[100:101], v13 offset:0
    v_cvt_pk_bf16_f32 v239, v174, v175
    v_mfma_f32_16x16x32_bf16 v[168:171], v[64:67], a[176:179], 0
    v_exp_f32 v160, v160
    v_mfma_f32_16x16x32_bf16 v[168:171], v[68:71], a[180:183], v[168:171]
    ds_read_b64_tr_b16 v[102:103], v13 offset:4096
    ds_read_b64_tr_b16 v[136:137], v14 offset:24576
    v_mfma_f32_16x16x32_bf16 v[168:171], v[72:75], a[184:187], v[168:171]
    v_exp_f32 v161, v161
    v_mfma_f32_16x16x32_bf16 v[168:171], v[76:79], a[188:191], v[168:171]
    ds_read_b64_tr_b16 v[138:139], v14 offset:28672
    v_cvt_pk_bf16_f32 v176, v160, v161
    v_mfma_f32_16x16x32_bf16 a[144:147], v[144:147], v[180:183], a[144:147]
    v_exp_f32 v162, v162
    v_mfma_f32_16x16x32_bf16 a[144:147], v[112:115], v[232:235], a[144:147]
    ds_read_b64_tr_b16 v[104:105], v14 offset:0
    ds_read_b64_tr_b16 v[106:107], v14 offset:4096
    v_mfma_f32_16x16x32_bf16 a[148:151], v[148:151], v[180:183], a[148:151]
    v_exp_f32 v163, v163
    v_mfma_f32_16x16x32_bf16 a[148:151], v[116:119], v[232:235], a[148:151]
    ds_read_b64_tr_b16 v[140:141], v15 offset:24576
    v_cvt_pk_bf16_f32 v177, v162, v163
    v_mfma_f32_16x16x32_bf16 v[172:175], v[80:83], a[176:179], 0
    v_exp_f32 v164, v164
    v_mfma_f32_16x16x32_bf16 v[172:175], v[84:87], a[180:183], v[172:175]
    ds_read_b64_tr_b16 v[142:143], v15 offset:28672
    ds_read_b64_tr_b16 v[108:109], v15 offset:0
    v_mfma_f32_16x16x32_bf16 v[172:175], v[88:91], a[184:187], v[172:175]
    v_exp_f32 v165, v165
    v_mfma_f32_16x16x32_bf16 v[172:175], v[92:95], a[188:191], v[172:175]
    ds_read_b64_tr_b16 v[110:111], v15 offset:4096
    v_cvt_pk_bf16_f32 v178, v164, v165
    v_mfma_f32_16x16x32_bf16 a[152:155], v[152:155], v[180:183], a[152:155]
    v_exp_f32 v166, v166
    v_mfma_f32_16x16x32_bf16 a[152:155], v[120:123], v[232:235], a[152:155]
    ds_read_b64_tr_b16 v[144:145], v16 offset:24576
    ds_read_b64_tr_b16 v[146:147], v16 offset:28672
    v_mfma_f32_16x16x32_bf16 a[156:159], v[156:159], v[180:183], a[156:159]
    v_exp_f32 v167, v167
    v_mfma_f32_16x16x32_bf16 a[156:159], v[124:127], v[232:235], a[156:159]
    ds_read_b64_tr_b16 v[112:113], v16 offset:0
    v_cvt_pk_bf16_f32 v179, v166, v167
    v_mfma_f32_16x16x32_bf16 v[160:163], v[32:35], a[176:179], 0
    v_exp_f32 v168, v168
    v_mfma_f32_16x16x32_bf16 v[160:163], v[36:39], a[180:183], v[160:163]
    ds_read_b64_tr_b16 v[114:115], v16 offset:4096
    ds_read_b64_tr_b16 v[148:149], v17 offset:24576
    v_mfma_f32_16x16x32_bf16 v[160:163], v[40:43], a[184:187], v[160:163]
    s_waitcnt lgkmcnt(13)
    v_exp_f32 v169, v169
    v_mfma_f32_16x16x32_bf16 v[160:163], v[44:47], a[188:191], v[160:163]
    ds_read_b64_tr_b16 v[150:151], v17 offset:28672
    v_cvt_pk_bf16_f32 v180, v168, v169
    v_mfma_f32_16x16x32_bf16 a[0:3], v[128:131], v[236:239], a[0:3]
    v_exp_f32 v170, v170
    v_mfma_f32_16x16x32_bf16 a[0:3], v[96:99], v[176:179], a[0:3]
    ds_read_b64_tr_b16 v[116:117], v17 offset:0
    ds_read_b64_tr_b16 v[118:119], v17 offset:4096
    v_mfma_f32_16x16x32_bf16 a[4:7], v[132:135], v[236:239], a[4:7]
    v_exp_f32 v171, v171
    v_mfma_f32_16x16x32_bf16 a[4:7], v[100:103], v[176:179], a[4:7]
    ds_read_b64_tr_b16 v[152:153], v18 offset:24576
    v_cvt_pk_bf16_f32 v181, v170, v171
    v_mfma_f32_16x16x32_bf16 v[164:167], v[48:51], a[176:179], 0
    v_exp_f32 v172, v172
    v_mfma_f32_16x16x32_bf16 v[164:167], v[52:55], a[180:183], v[164:167]
    ds_read_b64_tr_b16 v[154:155], v18 offset:28672
    ds_read_b64_tr_b16 v[120:121], v18 offset:0
    v_mfma_f32_16x16x32_bf16 v[164:167], v[56:59], a[184:187], v[164:167]
    s_waitcnt lgkmcnt(11)
    v_exp_f32 v173, v173
    v_mfma_f32_16x16x32_bf16 v[164:167], v[60:63], a[188:191], v[164:167]
    ds_read_b64_tr_b16 v[122:123], v18 offset:4096
    v_cvt_pk_bf16_f32 v182, v172, v173
    v_mfma_f32_16x16x32_bf16 a[8:11], v[136:139], v[236:239], a[8:11]
    v_exp_f32 v174, v174
    v_mfma_f32_16x16x32_bf16 a[8:11], v[104:107], v[176:179], a[8:11]
    ds_read_b64_tr_b16 v[156:157], v19 offset:24576
    ds_read_b64_tr_b16 v[158:159], v19 offset:28672
    v_mfma_f32_16x16x32_bf16 a[12:15], v[140:143], v[236:239], a[12:15]
    v_exp_f32 v175, v175
    v_mfma_f32_16x16x32_bf16 a[12:15], v[108:111], v[176:179], a[12:15]
    ds_read_b64_tr_b16 v[124:125], v19 offset:0
    v_cvt_pk_bf16_f32 v183, v174, v175
    v_mfma_f32_16x16x32_bf16 v[168:171], v[64:67], a[192:195], 0
    v_exp_f32 v160, v160
    v_mfma_f32_16x16x32_bf16 v[168:171], v[68:71], a[196:199], v[168:171]
    ds_read_b64_tr_b16 v[126:127], v19 offset:4096
    v_mfma_f32_16x16x32_bf16 v[168:171], v[72:75], a[200:203], v[168:171]
    s_waitcnt lgkmcnt(8)
    v_exp_f32 v161, v161
    v_mfma_f32_16x16x32_bf16 v[168:171], v[76:79], a[204:207], v[168:171]
    v_cvt_pk_bf16_f32 v232, v160, v161
    v_mfma_f32_16x16x32_bf16 a[16:19], v[144:147], v[236:239], a[16:19]
    v_exp_f32 v162, v162
    v_mfma_f32_16x16x32_bf16 a[16:19], v[112:115], v[176:179], a[16:19]
    v_mfma_f32_16x16x32_bf16 a[20:23], v[148:151], v[236:239], a[20:23]
    v_exp_f32 v163, v163
    v_mfma_f32_16x16x32_bf16 a[20:23], v[116:119], v[176:179], a[20:23]
    v_cvt_pk_bf16_f32 v233, v162, v163
    v_mfma_f32_16x16x32_bf16 v[172:175], v[80:83], a[192:195], 0
    v_exp_f32 v164, v164
    v_mfma_f32_16x16x32_bf16 v[172:175], v[84:87], a[196:199], v[172:175]
    v_mfma_f32_16x16x32_bf16 v[172:175], v[88:91], a[200:203], v[172:175]
    s_waitcnt lgkmcnt(0)
    v_exp_f32 v165, v165
    v_mfma_f32_16x16x32_bf16 v[172:175], v[92:95], a[204:207], v[172:175]
    v_cvt_pk_bf16_f32 v234, v164, v165
    v_mfma_f32_16x16x32_bf16 a[24:27], v[152:155], v[236:239], a[24:27]
    s_add_u32 m0, s30, 24576
    v_exp_f32 v166, v166
    v_mfma_f32_16x16x32_bf16 a[24:27], v[120:123], v[176:179], a[24:27]
    buffer_load_dwordx4 v20, s[8:11], s31 offen offset:0 sc1 lds
    v_mfma_f32_16x16x32_bf16 a[28:31], v[156:159], v[236:239], a[28:31]
    v_exp_f32 v167, v167
    v_mfma_f32_16x16x32_bf16 a[28:31], v[124:127], v[176:179], a[28:31]
    v_cvt_pk_bf16_f32 v235, v166, v167
    v_mfma_f32_16x16x32_bf16 v[160:163], v[32:35], a[192:195], 0
    v_exp_f32 v168, v168
    v_mfma_f32_16x16x32_bf16 v[160:163], v[36:39], a[196:199], v[160:163]
    buffer_load_dwordx4 v20, s[8:11], s31 offen offset:1024 sc1 lds
    v_mfma_f32_16x16x32_bf16 v[160:163], v[40:43], a[200:203], v[160:163]
    v_exp_f32 v169, v169
    v_mfma_f32_16x16x32_bf16 v[160:163], v[44:47], a[204:207], v[160:163]
    v_cvt_pk_bf16_f32 v236, v168, v169
    v_mfma_f32_16x16x32_bf16 a[32:35], v[128:131], v[180:183], a[32:35]
    v_exp_f32 v170, v170
    v_mfma_f32_16x16x32_bf16 a[32:35], v[96:99], v[232:235], a[32:35]
    buffer_load_dwordx4 v20, s[8:11], s31 offen offset:2048 sc1 lds
    v_mfma_f32_16x16x32_bf16 a[36:39], v[132:135], v[180:183], a[36:39]
    v_exp_f32 v171, v171
    v_mfma_f32_16x16x32_bf16 a[36:39], v[100:103], v[232:235], a[36:39]
    v_cvt_pk_bf16_f32 v237, v170, v171
    v_mfma_f32_16x16x32_bf16 v[164:167], v[48:51], a[192:195], 0
    v_exp_f32 v172, v172
    v_mfma_f32_16x16x32_bf16 v[164:167], v[52:55], a[196:199], v[164:167]
    buffer_load_dwordx4 v20, s[8:11], s31 offen offset:3072 sc1 lds
    v_mfma_f32_16x16x32_bf16 v[164:167], v[56:59], a[200:203], v[164:167]
    v_exp_f32 v173, v173
    v_mfma_f32_16x16x32_bf16 v[164:167], v[60:63], a[204:207], v[164:167]
    v_cvt_pk_bf16_f32 v238, v172, v173
    v_mfma_f32_16x16x32_bf16 a[40:43], v[136:139], v[180:183], a[40:43]
    s_add_u32 m0, s30, 28672
    v_exp_f32 v174, v174
    v_mfma_f32_16x16x32_bf16 a[40:43], v[104:107], v[232:235], a[40:43]
    buffer_load_dwordx4 v21, s[8:11], s31 offen offset:0 sc1 lds
    v_mfma_f32_16x16x32_bf16 a[44:47], v[140:143], v[180:183], a[44:47]
    v_exp_f32 v175, v175
    v_mfma_f32_16x16x32_bf16 a[44:47], v[108:111], v[232:235], a[44:47]
    v_cvt_pk_bf16_f32 v239, v174, v175
    v_mfma_f32_16x16x32_bf16 v[168:171], v[64:67], a[208:211], 0
    v_exp_f32 v160, v160
    v_mfma_f32_16x16x32_bf16 v[168:171], v[68:71], a[212:215], v[168:171]
    buffer_load_dwordx4 v21, s[8:11], s31 offen offset:1024 sc1 lds
    v_mfma_f32_16x16x32_bf16 v[168:171], v[72:75], a[216:219], v[168:171]
    v_exp_f32 v161, v161
    v_mfma_f32_16x16x32_bf16 v[168:171], v[76:79], a[220:223], v[168:171]
    v_cvt_pk_bf16_f32 v176, v160, v161
    v_mfma_f32_16x16x32_bf16 a[48:51], v[144:147], v[180:183], a[48:51]
    v_exp_f32 v162, v162
    v_mfma_f32_16x16x32_bf16 a[48:51], v[112:115], v[232:235], a[48:51]
    buffer_load_dwordx4 v21, s[8:11], s31 offen offset:2048 sc1 lds
    v_mfma_f32_16x16x32_bf16 a[52:55], v[148:151], v[180:183], a[52:55]
    v_exp_f32 v163, v163
    v_mfma_f32_16x16x32_bf16 a[52:55], v[116:119], v[232:235], a[52:55]
    v_cvt_pk_bf16_f32 v177, v162, v163
    v_mfma_f32_16x16x32_bf16 v[172:175], v[80:83], a[208:211], 0
    v_exp_f32 v164, v164
    v_mfma_f32_16x16x32_bf16 v[172:175], v[84:87], a[212:215], v[172:175]
    buffer_load_dwordx4 v21, s[8:11], s31 offen offset:3072 sc1 lds
    v_mfma_f32_16x16x32_bf16 v[172:175], v[88:91], a[216:219], v[172:175]
    s_add_u32 s31, s31, 8192
    v_exp_f32 v165, v165
    v_mfma_f32_16x16x32_bf16 v[172:175], v[92:95], a[220:223], v[172:175]
    v_cvt_pk_bf16_f32 v178, v164, v165
    v_mfma_f32_16x16x32_bf16 a[56:59], v[152:155], v[180:183], a[56:59]
    s_add_u32 m0, s30, 0
    v_exp_f32 v166, v166
    v_mfma_f32_16x16x32_bf16 a[56:59], v[120:123], v[232:235], a[56:59]
    buffer_load_dwordx4 v20, s[8:11], s31 offen offset:0 sc1 lds
    v_mfma_f32_16x16x32_bf16 a[60:63], v[156:159], v[180:183], a[60:63]
    v_exp_f32 v167, v167
    v_mfma_f32_16x16x32_bf16 a[60:63], v[124:127], v[232:235], a[60:63]
    v_cvt_pk_bf16_f32 v179, v166, v167
    v_mfma_f32_16x16x32_bf16 v[160:163], v[32:35], a[208:211], 0
    v_exp_f32 v168, v168
    v_mfma_f32_16x16x32_bf16 v[160:163], v[36:39], a[212:215], v[160:163]
    buffer_load_dwordx4 v20, s[8:11], s31 offen offset:1024 sc1 lds
    v_mfma_f32_16x16x32_bf16 v[160:163], v[40:43], a[216:219], v[160:163]
    v_exp_f32 v169, v169
    v_mfma_f32_16x16x32_bf16 v[160:163], v[44:47], a[220:223], v[160:163]
    v_cvt_pk_bf16_f32 v180, v168, v169
    v_mfma_f32_16x16x32_bf16 a[64:67], v[128:131], v[236:239], a[64:67]
    v_exp_f32 v170, v170
    v_mfma_f32_16x16x32_bf16 a[64:67], v[96:99], v[176:179], a[64:67]
    buffer_load_dwordx4 v20, s[8:11], s31 offen offset:2048 sc1 lds
    v_mfma_f32_16x16x32_bf16 a[68:71], v[132:135], v[236:239], a[68:71]
    v_exp_f32 v171, v171
    v_mfma_f32_16x16x32_bf16 a[68:71], v[100:103], v[176:179], a[68:71]
    v_cvt_pk_bf16_f32 v181, v170, v171
    v_mfma_f32_16x16x32_bf16 v[164:167], v[48:51], a[208:211], 0
    v_exp_f32 v172, v172
    v_mfma_f32_16x16x32_bf16 v[164:167], v[52:55], a[212:215], v[164:167]
    buffer_load_dwordx4 v20, s[8:11], s31 offen offset:3072 sc1 lds
    v_mfma_f32_16x16x32_bf16 v[164:167], v[56:59], a[216:219], v[164:167]
    v_exp_f32 v173, v173
    v_mfma_f32_16x16x32_bf16 v[164:167], v[60:63], a[220:223], v[164:167]
    v_cvt_pk_bf16_f32 v182, v172, v173
    v_mfma_f32_16x16x32_bf16 a[72:75], v[136:139], v[236:239], a[72:75]
    s_add_u32 m0, s30, 4096
    v_exp_f32 v174, v174
    v_mfma_f32_16x16x32_bf16 a[72:75], v[104:107], v[176:179], a[72:75]
    buffer_load_dwordx4 v21, s[8:11], s31 offen offset:0 sc1 lds
    v_mfma_f32_16x16x32_bf16 a[76:79], v[140:143], v[236:239], a[76:79]
    v_exp_f32 v175, v175
    v_mfma_f32_16x16x32_bf16 a[76:79], v[108:111], v[176:179], a[76:79]
    v_cvt_pk_bf16_f32 v183, v174, v175
    v_mfma_f32_16x16x32_bf16 v[168:171], v[64:67], a[224:227], 0
    v_exp_f32 v160, v160
    v_mfma_f32_16x16x32_bf16 v[168:171], v[68:71], a[228:231], v[168:171]
    buffer_load_dwordx4 v21, s[8:11], s31 offen offset:1024 sc1 lds
    v_mfma_f32_16x16x32_bf16 v[168:171], v[72:75], a[232:235], v[168:171]
    v_exp_f32 v161, v161
    v_mfma_f32_16x16x32_bf16 v[168:171], v[76:79], a[236:239], v[168:171]
    v_cvt_pk_bf16_f32 v232, v160, v161
    v_mfma_f32_16x16x32_bf16 a[80:83], v[144:147], v[236:239], a[80:83]
    s_waitcnt vmcnt(14)
    v_exp_f32 v162, v162
    v_mfma_f32_16x16x32_bf16 a[80:83], v[112:115], v[176:179], a[80:83]
    buffer_load_dwordx4 v21, s[8:11], s31 offen offset:2048 sc1 lds
    v_mfma_f32_16x16x32_bf16 a[84:87], v[148:151], v[236:239], a[84:87]
    v_exp_f32 v163, v163
    v_mfma_f32_16x16x32_bf16 a[84:87], v[116:119], v[176:179], a[84:87]
    ds_read_b128 v[64:67], v8 offset:8192
    v_cvt_pk_bf16_f32 v233, v162, v163
    v_mfma_f32_16x16x32_bf16 v[172:175], v[80:83], a[224:227], 0
    v_exp_f32 v164, v164
    v_mfma_f32_16x16x32_bf16 v[172:175], v[84:87], a[228:231], v[172:175]
    buffer_load_dwordx4 v21, s[8:11], s31 offen offset:3072 sc1 lds
    v_mfma_f32_16x16x32_bf16 v[172:175], v[88:91], a[232:235], v[172:175]
    s_add_u32 s31, s31, 8192
    v_exp_f32 v165, v165
    v_mfma_f32_16x16x32_bf16 v[172:175], v[92:95], a[236:239], v[172:175]
    ds_read_b128 v[68:71], v9 offset:8192
    v_cvt_pk_bf16_f32 v234, v164, v165
    v_mfma_f32_16x16x32_bf16 a[88:91], v[152:155], v[236:239], a[88:91]
    v_exp_f32 v166, v166
    v_mfma_f32_16x16x32_bf16 a[88:91], v[120:123], v[176:179], a[88:91]
    v_mfma_f32_16x16x32_bf16 a[92:95], v[156:159], v[236:239], a[92:95]
    v_exp_f32 v167, v167
    v_mfma_f32_16x16x32_bf16 a[92:95], v[124:127], v[176:179], a[92:95]
    ds_read_b128 v[72:75], v10 offset:8192
    v_cvt_pk_bf16_f32 v235, v166, v167
    v_mfma_f32_16x16x32_bf16 v[160:163], v[32:35], a[224:227], 0
    v_exp_f32 v168, v168
    v_mfma_f32_16x16x32_bf16 v[160:163], v[36:39], a[228:231], v[160:163]
    ds_read_b128 v[80:83], v8 offset:12288
    ds_read_b128 v[84:87], v9 offset:12288
    v_mfma_f32_16x16x32_bf16 v[160:163], v[40:43], a[232:235], v[160:163]
    v_exp_f32 v169, v169
    v_mfma_f32_16x16x32_bf16 v[160:163], v[44:47], a[236:239], v[160:163]
    ds_read_b128 v[76:79], v11 offset:8192
    v_cvt_pk_bf16_f32 v236, v168, v169
    v_mfma_f32_16x16x32_bf16 a[96:99], v[128:131], v[180:183], a[96:99]
    v_exp_f32 v170, v170
    v_mfma_f32_16x16x32_bf16 a[96:99], v[96:99], v[232:235], a[96:99]
    ds_read_b128 v[88:91], v10 offset:12288
    ds_read_b128 v[92:95], v11 offset:12288
    v_mfma_f32_16x16x32_bf16 a[100:103], v[132:135], v[180:183], a[100:103]
    v_exp_f32 v171, v171
    v_mfma_f32_16x16x32_bf16 a[100:103], v[100:103], v[232:235], a[100:103]
    ds_read_b128 v[32:35], v8 offset:16384
    v_cvt_pk_bf16_f32 v237, v170, v171
    v_mfma_f32_16x16x32_bf16 v[164:167], v[48:51], a[224:227], 0
    v_exp_f32 v172, v172
    v_mfma_f32_16x16x32_bf16 v[164:167], v[52:55], a[228:231], v[164:167]
    v_mfma_f32_16x16x32_bf16 v[164:167], v[56:59], a[232:235], v[164:167]
    v_exp_f32 v173, v173
    v_mfma_f32_16x16x32_bf16 v[164:167], v[60:63], a[236:239], v[164:167]
    ds_read_b128 v[36:39], v9 offset:16384
    v_cvt_pk_bf16_f32 v238, v172, v173
    v_mfma_f32_16x16x32_bf16 a[104:107], v[136:139], v[180:183], a[104:107]
    v_exp_f32 v174, v174
    v_mfma_f32_16x16x32_bf16 a[104:107], v[104:107], v[232:235], a[104:107]
    v_mfma_f32_16x16x32_bf16 a[108:111], v[140:143], v[180:183], a[108:111]
    s_waitcnt lgkmcnt(4)
    v_exp_f32 v175, v175
    v_mfma_f32_16x16x32_bf16 a[108:111], v[108:111], v[232:235], a[108:111]
    ds_read_b128 v[40:43], v10 offset:16384
    v_cvt_pk_bf16_f32 v239, v174, v175
    v_mfma_f32_16x16x32_bf16 v[168:171], v[64:67], a[160:163], 0
    v_exp_f32 v160, v160
    v_mfma_f32_16x16x32_bf16 v[168:171], v[68:71], a[164:167], v[168:171]
    ds_read_b128 v[48:51], v8 offset:20480
    ds_read_b128 v[52:55], v9 offset:20480
    v_mfma_f32_16x16x32_bf16 v[168:171], v[72:75], a[168:171], v[168:171]
    v_exp_f32 v161, v161
    v_mfma_f32_16x16x32_bf16 v[168:171], v[76:79], a[172:175], v[168:171]
    ds_read_b128 v[44:47], v11 offset:16384
    v_cvt_pk_bf16_f32 v176, v160, v161
    v_mfma_f32_16x16x32_bf16 a[112:115], v[144:147], v[180:183], a[112:115]
    v_exp_f32 v162, v162
    v_mfma_f32_16x16x32_bf16 a[112:115], v[112:115], v[232:235], a[112:115]
    ds_read_b128 v[56:59], v10 offset:20480
    ds_read_b128 v[60:63], v11 offset:20480
    v_mfma_f32_16x16x32_bf16 a[116:119], v[148:151], v[180:183], a[116:119]
    s_waitcnt lgkmcnt(8)
    v_exp_f32 v163, v163
    v_mfma_f32_16x16x32_bf16 a[116:119], v[116:119], v[232:235], a[116:119]
    v_cvt_pk_bf16_f32 v177, v162, v163
    v_mfma_f32_16x16x32_bf16 v[172:175], v[80:83], a[160:163], 0
    v_exp_f32 v164, v164
    v_mfma_f32_16x16x32_bf16 v[172:175], v[84:87], a[164:167], v[172:175]
    v_mfma_f32_16x16x32_bf16 v[172:175], v[88:91], a[168:171], v[172:175]
    v_exp_f32 v165, v165
    v_mfma_f32_16x16x32_bf16 v[172:175], v[92:95], a[172:175], v[172:175]
    v_cvt_pk_bf16_f32 v178, v164, v165
    v_mfma_f32_16x16x32_bf16 a[120:123], v[152:155], v[180:183], a[120:123]
    v_exp_f32 v166, v166
    v_mfma_f32_16x16x32_bf16 a[120:123], v[120:123], v[232:235], a[120:123]
    v_mfma_f32_16x16x32_bf16 a[124:127], v[156:159], v[180:183], a[124:127]
    s_waitcnt lgkmcnt(2)
    v_exp_f32 v167, v167
    v_mfma_f32_16x16x32_bf16 a[124:127], v[124:127], v[232:235], a[124:127]
    v_cvt_pk_bf16_f32 v179, v166, v167
    v_mfma_f32_16x16x32_bf16 v[160:163], v[32:35], a[160:163], 0
    v_exp_f32 v168, v168
    v_mfma_f32_16x16x32_bf16 v[160:163], v[36:39], a[164:167], v[160:163]
    v_mfma_f32_16x16x32_bf16 v[160:163], v[40:43], a[168:171], v[160:163]
    v_exp_f32 v169, v169
    v_mfma_f32_16x16x32_bf16 v[160:163], v[44:47], a[172:175], v[160:163]
    v_cvt_pk_bf16_f32 v180, v168, v169
    v_mfma_f32_16x16x32_bf16 a[128:131], v[128:131], v[236:239], a[128:131]
    v_exp_f32 v170, v170
    v_mfma_f32_16x16x32_bf16 a[128:131], v[96:99], v[176:179], a[128:131]
    v_mfma_f32_16x16x32_bf16 a[132:135], v[132:135], v[236:239], a[132:135]
    s_waitcnt lgkmcnt(0)
    v_exp_f32 v171, v171
    v_mfma_f32_16x16x32_bf16 a[132:135], v[100:103], v[176:179], a[132:135]
    ds_read_b64_tr_b16 v[128:129], v12 offset:8192
    v_cvt_pk_bf16_f32 v181, v170, v171
    v_mfma_f32_16x16x32_bf16 v[164:167], v[48:51], a[160:163], 0
    v_exp_f32 v172, v172
    v_mfma_f32_16x16x32_bf16 v[164:167], v[52:55], a[164:167], v[164:167]
    ds_read_b64_tr_b16 v[130:131], v12 offset:12288
    ds_read_b64_tr_b16 v[96:97], v12 offset:16384
    v_mfma_f32_16x16x32_bf16 v[164:167], v[56:59], a[168:171], v[164:167]
    v_exp_f32 v173, v173
    v_mfma_f32_16x16x32_bf16 v[164:167], v[60:63], a[172:175], v[164:167]
    ds_read_b64_tr_b16 v[98:99], v12 offset:20480
    v_cvt_pk_bf16_f32 v182, v172, v173
    v_mfma_f32_16x16x32_bf16 a[136:139], v[136:139], v[236:239], a[136:139]
    v_exp_f32 v174, v174
    v_mfma_f32_16x16x32_bf16 a[136:139], v[104:107], v[176:179], a[136:139]
    ds_read_b64_tr_b16 v[132:133], v13 offset:8192
    ds_read_b64_tr_b16 v[134:135], v13 offset:12288
    v_mfma_f32_16x16x32_bf16 a[140:143], v[140:143], v[236:239], a[140:143]
    v_exp_f32 v175, v175
    v_mfma_f32_16x16x32_bf16 a[140:143], v[108:111], v[176:179], a[140:143]
    ds_read_b64_tr_b16 v[100:101], v13 offset:16384
    v_cvt_pk_bf16_f32 v183, v174, v175
    v_mfma_f32_16x16x32_bf16 v[168:171], v[64:67], a[176:179], 0
    v_exp_f32 v160, v160
    v_mfma_f32_16x16x32_bf16 v[168:171], v[68:71], a[180:183], v[168:171]
    ds_read_b64_tr_b16 v[102:103], v13 offset:20480
    ds_read_b64_tr_b16 v[136:137], v14 offset:8192
    v_mfma_f32_16x16x32_bf16 v[168:171], v[72:75], a[184:187], v[168:171]
    v_exp_f32 v161, v161
    v_mfma_f32_16x16x32_bf16 v[168:171], v[76:79], a[188:191], v[168:171]
    ds_read_b64_tr_b16 v[138:139], v14 offset:12288
    v_cvt_pk_bf16_f32 v232, v160, v161
    v_mfma_f32_16x16x32_bf16 a[144:147], v[144:147], v[236:239], a[144:147]
    v_exp_f32 v162, v162
    v_mfma_f32_16x16x32_bf16 a[144:147], v[112:115], v[176:179], a[144:147]
    ds_read_b64_tr_b16 v[104:105], v14 offset:16384
    ds_read_b64_tr_b16 v[106:107], v14 offset:20480
    v_mfma_f32_16x16x32_bf16 a[148:151], v[148:151], v[236:239], a[148:151]
    v_exp_f32 v163, v163
    v_mfma_f32_16x16x32_bf16 a[148:151], v[116:119], v[176:179], a[148:151]
    ds_read_b64_tr_b16 v[140:141], v15 offset:8192
    v_cvt_pk_bf16_f32 v233, v162, v163
    v_mfma_f32_16x16x32_bf16 v[172:175], v[80:83], a[176:179], 0
    v_exp_f32 v164, v164
    v_mfma_f32_16x16x32_bf16 v[172:175], v[84:87], a[180:183], v[172:175]
    ds_read_b64_tr_b16 v[142:143], v15 offset:12288
    ds_read_b64_tr_b16 v[108:109], v15 offset:16384
    v_mfma_f32_16x16x32_bf16 v[172:175], v[88:91], a[184:187], v[172:175]
    v_exp_f32 v165, v165
    v_mfma_f32_16x16x32_bf16 v[172:175], v[92:95], a[188:191], v[172:175]
    ds_read_b64_tr_b16 v[110:111], v15 offset:20480
    v_cvt_pk_bf16_f32 v234, v164, v165
    v_mfma_f32_16x16x32_bf16 a[152:155], v[152:155], v[236:239], a[152:155]
    v_exp_f32 v166, v166
    v_mfma_f32_16x16x32_bf16 a[152:155], v[120:123], v[176:179], a[152:155]
    ds_read_b64_tr_b16 v[144:145], v16 offset:8192
    ds_read_b64_tr_b16 v[146:147], v16 offset:12288
    v_mfma_f32_16x16x32_bf16 a[156:159], v[156:159], v[236:239], a[156:159]
    v_exp_f32 v167, v167
    v_mfma_f32_16x16x32_bf16 a[156:159], v[124:127], v[176:179], a[156:159]
    ds_read_b64_tr_b16 v[112:113], v16 offset:16384
    v_cvt_pk_bf16_f32 v235, v166, v167
    v_mfma_f32_16x16x32_bf16 v[160:163], v[32:35], a[176:179], 0
    v_exp_f32 v168, v168
    v_mfma_f32_16x16x32_bf16 v[160:163], v[36:39], a[180:183], v[160:163]
    ds_read_b64_tr_b16 v[114:115], v16 offset:20480
    ds_read_b64_tr_b16 v[148:149], v17 offset:8192
    v_mfma_f32_16x16x32_bf16 v[160:163], v[40:43], a[184:187], v[160:163]
    s_waitcnt lgkmcnt(13)
    v_exp_f32 v169, v169
    v_mfma_f32_16x16x32_bf16 v[160:163], v[44:47], a[188:191], v[160:163]
    ds_read_b64_tr_b16 v[150:151], v17 offset:12288
    v_cvt_pk_bf16_f32 v236, v168, v169
    v_mfma_f32_16x16x32_bf16 a[0:3], v[128:131], v[180:183], a[0:3]
    v_exp_f32 v170, v170
    v_mfma_f32_16x16x32_bf16 a[0:3], v[96:99], v[232:235], a[0:3]
    ds_read_b64_tr_b16 v[116:117], v17 offset:16384
    ds_read_b64_tr_b16 v[118:119], v17 offset:20480
    v_mfma_f32_16x16x32_bf16 a[4:7], v[132:135], v[180:183], a[4:7]
    v_exp_f32 v171, v171
    v_mfma_f32_16x16x32_bf16 a[4:7], v[100:103], v[232:235], a[4:7]
    ds_read_b64_tr_b16 v[152:153], v18 offset:8192
    v_cvt_pk_bf16_f32 v237, v170, v171
    v_mfma_f32_16x16x32_bf16 v[164:167], v[48:51], a[176:179], 0
    v_exp_f32 v172, v172
    v_mfma_f32_16x16x32_bf16 v[164:167], v[52:55], a[180:183], v[164:167]
    ds_read_b64_tr_b16 v[154:155], v18 offset:12288
    ds_read_b64_tr_b16 v[120:121], v18 offset:16384
    v_mfma_f32_16x16x32_bf16 v[164:167], v[56:59], a[184:187], v[164:167]
    s_waitcnt lgkmcnt(11)
    v_exp_f32 v173, v173
    v_mfma_f32_16x16x32_bf16 v[164:167], v[60:63], a[188:191], v[164:167]
    ds_read_b64_tr_b16 v[122:123], v18 offset:20480
    v_cvt_pk_bf16_f32 v238, v172, v173
    v_mfma_f32_16x16x32_bf16 a[8:11], v[136:139], v[180:183], a[8:11]
    v_exp_f32 v174, v174
    v_mfma_f32_16x16x32_bf16 a[8:11], v[104:107], v[232:235], a[8:11]
    ds_read_b64_tr_b16 v[156:157], v19 offset:8192
    ds_read_b64_tr_b16 v[158:159], v19 offset:12288
    v_mfma_f32_16x16x32_bf16 a[12:15], v[140:143], v[180:183], a[12:15]
    v_exp_f32 v175, v175
    v_mfma_f32_16x16x32_bf16 a[12:15], v[108:111], v[232:235], a[12:15]
    ds_read_b64_tr_b16 v[124:125], v19 offset:16384
    v_cvt_pk_bf16_f32 v239, v174, v175
    v_mfma_f32_16x16x32_bf16 v[168:171], v[64:67], a[192:195], 0
    v_exp_f32 v160, v160
    v_mfma_f32_16x16x32_bf16 v[168:171], v[68:71], a[196:199], v[168:171]
    ds_read_b64_tr_b16 v[126:127], v19 offset:20480
    v_mfma_f32_16x16x32_bf16 v[168:171], v[72:75], a[200:203], v[168:171]
    s_waitcnt lgkmcnt(8)
    v_exp_f32 v161, v161
    v_mfma_f32_16x16x32_bf16 v[168:171], v[76:79], a[204:207], v[168:171]
    v_cvt_pk_bf16_f32 v176, v160, v161
    v_mfma_f32_16x16x32_bf16 a[16:19], v[144:147], v[180:183], a[16:19]
    v_exp_f32 v162, v162
    v_mfma_f32_16x16x32_bf16 a[16:19], v[112:115], v[232:235], a[16:19]
    buffer_load_dwordx4 v[240:243], v22, s[12:15], s58 offen sc1
    v_mfma_f32_16x16x32_bf16 a[20:23], v[148:151], v[180:183], a[20:23]
    v_exp_f32 v163, v163
    v_mfma_f32_16x16x32_bf16 a[20:23], v[116:119], v[232:235], a[20:23]
    v_cvt_pk_bf16_f32 v177, v162, v163
    v_mfma_f32_16x16x32_bf16 v[172:175], v[80:83], a[192:195], 0
    v_exp_f32 v164, v164
    v_mfma_f32_16x16x32_bf16 v[172:175], v[84:87], a[196:199], v[172:175]
    v_mfma_f32_16x16x32_bf16 v[172:175], v[88:91], a[200:203], v[172:175]
    s_waitcnt lgkmcnt(0)
    v_exp_f32 v165, v165
    v_mfma_f32_16x16x32_bf16 v[172:175], v[92:95], a[204:207], v[172:175]
    v_cvt_pk_bf16_f32 v178, v164, v165
    v_mfma_f32_16x16x32_bf16 a[24:27], v[152:155], v[180:183], a[24:27]
    s_add_u32 m0, s30, 8192
    v_exp_f32 v166, v166
    v_mfma_f32_16x16x32_bf16 a[24:27], v[120:123], v[232:235], a[24:27]
    buffer_load_dwordx4 v20, s[8:11], s31 offen offset:0 sc1 lds
    v_mfma_f32_16x16x32_bf16 a[28:31], v[156:159], v[180:183], a[28:31]
    v_exp_f32 v167, v167
    v_mfma_f32_16x16x32_bf16 a[28:31], v[124:127], v[232:235], a[28:31]
    v_cvt_pk_bf16_f32 v179, v166, v167
    v_mfma_f32_16x16x32_bf16 v[160:163], v[32:35], a[192:195], 0
    v_exp_f32 v168, v168
    v_mfma_f32_16x16x32_bf16 v[160:163], v[36:39], a[196:199], v[160:163]
    buffer_load_dwordx4 v20, s[8:11], s31 offen offset:1024 sc1 lds
    v_mfma_f32_16x16x32_bf16 v[160:163], v[40:43], a[200:203], v[160:163]
    v_exp_f32 v169, v169
    v_mfma_f32_16x16x32_bf16 v[160:163], v[44:47], a[204:207], v[160:163]
    v_cvt_pk_bf16_f32 v180, v168, v169
    v_mfma_f32_16x16x32_bf16 a[32:35], v[128:131], v[236:239], a[32:35]
    v_exp_f32 v170, v170
    v_mfma_f32_16x16x32_bf16 a[32:35], v[96:99], v[176:179], a[32:35]
    buffer_load_dwordx4 v20, s[8:11], s31 offen offset:2048 sc1 lds
    v_mfma_f32_16x16x32_bf16 a[36:39], v[132:135], v[236:239], a[36:39]
    v_exp_f32 v171, v171
    v_mfma_f32_16x16x32_bf16 a[36:39], v[100:103], v[176:179], a[36:39]
    v_cvt_pk_bf16_f32 v181, v170, v171
    v_mfma_f32_16x16x32_bf16 v[164:167], v[48:51], a[192:195], 0
    v_exp_f32 v172, v172
    v_mfma_f32_16x16x32_bf16 v[164:167], v[52:55], a[196:199], v[164:167]
    buffer_load_dwordx4 v20, s[8:11], s31 offen offset:3072 sc1 lds
    v_mfma_f32_16x16x32_bf16 v[164:167], v[56:59], a[200:203], v[164:167]
    v_exp_f32 v173, v173
    v_mfma_f32_16x16x32_bf16 v[164:167], v[60:63], a[204:207], v[164:167]
    v_cvt_pk_bf16_f32 v182, v172, v173
    v_mfma_f32_16x16x32_bf16 a[40:43], v[136:139], v[236:239], a[40:43]
    s_add_u32 m0, s30, 12288
    v_exp_f32 v174, v174
    v_mfma_f32_16x16x32_bf16 a[40:43], v[104:107], v[176:179], a[40:43]
    buffer_load_dwordx4 v21, s[8:11], s31 offen offset:0 sc1 lds
    v_mfma_f32_16x16x32_bf16 a[44:47], v[140:143], v[236:239], a[44:47]
    v_exp_f32 v175, v175
    v_mfma_f32_16x16x32_bf16 a[44:47], v[108:111], v[176:179], a[44:47]
    v_cvt_pk_bf16_f32 v183, v174, v175
    v_mfma_f32_16x16x32_bf16 v[168:171], v[64:67], a[208:211], 0
    v_exp_f32 v160, v160
    v_mfma_f32_16x16x32_bf16 v[168:171], v[68:71], a[212:215], v[168:171]
    buffer_load_dwordx4 v21, s[8:11], s31 offen offset:1024 sc1 lds
    v_mfma_f32_16x16x32_bf16 v[168:171], v[72:75], a[216:219], v[168:171]
    v_exp_f32 v161, v161
    v_mfma_f32_16x16x32_bf16 v[168:171], v[76:79], a[220:223], v[168:171]
    v_cvt_pk_bf16_f32 v232, v160, v161
    v_mfma_f32_16x16x32_bf16 a[48:51], v[144:147], v[236:239], a[48:51]
    v_exp_f32 v162, v162
    v_mfma_f32_16x16x32_bf16 a[48:51], v[112:115], v[176:179], a[48:51]
    buffer_load_dwordx4 v21, s[8:11], s31 offen offset:2048 sc1 lds
    v_mfma_f32_16x16x32_bf16 a[52:55], v[148:151], v[236:239], a[52:55]
    v_exp_f32 v163, v163
    v_mfma_f32_16x16x32_bf16 a[52:55], v[116:119], v[176:179], a[52:55]
    v_cvt_pk_bf16_f32 v233, v162, v163
    v_mfma_f32_16x16x32_bf16 v[172:175], v[80:83], a[208:211], 0
    v_exp_f32 v164, v164
    v_mfma_f32_16x16x32_bf16 v[172:175], v[84:87], a[212:215], v[172:175]
    buffer_load_dwordx4 v21, s[8:11], s31 offen offset:3072 sc1 lds
    v_mfma_f32_16x16x32_bf16 v[172:175], v[88:91], a[216:219], v[172:175]
    s_add_u32 s31, s31, 8192
    v_exp_f32 v165, v165
    v_mfma_f32_16x16x32_bf16 v[172:175], v[92:95], a[220:223], v[172:175]
    v_cvt_pk_bf16_f32 v234, v164, v165
    v_mfma_f32_16x16x32_bf16 a[56:59], v[152:155], v[236:239], a[56:59]
    s_add_u32 m0, s30, 16384
    v_exp_f32 v166, v166
    v_mfma_f32_16x16x32_bf16 a[56:59], v[120:123], v[176:179], a[56:59]
    buffer_load_dwordx4 v20, s[8:11], s31 offen offset:0 sc1 lds
    v_mfma_f32_16x16x32_bf16 a[60:63], v[156:159], v[236:239], a[60:63]
    v_exp_f32 v167, v167
    v_mfma_f32_16x16x32_bf16 a[60:63], v[124:127], v[176:179], a[60:63]
    v_cvt_pk_bf16_f32 v235, v166, v167
    v_mfma_f32_16x16x32_bf16 v[160:163], v[32:35], a[208:211], 0
    v_exp_f32 v168, v168
    v_mfma_f32_16x16x32_bf16 v[160:163], v[36:39], a[212:215], v[160:163]
    buffer_load_dwordx4 v20, s[8:11], s31 offen offset:1024 sc1 lds
    v_mfma_f32_16x16x32_bf16 v[160:163], v[40:43], a[216:219], v[160:163]
    v_exp_f32 v169, v169
    v_mfma_f32_16x16x32_bf16 v[160:163], v[44:47], a[220:223], v[160:163]
    v_cvt_pk_bf16_f32 v236, v168, v169
    v_mfma_f32_16x16x32_bf16 a[64:67], v[128:131], v[180:183], a[64:67]
    v_exp_f32 v170, v170
    v_mfma_f32_16x16x32_bf16 a[64:67], v[96:99], v[232:235], a[64:67]
    buffer_load_dwordx4 v20, s[8:11], s31 offen offset:2048 sc1 lds
    v_mfma_f32_16x16x32_bf16 a[68:71], v[132:135], v[180:183], a[68:71]
    v_exp_f32 v171, v171
    v_mfma_f32_16x16x32_bf16 a[68:71], v[100:103], v[232:235], a[68:71]
    v_cvt_pk_bf16_f32 v237, v170, v171
    v_mfma_f32_16x16x32_bf16 v[164:167], v[48:51], a[208:211], 0
    v_exp_f32 v172, v172
    v_mfma_f32_16x16x32_bf16 v[164:167], v[52:55], a[212:215], v[164:167]
    buffer_load_dwordx4 v20, s[8:11], s31 offen offset:3072 sc1 lds
    v_mfma_f32_16x16x32_bf16 v[164:167], v[56:59], a[216:219], v[164:167]
    v_exp_f32 v173, v173
    v_mfma_f32_16x16x32_bf16 v[164:167], v[60:63], a[220:223], v[164:167]
    v_cvt_pk_bf16_f32 v238, v172, v173
    v_mfma_f32_16x16x32_bf16 a[72:75], v[136:139], v[180:183], a[72:75]
    s_add_u32 m0, s30, 20480
    v_exp_f32 v174, v174
    v_mfma_f32_16x16x32_bf16 a[72:75], v[104:107], v[232:235], a[72:75]
    buffer_load_dwordx4 v21, s[8:11], s31 offen offset:0 sc1 lds
    v_mfma_f32_16x16x32_bf16 a[76:79], v[140:143], v[180:183], a[76:79]
    v_exp_f32 v175, v175
    v_mfma_f32_16x16x32_bf16 a[76:79], v[108:111], v[232:235], a[76:79]
    v_cvt_pk_bf16_f32 v239, v174, v175
    v_mfma_f32_16x16x32_bf16 v[168:171], v[64:67], a[224:227], 0
    v_exp_f32 v160, v160
    v_mfma_f32_16x16x32_bf16 v[168:171], v[68:71], a[228:231], v[168:171]
    buffer_load_dwordx4 v21, s[8:11], s31 offen offset:1024 sc1 lds
    v_mfma_f32_16x16x32_bf16 v[168:171], v[72:75], a[232:235], v[168:171]
    v_exp_f32 v161, v161
    v_mfma_f32_16x16x32_bf16 v[168:171], v[76:79], a[236:239], v[168:171]
    v_cvt_pk_bf16_f32 v176, v160, v161
    v_mfma_f32_16x16x32_bf16 a[80:83], v[144:147], v[180:183], a[80:83]
    s_waitcnt vmcnt(15)
    v_exp_f32 v162, v162
    v_mfma_f32_16x16x32_bf16 a[80:83], v[112:115], v[232:235], a[80:83]
    buffer_load_dwordx4 v21, s[8:11], s31 offen offset:2048 sc1 lds
    v_mfma_f32_16x16x32_bf16 a[84:87], v[148:151], v[180:183], a[84:87]
    v_exp_f32 v163, v163
    v_mfma_f32_16x16x32_bf16 a[84:87], v[116:119], v[232:235], a[84:87]
    ds_read_b128 v[64:67], v8 offset:24576
    v_cvt_pk_bf16_f32 v177, v162, v163
    v_mfma_f32_16x16x32_bf16 v[172:175], v[80:83], a[224:227], 0
    v_exp_f32 v164, v164
    v_mfma_f32_16x16x32_bf16 v[172:175], v[84:87], a[228:231], v[172:175]
    buffer_load_dwordx4 v21, s[8:11], s31 offen offset:3072 sc1 lds
    v_mfma_f32_16x16x32_bf16 v[172:175], v[88:91], a[232:235], v[172:175]
    s_add_u32 s31, s31, 8192
    v_exp_f32 v165, v165
    v_mfma_f32_16x16x32_bf16 v[172:175], v[92:95], a[236:239], v[172:175]
    ds_read_b128 v[68:71], v9 offset:24576
    v_cvt_pk_bf16_f32 v178, v164, v165
    v_mfma_f32_16x16x32_bf16 a[88:91], v[152:155], v[180:183], a[88:91]
    v_exp_f32 v166, v166
    v_mfma_f32_16x16x32_bf16 a[88:91], v[120:123], v[232:235], a[88:91]
    v_mfma_f32_16x16x32_bf16 a[92:95], v[156:159], v[180:183], a[92:95]
    v_exp_f32 v167, v167
    v_mfma_f32_16x16x32_bf16 a[92:95], v[124:127], v[232:235], a[92:95]
    ds_read_b128 v[72:75], v10 offset:24576
    v_cvt_pk_bf16_f32 v179, v166, v167
    v_mfma_f32_16x16x32_bf16 v[160:163], v[32:35], a[224:227], 0
    v_exp_f32 v168, v168
    v_mfma_f32_16x16x32_bf16 v[160:163], v[36:39], a[228:231], v[160:163]
    ds_read_b128 v[80:83], v8 offset:28672
    ds_read_b128 v[84:87], v9 offset:28672
    v_mfma_f32_16x16x32_bf16 v[160:163], v[40:43], a[232:235], v[160:163]
    v_exp_f32 v169, v169
    v_mfma_f32_16x16x32_bf16 v[160:163], v[44:47], a[236:239], v[160:163]
    ds_read_b128 v[76:79], v11 offset:24576
    v_cvt_pk_bf16_f32 v180, v168, v169
    v_mfma_f32_16x16x32_bf16 a[96:99], v[128:131], v[236:239], a[96:99]
    v_exp_f32 v170, v170
    v_mfma_f32_16x16x32_bf16 a[96:99], v[96:99], v[176:179], a[96:99]
    ds_read_b128 v[88:91], v10 offset:28672
    ds_read_b128 v[92:95], v11 offset:28672
    v_mfma_f32_16x16x32_bf16 a[100:103], v[132:135], v[236:239], a[100:103]
    v_exp_f32 v171, v171
    v_mfma_f32_16x16x32_bf16 a[100:103], v[100:103], v[176:179], a[100:103]
    ds_read_b128 v[32:35], v8 offset:0
    v_cvt_pk_bf16_f32 v181, v170, v171
    v_mfma_f32_16x16x32_bf16 v[164:167], v[48:51], a[224:227], 0
    v_exp_f32 v172, v172
    v_mfma_f32_16x16x32_bf16 v[164:167], v[52:55], a[228:231], v[164:167]
    v_mfma_f32_16x16x32_bf16 v[164:167], v[56:59], a[232:235], v[164:167]
    v_exp_f32 v173, v173
    v_mfma_f32_16x16x32_bf16 v[164:167], v[60:63], a[236:239], v[164:167]
    ds_read_b128 v[36:39], v9 offset:0
    v_cvt_pk_bf16_f32 v182, v172, v173
    v_mfma_f32_16x16x32_bf16 a[104:107], v[136:139], v[236:239], a[104:107]
    v_exp_f32 v174, v174
    v_mfma_f32_16x16x32_bf16 a[104:107], v[104:107], v[176:179], a[104:107]
    v_mfma_f32_16x16x32_bf16 a[108:111], v[140:143], v[236:239], a[108:111]
    s_waitcnt lgkmcnt(4)
    v_exp_f32 v175, v175
    v_mfma_f32_16x16x32_bf16 a[108:111], v[108:111], v[176:179], a[108:111]
    ds_read_b128 v[40:43], v10 offset:0
    v_cvt_pk_bf16_f32 v183, v174, v175
    v_mfma_f32_16x16x32_bf16 v[168:171], v[64:67], a[160:163], 0
    v_exp_f32 v160, v160
    v_mfma_f32_16x16x32_bf16 v[168:171], v[68:71], a[164:167], v[168:171]
    ds_read_b128 v[48:51], v8 offset:4096
    ds_read_b128 v[52:55], v9 offset:4096
    v_mfma_f32_16x16x32_bf16 v[168:171], v[72:75], a[168:171], v[168:171]
    v_exp_f32 v161, v161
    v_mfma_f32_16x16x32_bf16 v[168:171], v[76:79], a[172:175], v[168:171]
    ds_read_b128 v[44:47], v11 offset:0
    v_cvt_pk_bf16_f32 v232, v160, v161
    v_mfma_f32_16x16x32_bf16 a[112:115], v[144:147], v[236:239], a[112:115]
    v_exp_f32 v162, v162
    v_mfma_f32_16x16x32_bf16 a[112:115], v[112:115], v[176:179], a[112:115]
    ds_read_b128 v[56:59], v10 offset:4096
    ds_read_b128 v[60:63], v11 offset:4096
    v_mfma_f32_16x16x32_bf16 a[116:119], v[148:151], v[236:239], a[116:119]
    s_waitcnt lgkmcnt(8)
    v_exp_f32 v163, v163
    v_mfma_f32_16x16x32_bf16 a[116:119], v[116:119], v[176:179], a[116:119]
    v_cvt_pk_bf16_f32 v233, v162, v163
    v_mfma_f32_16x16x32_bf16 v[172:175], v[80:83], a[160:163], 0
    v_exp_f32 v164, v164
    v_mfma_f32_16x16x32_bf16 v[172:175], v[84:87], a[164:167], v[172:175]
    v_mfma_f32_16x16x32_bf16 v[172:175], v[88:91], a[168:171], v[172:175]
    s_sub_u32 s33, s33, 1
    v_exp_f32 v165, v165
    v_mfma_f32_16x16x32_bf16 v[172:175], v[92:95], a[172:175], v[172:175]
    v_cvt_pk_bf16_f32 v234, v164, v165
    v_mfma_f32_16x16x32_bf16 a[120:123], v[152:155], v[236:239], a[120:123]
    s_cmp_lg_u32 s33, 0
    v_exp_f32 v166, v166
    v_mfma_f32_16x16x32_bf16 a[120:123], v[120:123], v[176:179], a[120:123]
    v_mfma_f32_16x16x32_bf16 a[124:127], v[156:159], v[236:239], a[124:127]
    s_waitcnt lgkmcnt(2)
    v_exp_f32 v167, v167
    v_mfma_f32_16x16x32_bf16 a[124:127], v[124:127], v[176:179], a[124:127]
    v_cvt_pk_bf16_f32 v235, v166, v167
    s_cbranch_scc1 L2_loop_f
    s_waitcnt vmcnt(16)
    s_mov_b32 s49, 0x40000
L2_rdy_bf:
    v_xor_b32 v240, s59, v240
    v_xor_b32 v241, s59, v241
    v_xor_b32 v242, s59, v242
    v_xor_b32 v243, s59, v243
    v_or3_b32 v240, v240, v241, v242
    v_or_b32 v240, v240, v243
    v_cmp_ne_u32 vcc, 0, v240
    s_sub_u32 s49, s49, 1
    s_cselect_b64 vcc, 0, vcc
    s_cbranch_vccz L2_go_bf
    buffer_load_dwordx4 v[240:243], v22, s[12:15], s58 offen sc1
    s_waitcnt vmcnt(0)
    s_branch L2_rdy_bf
L2_go_bf:
    v_mfma_f32_16x16x32_bf16 v[160:163], v[32:35], a[160:163], 0
    v_exp_f32 v168, v168
    v_mfma_f32_16x16x32_bf16 v[160:163], v[36:39], a[164:167], v[160:163]
    buffer_load_dword v22, v23, s[12:15], s39 offen sc1
    v_mfma_f32_16x16x32_bf16 v[160:163], v[40:43], a[168:171], v[160:163]
    v_exp_f32 v169, v169
    v_mfma_f32_16x16x32_bf16 v[160:163], v[44:47], a[172:175], v[160:163]
    v_cvt_pk_bf16_f32 v236, v168, v169
    v_mfma_f32_16x16x32_bf16 a[128:131], v[128:131], v[180:183], a[128:131]
    v_exp_f32 v170, v170
    v_mfma_f32_16x16x32_bf16 a[128:131], v[96:99], v[232:235], a[128:131]
    v_add_u32 v250, 1, v0
    v_add_u32 v251, s45, v23
    v_mfma_f32_16x16x32_bf16 a[132:135], v[132:135], v[180:183], a[132:135]
    s_waitcnt lgkmcnt(0)
    v_exp_f32 v171, v171
    v_mfma_f32_16x16x32_bf16 a[132:135], v[100:103], v[232:235], a[132:135]
    ds_read_b64_tr_b16 v[128:129], v12 offset:24576
    v_cvt_pk_bf16_f32 v237, v170, v171
    v_mfma_f32_16x16x32_bf16 v[164:167], v[48:51], a[160:163], 0
    v_exp_f32 v172, v172
    v_mfma_f32_16x16x32_bf16 v[164:167], v[52:55], a[164:167], v[164:167]
    ds_read_b64_tr_b16 v[130:131], v12 offset:28672
    ds_read_b64_tr_b16 v[96:97], v12 offset:0
    v_mfma_f32_16x16x32_bf16 v[164:167], v[56:59], a[168:171], v[164:167]
    v_exp_f32 v173, v173
    v_mfma_f32_16x16x32_bf16 v[164:167], v[60:63], a[172:175], v[164:167]
    ds_read_b64_tr_b16 v[98:99], v12 offset:4096
    v_cvt_pk_bf16_f32 v238, v172, v173
    v_mfma_f32_16x16x32_bf16 a[136:139], v[136:139], v[180:183], a[136:139]
    v_exp_f32 v174, v174
    v_mfma_f32_16x16x32_bf16 a[136:139], v[104:107], v[232:235], a[136:139]
    ds_read_b64_tr_b16 v[132:133], v13 offset:24576
    ds_read_b64_tr_b16 v[134:135], v13 offset:28672
    v_mfma_f32_16x16x32_bf16 a[140:143], v[140:143], v[180:183], a[140:143]
    v_exp_f32 v175, v175
    v_mfma_f32_16x16x32_bf16 a[140:143], v[108:111], v[232:235], a[140:143]
    ds_read_b64_tr_b16 v[100:101], v13 offset:0
    v_cvt_pk_bf16_f32 v239, v174, v175
    v_mfma_f32_16x16x32_bf16 v[168:171], v[64:67], a[176:179], 0
    v_exp_f32 v160, v160
    v_mfma_f32_16x16x32_bf16 v[168:171], v[68:71], a[180:183], v[168:171]
    ds_read_b64_tr_b16 v[102:103], v13 offset:4096
    ds_read_b64_tr_b16 v[136:137], v14 offset:24576
    v_mfma_f32_16x16x32_bf16 v[168:171], v[72:75], a[184:187], v[168:171]
    v_exp_f32 v161, v161
    v_mfma_f32_16x16x32_bf16 v[168:171], v[76:79], a[188:191], v[168:171]
    ds_read_b64_tr_b16 v[138:139], v14 offset:28672
    v_cvt_pk_bf16_f32 v176, v160, v161
    v_mfma_f32_16x16x32_bf16 a[144:147], v[144:147], v[180:183], a[144:147]
    v_exp_f32 v162, v162
    v_mfma_f32_16x16x32_bf16 a[144:147], v[112:115], v[232:235], a[144:147]
    ds_read_b64_tr_b16 v[104:105], v14 offset:0
    ds_read_b64_tr_b16 v[106:107], v14 offset:4096
    v_mfma_f32_16x16x32_bf16 a[148:151], v[148:151], v[180:183], a[148:151]
    v_exp_f32 v163, v163
    v_mfma_f32_16x16x32_bf16 a[148:151], v[116:119], v[232:235], a[148:151]
    ds_read_b64_tr_b16 v[140:141], v15 offset:24576
    v_cvt_pk_bf16_f32 v177, v162, v163
    v_mfma_f32_16x16x32_bf16 v[172:175], v[80:83], a[176:179], 0
    v_exp_f32 v164, v164
    v_mfma_f32_16x16x32_bf16 v[172:175], v[84:87], a[180:183], v[172:175]
    ds_read_b64_tr_b16 v[142:143], v15 offset:28672
    ds_read_b64_tr_b16 v[108:109], v15 offset:0
    v_mfma_f32_16x16x32_bf16 v[172:175], v[88:91], a[184:187], v[172:175]
    v_exp_f32 v165, v165
    v_mfma_f32_16x16x32_bf16 v[172:175], v[92:95], a[188:191], v[172:175]
    ds_read_b64_tr_b16 v[110:111], v15 offset:4096
    v_cvt_pk_bf16_f32 v178, v164, v165
    v_mfma_f32_16x16x32_bf16 a[152:155], v[152:155], v[180:183], a[152:155]
    v_exp_f32 v166, v166
    v_mfma_f32_16x16x32_bf16 a[152:155], v[120:123], v[232:235], a[152:155]
    ds_read_b64_tr_b16 v[144:145], v16 offset:24576
    ds_read_b64_tr_b16 v[146:147], v16 offset:28672
    v_mfma_f32_16x16x32_bf16 a[156:159], v[156:159], v[180:183], a[156:159]
    v_exp_f32 v167, v167
    v_mfma_f32_16x16x32_bf16 a[156:159], v[124:127], v[232:235], a[156:159]
    ds_read_b64_tr_b16 v[112:113], v16 offset:0
    v_cvt_pk_bf16_f32 v179, v166, v167
    v_mfma_f32_16x16x32_bf16 v[160:163], v[32:35], a[176:179], 0
    v_exp_f32 v168, v168
    v_mfma_f32_16x16x32_bf16 v[160:163], v[36:39], a[180:183], v[160:163]
    ds_read_b64_tr_b16 v[114:115], v16 offset:4096
    ds_read_b64_tr_b16 v[148:149], v17 offset:24576
    v_mfma_f32_16x16x32_bf16 v[160:163], v[40:43], a[184:187], v[160:163]
    s_waitcnt lgkmcnt(13)
    v_exp_f32 v169, v169
    v_mfma_f32_16x16x32_bf16 v[160:163], v[44:47], a[188:191], v[160:163]
    ds_read_b64_tr_b16 v[150:151], v17 offset:28672
    v_cvt_pk_bf16_f32 v180, v168, v169
    v_mfma_f32_16x16x32_bf16 a[0:3], v[128:131], v[236:239], a[0:3]
    v_exp_f32 v170, v170
    v_mfma_f32_16x16x32_bf16 a[0:3], v[96:99], v[176:179], a[0:3]
    ds_read_b64_tr_b16 v[116:117], v17 offset:0
    ds_read_b64_tr_b16 v[118:119], v17 offset:4096
    v_mfma_f32_16x16x32_bf16 a[4:7], v[132:135], v[236:239], a[4:7]
    v_exp_f32 v171, v171
    v_mfma_f32_16x16x32_bf16 a[4:7], v[100:103], v[176:179], a[4:7]
    ds_read_b64_tr_b16 v[152:153], v18 offset:24576
    v_cvt_pk_bf16_f32 v181, v170, v171
    v_mfma_f32_16x16x32_bf16 v[164:167], v[48:51], a[176:179], 0
    v_exp_f32 v172, v172
    v_mfma_f32_16x16x32_bf16 v[164:167], v[52:55], a[180:183], v[164:167]
    ds_read_b64_tr_b16 v[154:155], v18 offset:28672
    ds_read_b64_tr_b16 v[120:121], v18 offset:0
    v_mfma_f32_16x16x32_bf16 v[164:167], v[56:59], a[184:187], v[164:167]
    s_waitcnt lgkmcnt(11)
    v_exp_f32 v173, v173
    v_mfma_f32_16x16x32_bf16 v[164:167], v[60:63], a[188:191], v[164:167]
    ds_read_b64_tr_b16 v[122:123], v18 offset:4096
    v_cvt_pk_bf16_f32 v182, v172, v173
    v_mfma_f32_16x16x32_bf16 a[8:11], v[136:139], v[236:239], a[8:11]
    v_exp_f32 v174, v174
    v_mfma_f32_16x16x32_bf16 a[8:11], v[104:107], v[176:179], a[8:11]
    ds_read_b64_tr_b16 v[156:157], v19 offset:24576
    ds_read_b64_tr_b16 v[158:159], v19 offset:28672
    v_mfma_f32_16x16x32_bf16 a[12:15], v[140:143], v[236:239], a[12:15]
    v_exp_f32 v175, v175
    v_mfma_f32_16x16x32_bf16 a[12:15], v[108:111], v[176:179], a[12:15]
    ds_read_b64_tr_b16 v[124:125], v19 offset:0
    v_cvt_pk_bf16_f32 v183, v174, v175
    v_mfma_f32_16x16x32_bf16 v[168:171], v[64:67], a[192:195], 0
    v_exp_f32 v160, v160
    v_mfma_f32_16x16x32_bf16 v[168:171], v[68:71], a[196:199], v[168:171]
    ds_read_b64_tr_b16 v[126:127], v19 offset:4096
    v_mfma_f32_16x16x32_bf16 v[168:171], v[72:75], a[200:203], v[168:171]
    s_waitcnt lgkmcnt(8)
    v_exp_f32 v161, v161
    v_mfma_f32_16x16x32_bf16 v[168:171], v[76:79], a[204:207], v[168:171]
    v_cvt_pk_bf16_f32 v232, v160, v161
    v_mfma_f32_16x16x32_bf16 a[16:19], v[144:147], v[236:239], a[16:19]
    v_exp_f32 v162, v162
    v_mfma_f32_16x16x32_bf16 a[16:19], v[112:115], v[176:179], a[16:19]
    v_mfma_f32_16x16x32_bf16 a[20:23], v[148:151], v[236:239], a[20:23]
    v_exp_f32 v163, v163
    v_mfma_f32_16x16x32_bf16 a[20:23], v[116:119], v[176:179], a[20:23]
    v_cvt_pk_bf16_f32 v233, v162, v163
    v_mfma_f32_16x16x32_bf16 v[172:175], v[80:83], a[192:195], 0
    s_waitcnt vmcnt(0)
    v_exp_f32 v164, v164
    v_mfma_f32_16x16x32_bf16 v[172:175], v[84:87], a[196:199], v[172:175]
    v_readlane_b32 s84, v22, 0
    v_readlane_b32 s85, v22, 1
    v_mfma_f32_16x16x32_bf16 v[172:175], v[88:91], a[200:203], v[172:175]
    s_waitcnt lgkmcnt(0)
    v_exp_f32 v165, v165
    v_mfma_f32_16x16x32_bf16 v[172:175], v[92:95], a[204:207], v[172:175]
    v_readlane_b32 s86, v22, 2
    v_cvt_pk_bf16_f32 v234, v164, v165
    v_mfma_f32_16x16x32_bf16 a[24:27], v[152:155], v[236:239], a[24:27]
    v_exp_f32 v166, v166
    v_mfma_f32_16x16x32_bf16 a[24:27], v[120:123], v[176:179], a[24:27]
    v_readlane_b32 s87, v22, 3
    v_readlane_b32 s88, v22, 4
    v_mfma_f32_16x16x32_bf16 a[28:31], v[156:159], v[236:239], a[28:31]
    v_exp_f32 v167, v167
    v_mfma_f32_16x16x32_bf16 a[28:31], v[124:127], v[176:179], a[28:31]
    v_readlane_b32 s89, v22, 5
    v_cvt_pk_bf16_f32 v235, v166, v167
    v_mfma_f32_16x16x32_bf16 v[160:163], v[32:35], a[192:195], 0
    s_and_b32 s90, s84, 0xffff
    s_lshr_b32 s84, s84, 16
    v_exp_f32 v168, v168
    v_mfma_f32_16x16x32_bf16 v[160:163], v[36:39], a[196:199], v[160:163]
    v_mfma_f32_16x16x32_bf16 v[160:163], v[40:43], a[200:203], v[160:163]
    s_lshl2_add_u32 s90, s90, 2818048
    s_min_u32 s60, s84, 64
    v_exp_f32 v169, v169
    v_mfma_f32_16x16x32_bf16 v[160:163], v[44:47], a[204:207], v[160:163]
    v_cvt_pk_bf16_f32 v236, v168, v169
    v_mfma_f32_16x16x32_bf16 a[32:35], v[128:131], v[180:183], a[32:35]
    s_mov_b32 s46, s60
    s_and_b32 s91, s85, 0xffff
    v_exp_f32 v170, v170
    v_mfma_f32_16x16x32_bf16 a[32:35], v[96:99], v[232:235], a[32:35]
    v_mfma_f32_16x16x32_bf16 a[36:39], v[132:135], v[180:183], a[36:39]
    v_exp_f32 v171, v171
    v_mfma_f32_16x16x32_bf16 a[36:39], v[100:103], v[232:235], a[36:39]
    v_cvt_pk_bf16_f32 v237, v170, v171
    v_mfma_f32_16x16x32_bf16 v[164:167], v[48:51], a[192:195], 0
    s_lshr_b32 s85, s85, 16
    s_lshl2_add_u32 s91, s91, 2925568
    v_exp_f32 v172, v172
    v_mfma_f32_16x16x32_bf16 v[164:167], v[52:55], a[196:199], v[164:167]
    v_sub_u32 v244, v250, s60 clamp
    v_lshl_add_u32 v192, v244, 26, v23
    v_mfma_f32_16x16x32_bf16 v[164:167], v[56:59], a[200:203], v[164:167]
    s_min_u32 s61, s85, 64
    s_lshl_b32 s42, s46, 2
    v_exp_f32 v173, v173
    v_mfma_f32_16x16x32_bf16 v[164:167], v[60:63], a[204:207], v[164:167]
    v_cvt_pk_bf16_f32 v238, v172, v173
    v_mfma_f32_16x16x32_bf16 a[40:43], v[136:139], v[180:183], a[40:43]
    s_add_u32 s46, s46, s61
    s_and_b32 s92, s86, 0xffff
    v_exp_f32 v174, v174
    v_mfma_f32_16x16x32_bf16 a[40:43], v[104:107], v[232:235], a[40:43]
    buffer_load_dword v184, v192, s[12:15], s90 offen sc1
    v_mfma_f32_16x16x32_bf16 a[44:47], v[140:143], v[180:183], a[44:47]
    v_exp_f32 v175, v175
    v_mfma_f32_16x16x32_bf16 a[44:47], v[108:111], v[232:235], a[44:47]
    v_cvt_pk_bf16_f32 v239, v174, v175
    v_mfma_f32_16x16x32_bf16 v[168:171], v[64:67], a[208:211], 0
    s_lshr_b32 s86, s86, 16
    s_lshl2_add_u32 s92, s92, 3033088
    v_exp_f32 v160, v160
    v_mfma_f32_16x16x32_bf16 v[168:171], v[68:71], a[212:215], v[168:171]
    v_sub_u32 v245, v250, s61 clamp
    v_lshl_add_u32 v193, v245, 26, v23
    v_mfma_f32_16x16x32_bf16 v[168:171], v[72:75], a[216:219], v[168:171]
    s_min_u32 s62, s86, 64
    s_lshl_b32 s43, s46, 2
    v_exp_f32 v161, v161
    v_mfma_f32_16x16x32_bf16 v[168:171], v[76:79], a[220:223], v[168:171]
    v_cvt_pk_bf16_f32 v176, v160, v161
    v_mfma_f32_16x16x32_bf16 a[48:51], v[144:147], v[180:183], a[48:51]
    s_add_u32 s46, s46, s62
    s_and_b32 s93, s87, 0xffff
    v_exp_f32 v162, v162
    v_mfma_f32_16x16x32_bf16 a[48:51], v[112:115], v[232:235], a[48:51]
    buffer_load_dword v185, v193, s[12:15], s91 offen sc1
    v_mfma_f32_16x16x32_bf16 a[52:55], v[148:151], v[180:183], a[52:55]
    v_exp_f32 v163, v163
    v_mfma_f32_16x16x32_bf16 a[52:55], v[116:119], v[232:235], a[52:55]
    v_cvt_pk_bf16_f32 v177, v162, v163
    v_mfma_f32_16x16x32_bf16 v[172:175], v[80:83], a[208:211], 0
    s_lshr_b32 s87, s87, 16
    s_lshl2_add_u32 s93, s93, 3140608
    v_exp_f32 v164, v164
    v_mfma_f32_16x16x32_bf16 v[172:175], v[84:87], a[212:215], v[172:175]
    v_sub_u32 v246, v250, s62 clamp
    v_lshl_add_u32 v194, v246, 26, v23
    v_mfma_f32_16x16x32_bf16 v[172:175], v[88:91], a[216:219], v[172:175]
    s_min_u32 s63, s87, 64
    s_lshl_b32 s44, s46, 2
    v_exp_f32 v165, v165
    v_mfma_f32_16x16x32_bf16 v[172:175], v[92:95], a[220:223], v[172:175]
    v_cvt_pk_bf16_f32 v178, v164, v165
    v_mfma_f32_16x16x32_bf16 a[56:59], v[152:155], v[180:183], a[56:59]
    s_add_u32 s46, s46, s63
    s_and_b32 s94, s88, 0xffff
    v_exp_f32 v166, v166
    v_mfma_f32_16x16x32_bf16 a[56:59], v[120:123], v[232:235], a[56:59]
    buffer_load_dword v186, v194, s[12:15], s92 offen sc1
    v_mfma_f32_16x16x32_bf16 a[60:63], v[156:159], v[180:183], a[60:63]
    v_exp_f32 v167, v167
    v_mfma_f32_16x16x32_bf16 a[60:63], v[124:127], v[232:235], a[60:63]
    v_cvt_pk_bf16_f32 v179, v166, v167
    v_mfma_f32_16x16x32_bf16 v[160:163], v[32:35], a[208:211], 0
    s_lshr_b32 s88, s88, 16
    s_lshl2_add_u32 s94, s94, 3248128
    v_exp_f32 v168, v168
    v_mfma_f32_16x16x32_bf16 v[160:163], v[36:39], a[212:215], v[160:163]
    v_sub_u32 v247, v250, s63 clamp
    v_lshl_add_u32 v195, v247, 26, v23
    v_mfma_f32_16x16x32_bf16 v[160:163], v[40:43], a[216:219], v[160:163]
    s_min_u32 s50, s88, 64
    s_lshl_b32 s48, s46, 2
    v_exp_f32 v169, v169
    v_mfma_f32_16x16x32_bf16 v[160:163], v[44:47], a[220:223], v[160:163]
    v_cvt_pk_bf16_f32 v180, v168, v169
    v_mfma_f32_16x16x32_bf16 a[64:67], v[128:131], v[236:239], a[64:67]
    s_add_u32 s46, s46, s50
    s_and_b32 s95, s89, 0xffff
    v_exp_f32 v170, v170
    v_mfma_f32_16x16x32_bf16 a[64:67], v[96:99], v[176:179], a[64:67]
    buffer_load_dword v187, v195, s[12:15], s93 offen sc1
    v_mfma_f32_16x16x32_bf16 a[68:71], v[132:135], v[236:239], a[68:71]
    v_exp_f32 v171, v171
    v_mfma_f32_16x16x32_bf16 a[68:71], v[100:103], v[176:179], a[68:71]
    v_cvt_pk_bf16_f32 v181, v170, v171
    v_mfma_f32_16x16x32_bf16 v[164:167], v[48:51], a[208:211], 0
    s_lshr_b32 s89, s89, 16
    s_lshl2_add_u32 s95, s95, 3355648
    v_exp_f32 v172, v172
    v_mfma_f32_16x16x32_bf16 v[164:167], v[52:55], a[212:215], v[164:167]
    v_sub_u32 v248, v250, s50 clamp
    v_lshl_add_u32 v196, v248, 26, v23
    v_mfma_f32_16x16x32_bf16 v[164:167], v[56:59], a[216:219], v[164:167]
    s_min_u32 s51, s89, 64
    s_lshl_b32 s49, s46, 2
    v_exp_f32 v173, v173
    v_mfma_f32_16x16x32_bf16 v[164:167], v[60:63], a[220:223], v[164:167]
    v_cvt_pk_bf16_f32 v182, v172, v173
    v_mfma_f32_16x16x32_bf16 a[72:75], v[136:139], v[236:239], a[72:75]
    s_add_u32 s46, s46, s51
    v_exp_f32 v174, v174
    v_mfma_f32_16x16x32_bf16 a[72:75], v[104:107], v[176:179], a[72:75]
    buffer_load_dword v188, v196, s[12:15], s94 offen sc1
    v_mfma_f32_16x16x32_bf16 a[76:79], v[140:143], v[236:239], a[76:79]
    v_exp_f32 v175, v175
    v_mfma_f32_16x16x32_bf16 a[76:79], v[108:111], v[176:179], a[76:79]
    v_cvt_pk_bf16_f32 v183, v174, v175
    v_mfma_f32_16x16x32_bf16 v[168:171], v[64:67], a[224:227], 0
    v_exp_f32 v160, v160
    v_mfma_f32_16x16x32_bf16 v[168:171], v[68:71], a[228:231], v[168:171]
    v_sub_u32 v249, v250, s51 clamp
    v_lshl_add_u32 v197, v249, 26, v23
    v_mfma_f32_16x16x32_bf16 v[168:171], v[72:75], a[232:235], v[168:171]
    v_exp_f32 v161, v161
    v_mfma_f32_16x16x32_bf16 v[168:171], v[76:79], a[236:239], v[168:171]
    v_cvt_pk_bf16_f32 v232, v160, v161
    v_mfma_f32_16x16x32_bf16 a[80:83], v[144:147], v[236:239], a[80:83]
    s_waitcnt vmcnt(6)
    v_exp_f32 v162, v162
    v_mfma_f32_16x16x32_bf16 a[80:83], v[112:115], v[176:179], a[80:83]
    buffer_load_dword v189, v197, s[12:15], s95 offen sc1
    v_mfma_f32_16x16x32_bf16 a[84:87], v[148:151], v[236:239], a[84:87]
    v_exp_f32 v163, v163
    v_mfma_f32_16x16x32_bf16 a[84:87], v[116:119], v[176:179], a[84:87]
    ds_read_b128 v[64:67], v8 offset:8192
    v_cvt_pk_bf16_f32 v233, v162, v163
    v_mfma_f32_16x16x32_bf16 v[172:175], v[80:83], a[224:227], 0
    v_exp_f32 v164, v164
    v_mfma_f32_16x16x32_bf16 v[172:175], v[84:87], a[228:231], v[172:175]
    v_mfma_f32_16x16x32_bf16 v[172:175], v[88:91], a[232:235], v[172:175]
    v_exp_f32 v165, v165
    v_mfma_f32_16x16x32_bf16 v[172:175], v[92:95], a[236:239], v[172:175]
    ds_read_b128 v[68:71], v9 offset:8192
    v_cvt_pk_bf16_f32 v234, v164, v165
    v_mfma_f32_16x16x32_bf16 a[88:91], v[152:155], v[236:239], a[88:91]
    v_exp_f32 v166, v166
    v_mfma_f32_16x16x32_bf16 a[88:91], v[120:123], v[176:179], a[88:91]
    v_lshl_add_u32 v252, s46, 2, v251
    v_mov_b32 v253, 0x7fffff0f
    v_mfma_f32_16x16x32_bf16 a[92:95], v[156:159], v[236:239], a[92:95]
    v_exp_f32 v167, v167
    v_mfma_f32_16x16x32_bf16 a[92:95], v[124:127], v[176:179], a[92:95]
    ds_read_b128 v[72:75], v10 offset:8192
    v_cvt_pk_bf16_f32 v235, v166, v167
    v_mfma_f32_16x16x32_bf16 v[160:163], v[32:35], a[224:227], 0
    s_add_u32 s6, s40, 32768
    v_exp_f32 v168, v168
    v_mfma_f32_16x16x32_bf16 v[160:163], v[36:39], a[228:231], v[160:163]
    ds_read_b128 v[80:83], v8 offset:12288
    ds_read_b128 v[84:87], v9 offset:12288
    v_mfma_f32_16x16x32_bf16 v[160:163], v[40:43], a[232:235], v[160:163]
    s_mov_b32 s7, 0xfffffff0
    v_exp_f32 v169, v169
    v_mfma_f32_16x16x32_bf16 v[160:163], v[44:47], a[236:239], v[160:163]
    ds_read_b128 v[76:79], v11 offset:8192
    v_cvt_pk_bf16_f32 v236, v168, v169
    v_mfma_f32_16x16x32_bf16 a[96:99], v[128:131], v[180:183], a[96:99]
    s_mov_b32 s52, s8
    v_exp_f32 v170, v170
    v_mfma_f32_16x16x32_bf16 a[96:99], v[96:99], v[232:235], a[96:99]
    ds_read_b128 v[88:91], v10 offset:12288
    ds_read_b128 v[92:95], v11 offset:12288
    v_mfma_f32_16x16x32_bf16 a[100:103], v[132:135], v[180:183], a[100:103]
    s_mov_b32 s53, s9
    v_exp_f32 v171, v171
    v_mfma_f32_16x16x32_bf16 a[100:103], v[100:103], v[232:235], a[100:103]
    ds_read_b128 v[32:35], v8 offset:16384
    v_cvt_pk_bf16_f32 v237, v170, v171
    v_mfma_f32_16x16x32_bf16 v[164:167], v[48:51], a[224:227], 0
    s_mov_b32 s55, 0x00020000
    v_exp_f32 v172, v172
    v_mfma_f32_16x16x32_bf16 v[164:167], v[52:55], a[228:231], v[164:167]
    ds_write_b32 v252, v253
    v_mfma_f32_16x16x32_bf16 v[164:167], v[56:59], a[232:235], v[164:167]
    v_exp_f32 v173, v173
    v_mfma_f32_16x16x32_bf16 v[164:167], v[60:63], a[236:239], v[164:167]
    ds_read_b128 v[36:39], v9 offset:16384
    v_cvt_pk_bf16_f32 v238, v172, v173
    v_mfma_f32_16x16x32_bf16 a[104:107], v[136:139], v[180:183], a[104:107]
    v_exp_f32 v174, v174
    v_mfma_f32_16x16x32_bf16 a[104:107], v[104:107], v[232:235], a[104:107]
    v_mfma_f32_16x16x32_bf16 a[108:111], v[140:143], v[180:183], a[108:111]
    s_waitcnt lgkmcnt(5)
    v_exp_f32 v175, v175
    v_mfma_f32_16x16x32_bf16 a[108:111], v[108:111], v[232:235], a[108:111]
    ds_read_b128 v[40:43], v10 offset:16384
    v_cvt_pk_bf16_f32 v239, v174, v175
    v_mfma_f32_16x16x32_bf16 v[168:171], v[64:67], a[160:163], 0
    v_exp_f32 v160, v160
    v_mfma_f32_16x16x32_bf16 v[168:171], v[68:71], a[164:167], v[168:171]
    ds_read_b128 v[48:51], v8 offset:20480
    ds_read_b128 v[52:55], v9 offset:20480
    v_mfma_f32_16x16x32_bf16 v[168:171], v[72:75], a[168:171], v[168:171]
    v_exp_f32 v161, v161
    v_mfma_f32_16x16x32_bf16 v[168:171], v[76:79], a[172:175], v[168:171]
    ds_read_b128 v[44:47], v11 offset:16384
    v_cvt_pk_bf16_f32 v176, v160, v161
    v_mfma_f32_16x16x32_bf16 a[112:115], v[144:147], v[180:183], a[112:115]
    v_exp_f32 v162, v162
    v_mfma_f32_16x16x32_bf16 a[112:115], v[112:115], v[232:235], a[112:115]
    ds_read_b128 v[56:59], v10 offset:20480
    ds_read_b128 v[60:63], v11 offset:20480
    v_mfma_f32_16x16x32_bf16 a[116:119], v[148:151], v[180:183], a[116:119]
    s_waitcnt lgkmcnt(9)
    v_exp_f32 v163, v163
    v_mfma_f32_16x16x32_bf16 a[116:119], v[116:119], v[232:235], a[116:119]
    v_cvt_pk_bf16_f32 v177, v162, v163
    v_mfma_f32_16x16x32_bf16 v[172:175], v[80:83], a[160:163], 0
    v_exp_f32 v164, v164
    v_mfma_f32_16x16x32_bf16 v[172:175], v[84:87], a[164:167], v[172:175]
    v_mfma_f32_16x16x32_bf16 v[172:175], v[88:91], a[168:171], v[172:175]
    v_exp_f32 v165, v165
    v_mfma_f32_16x16x32_bf16 v[172:175], v[92:95], a[172:175], v[172:175]
    v_cvt_pk_bf16_f32 v178, v164, v165
    v_mfma_f32_16x16x32_bf16 a[120:123], v[152:155], v[180:183], a[120:123]
    v_exp_f32 v166, v166
    v_mfma_f32_16x16x32_bf16 a[120:123], v[120:123], v[232:235], a[120:123]
    v_mfma_f32_16x16x32_bf16 a[124:127], v[156:159], v[180:183], a[124:127]
    s_waitcnt lgkmcnt(2)
    v_exp_f32 v167, v167
    v_mfma_f32_16x16x32_bf16 a[124:127], v[124:127], v[232:235], a[124:127]
    v_cvt_pk_bf16_f32 v179, v166, v167
    v_mfma_f32_16x16x32_bf16 v[160:163], v[32:35], a[160:163], 0
    v_exp_f32 v168, v168
    v_mfma_f32_16x16x32_bf16 v[160:163], v[36:39], a[164:167], v[160:163]
    v_lshrrev_b32 v9, 1, v24
    v_and_b32 v10, 1, v24
    v_mfma_f32_16x16x32_bf16 v[160:163], v[40:43], a[168:171], v[160:163]
    v_exp_f32 v169, v169
    v_mfma_f32_16x16x32_bf16 v[160:163], v[44:47], a[172:175], v[160:163]
    v_xor_b32 v9, v9, v25
    v_cvt_pk_bf16_f32 v180, v168, v169
    v_mfma_f32_16x16x32_bf16 a[128:131], v[128:131], v[236:239], a[128:131]
    v_exp_f32 v170, v170
    v_mfma_f32_16x16x32_bf16 a[128:131], v[96:99], v[176:179], a[128:131]
    v_lshlrev_b32 v10, 4, v10
    v_mfma_f32_16x16x32_bf16 a[132:135], v[132:135], v[236:239], a[132:135]
    s_waitcnt lgkmcnt(0)
    v_exp_f32 v171, v171
    v_mfma_f32_16x16x32_bf16 a[132:135], v[100:103], v[176:179], a[132:135]
    ds_read_b64_tr_b16 v[128:129], v12 offset:8192
    v_cvt_pk_bf16_f32 v181, v170, v171
    v_mfma_f32_16x16x32_bf16 v[164:167], v[48:51], a[160:163], 0
    v_exp_f32 v172, v172
    v_mfma_f32_16x16x32_bf16 v[164:167], v[52:55], a[164:167], v[164:167]
    ds_read_b64_tr_b16 v[130:131], v12 offset:12288
    ds_read_b64_tr_b16 v[96:97], v12 offset:16384
    v_mfma_f32_16x16x32_bf16 v[164:167], v[56:59], a[168:171], v[164:167]
    v_exp_f32 v173, v173
    v_mfma_f32_16x16x32_bf16 v[164:167], v[60:63], a[172:175], v[164:167]
    ds_read_b64_tr_b16 v[98:99], v12 offset:20480
    v_cvt_pk_bf16_f32 v182, v172, v173
    v_mfma_f32_16x16x32_bf16 a[136:139], v[136:139], v[236:239], a[136:139]
    v_exp_f32 v174, v174
    v_mfma_f32_16x16x32_bf16 a[136:139], v[104:107], v[176:179], a[136:139]
    ds_read_b64_tr_b16 v[132:133], v13 offset:8192
    ds_read_b64_tr_b16 v[134:135], v13 offset:12288
    v_mfma_f32_16x16x32_bf16 a[140:143], v[140:143], v[236:239], a[140:143]
    v_exp_f32 v175, v175
    v_mfma_f32_16x16x32_bf16 a[140:143], v[108:111], v[176:179], a[140:143]
    ds_read_b64_tr_b16 v[100:101], v13 offset:16384
    v_cvt_pk_bf16_f32 v183, v174, v175
    v_mfma_f32_16x16x32_bf16 v[168:171], v[64:67], a[176:179], 0
    v_exp_f32 v160, v160
    v_mfma_f32_16x16x32_bf16 v[168:171], v[68:71], a[180:183], v[168:171]
    ds_read_b64_tr_b16 v[102:103], v13 offset:20480
    ds_read_b64_tr_b16 v[136:137], v14 offset:8192
    v_mfma_f32_16x16x32_bf16 v[168:171], v[72:75], a[184:187], v[168:171]
    v_exp_f32 v161, v161
    v_mfma_f32_16x16x32_bf16 v[168:171], v[76:79], a[188:191], v[168:171]
    ds_read_b64_tr_b16 v[138:139], v14 offset:12288
    v_cvt_pk_bf16_f32 v232, v160, v161
    v_mfma_f32_16x16x32_bf16 a[144:147], v[144:147], v[236:239], a[144:147]
    v_exp_f32 v162, v162
    v_mfma_f32_16x16x32_bf16 a[144:147], v[112:115], v[176:179], a[144:147]
    ds_read_b64_tr_b16 v[104:105], v14 offset:16384
    ds_read_b64_tr_b16 v[106:107], v14 offset:20480
    v_mfma_f32_16x16x32_bf16 a[148:151], v[148:151], v[236:239], a[148:151]
    v_exp_f32 v163, v163
    v_mfma_f32_16x16x32_bf16 a[148:151], v[116:119], v[176:179], a[148:151]
    ds_read_b64_tr_b16 v[140:141], v15 offset:8192
    v_cvt_pk_bf16_f32 v233, v162, v163
    v_mfma_f32_16x16x32_bf16 v[172:175], v[80:83], a[176:179], 0
    v_exp_f32 v164, v164
    v_mfma_f32_16x16x32_bf16 v[172:175], v[84:87], a[180:183], v[172:175]
    ds_read_b64_tr_b16 v[142:143], v15 offset:12288
    ds_read_b64_tr_b16 v[108:109], v15 offset:16384
    v_mfma_f32_16x16x32_bf16 v[172:175], v[88:91], a[184:187], v[172:175]
    v_exp_f32 v165, v165
    v_mfma_f32_16x16x32_bf16 v[172:175], v[92:95], a[188:191], v[172:175]
    ds_read_b64_tr_b16 v[110:111], v15 offset:20480
    v_cvt_pk_bf16_f32 v234, v164, v165
    v_mfma_f32_16x16x32_bf16 a[152:155], v[152:155], v[236:239], a[152:155]
    v_exp_f32 v166, v166
    v_mfma_f32_16x16x32_bf16 a[152:155], v[120:123], v[176:179], a[152:155]
    ds_read_b64_tr_b16 v[144:145], v16 offset:8192
    ds_read_b64_tr_b16 v[146:147], v16 offset:12288
    v_mfma_f32_16x16x32_bf16 a[156:159], v[156:159], v[236:239], a[156:159]
    v_exp_f32 v167, v167
    v_mfma_f32_16x16x32_bf16 a[156:159], v[124:127], v[176:179], a[156:159]
    ds_read_b64_tr_b16 v[112:113], v16 offset:16384
    v_cvt_pk_bf16_f32 v235, v166, v167
    v_mfma_f32_16x16x32_bf16 v[160:163], v[32:35], a[176:179], 0
    v_exp_f32 v168, v168
    v_mfma_f32_16x16x32_bf16 v[160:163], v[36:39], a[180:183], v[160:163]
    ds_read_b64_tr_b16 v[114:115], v16 offset:20480
    ds_read_b64_tr_b16 v[148:149], v17 offset:8192
    v_mfma_f32_16x16x32_bf16 v[160:163], v[40:43], a[184:187], v[160:163]
    s_waitcnt lgkmcnt(13)
    v_exp_f32 v169, v169
    v_mfma_f32_16x16x32_bf16 v[160:163], v[44:47], a[188:191], v[160:163]
    ds_read_b64_tr_b16 v[150:151], v17 offset:12288
    v_cvt_pk_bf16_f32 v236, v168, v169
    v_mfma_f32_16x16x32_bf16 a[0:3], v[128:131], v[180:183], a[0:3]
    v_exp_f32 v170, v170
    v_mfma_f32_16x16x32_bf16 a[0:3], v[96:99], v[232:235], a[0:3]
    ds_read_b64_tr_b16 v[116:117], v17 offset:16384
    ds_read_b64_tr_b16 v[118:119], v17 offset:20480
    v_mfma_f32_16x16x32_bf16 a[4:7], v[132:135], v[180:183], a[4:7]
    v_exp_f32 v171, v171
    v_mfma_f32_16x16x32_bf16 a[4:7], v[100:103], v[232:235], a[4:7]
    ds_read_b64_tr_b16 v[152:153], v18 offset:8192
    v_cvt_pk_bf16_f32 v237, v170, v171
    v_mfma_f32_16x16x32_bf16 v[164:167], v[48:51], a[176:179], 0
    v_exp_f32 v172, v172
    v_mfma_f32_16x16x32_bf16 v[164:167], v[52:55], a[180:183], v[164:167]
    ds_read_b64_tr_b16 v[154:155], v18 offset:12288
    ds_read_b64_tr_b16 v[120:121], v18 offset:16384
    v_mfma_f32_16x16x32_bf16 v[164:167], v[56:59], a[184:187], v[164:167]
    s_waitcnt lgkmcnt(11)
    v_exp_f32 v173, v173
    v_mfma_f32_16x16x32_bf16 v[164:167], v[60:63], a[188:191], v[164:167]
    ds_read_b64_tr_b16 v[122:123], v18 offset:20480
    v_cvt_pk_bf16_f32 v238, v172, v173
    v_mfma_f32_16x16x32_bf16 a[8:11], v[136:139], v[180:183], a[8:11]
    v_exp_f32 v174, v174
    v_mfma_f32_16x16x32_bf16 a[8:11], v[104:107], v[232:235], a[8:11]
    ds_read_b64_tr_b16 v[156:157], v19 offset:8192
    ds_read_b64_tr_b16 v[158:159], v19 offset:12288
    v_mfma_f32_16x16x32_bf16 a[12:15], v[140:143], v[180:183], a[12:15]
    v_exp_f32 v175, v175
    v_mfma_f32_16x16x32_bf16 a[12:15], v[108:111], v[232:235], a[12:15]
    ds_read_b64_tr_b16 v[124:125], v19 offset:16384
    v_cvt_pk_bf16_f32 v239, v174, v175
    v_mfma_f32_16x16x32_bf16 v[168:171], v[64:67], a[192:195], 0
    s_waitcnt vmcnt(0)
    v_exp_f32 v160, v160
    v_mfma_f32_16x16x32_bf16 v[168:171], v[68:71], a[196:199], v[168:171]
    ds_read_b64_tr_b16 v[126:127], v19 offset:20480
    v_lshl_add_u32 v244, v244, 18, v251
    v_lshl_or_b32 v9, v9, 5, v10
    v_mfma_f32_16x16x32_bf16 v[168:171], v[72:75], a[200:203], v[168:171]
    s_waitcnt lgkmcnt(8)
    v_exp_f32 v161, v161
    v_mfma_f32_16x16x32_bf16 v[168:171], v[76:79], a[204:207], v[168:171]
    ds_write_b32 v244, v184
    v_lshl_add_u32 v245, v245, 18, v251
    v_cvt_pk_bf16_f32 v176, v160, v161
    v_mfma_f32_16x16x32_bf16 a[16:19], v[144:147], v[180:183], a[16:19]
    v_exp_f32 v162, v162
    v_mfma_f32_16x16x32_bf16 a[16:19], v[112:115], v[232:235], a[16:19]
    v_add_u32 v245, s42, v245
    v_lshl_add_u32 v254, v25, 5, s45
    v_xor_b32 v10, 0x80, v9
    v_mfma_f32_16x16x32_bf16 a[20:23], v[148:151], v[180:183], a[20:23]
    v_exp_f32 v163, v163
    v_mfma_f32_16x16x32_bf16 a[20:23], v[116:119], v[232:235], a[20:23]
    ds_write_b32 v245, v185
    v_lshl_add_u32 v246, v246, 18, v251
    v_cvt_pk_bf16_f32 v177, v162, v163
    v_mfma_f32_16x16x32_bf16 v[172:175], v[80:83], a[192:195], 0
    v_exp_f32 v164, v164
    v_mfma_f32_16x16x32_bf16 v[172:175], v[84:87], a[196:199], v[172:175]
    v_add_u32 v246, s43, v246
    v_mfma_f32_16x16x32_bf16 v[172:175], v[88:91], a[200:203], v[172:175]
    s_waitcnt lgkmcnt(2)
    v_exp_f32 v165, v165
    v_mfma_f32_16x16x32_bf16 v[172:175], v[92:95], a[204:207], v[172:175]
    ds_write_b32 v246, v186
    v_lshl_add_u32 v247, v247, 18, v251
    v_cvt_pk_bf16_f32 v178, v164, v165
    v_mfma_f32_16x16x32_bf16 a[24:27], v[152:155], v[180:183], a[24:27]
    v_exp_f32 v166, v166
    v_mfma_f32_16x16x32_bf16 a[24:27], v[120:123], v[232:235], a[24:27]
    v_add_u32 v247, s44, v247
    v_mfma_f32_16x16x32_bf16 a[28:31], v[156:159], v[180:183], a[28:31]
    v_exp_f32 v167, v167
    v_mfma_f32_16x16x32_bf16 a[28:31], v[124:127], v[232:235], a[28:31]
    ds_write_b32 v247, v187
    v_lshl_add_u32 v248, v248, 18, v251
    v_cvt_pk_bf16_f32 v179, v166, v167
    v_mfma_f32_16x16x32_bf16 v[160:163], v[32:35], a[192:195], 0
    v_exp_f32 v168, v168
    v_mfma_f32_16x16x32_bf16 v[160:163], v[36:39], a[196:199], v[160:163]
    v_add_u32 v248, s48, v248
    v_mfma_f32_16x16x32_bf16 v[160:163], v[40:43], a[200:203], v[160:163]
    v_exp_f32 v169, v169
    v_mfma_f32_16x16x32_bf16 v[160:163], v[44:47], a[204:207], v[160:163]
    ds_write_b32 v248, v188
    v_lshl_add_u32 v249, v249, 18, v251
    v_cvt_pk_bf16_f32 v180, v168, v169
    v_mfma_f32_16x16x32_bf16 a[32:35], v[128:131], v[236:239], a[32:35]
    v_exp_f32 v170, v170
    v_mfma_f32_16x16x32_bf16 a[32:35], v[96:99], v[176:179], a[32:35]
    ds_write_b128 v1, a[8:11] offset:8192
    v_add_u32 v249, s49, v249
    v_mfma_f32_16x16x32_bf16 a[36:39], v[132:135], v[236:239], a[36:39]
    v_exp_f32 v171, v171
    v_mfma_f32_16x16x32_bf16 a[36:39], v[100:103], v[176:179], a[36:39]
    ds_write_b32 v249, v189
    v_cvt_pk_bf16_f32 v181, v170, v171
    v_mfma_f32_16x16x32_bf16 v[164:167], v[48:51], a[192:195], 0
    v_exp_f32 v172, v172
    v_mfma_f32_16x16x32_bf16 v[164:167], v[52:55], a[196:199], v[164:167]
    ds_write_b128 v1, a[12:15] offset:9216
    v_mfma_f32_16x16x32_bf16 v[164:167], v[56:59], a[200:203], v[164:167]
    v_exp_f32 v173, v173
    v_mfma_f32_16x16x32_bf16 v[164:167], v[60:63], a[204:207], v[164:167]
    ds_read_b128 v[192:195], v254
    v_cvt_pk_bf16_f32 v182, v172, v173
    v_mfma_f32_16x16x32_bf16 a[40:43], v[136:139], v[236:239], a[40:43]
    v_exp_f32 v174, v174
    v_mfma_f32_16x16x32_bf16 a[40:43], v[104:107], v[176:179], a[40:43]
    ds_write_b128 v1, a[16:19] offset:10240
    v_mfma_f32_16x16x32_bf16 a[44:47], v[140:143], v[236:239], a[44:47]
    v_exp_f32 v175, v175
    v_mfma_f32_16x16x32_bf16 a[44:47], v[108:111], v[176:179], a[44:47]
    ds_read_b128 v[196:199], v254 offset:16
    v_cvt_pk_bf16_f32 v183, v174, v175
    v_mfma_f32_16x16x32_bf16 v[168:171], v[64:67], a[208:211], 0
    v_exp_f32 v160, v160
    v_mfma_f32_16x16x32_bf16 v[168:171], v[68:71], a[212:215], v[168:171]
    ds_write_b128 v1, a[20:23] offset:11264
    v_mfma_f32_16x16x32_bf16 v[168:171], v[72:75], a[216:219], v[168:171]
    v_exp_f32 v161, v161
    v_mfma_f32_16x16x32_bf16 v[168:171], v[76:79], a[220:223], v[168:171]
    v_cvt_pk_bf16_f32 v232, v160, v161
    v_mfma_f32_16x16x32_bf16 a[48:51], v[144:147], v[236:239], a[48:51]
    s_waitcnt lgkmcnt(1)
    v_exp_f32 v162, v162
    v_mfma_f32_16x16x32_bf16 a[48:51], v[112:115], v[176:179], a[48:51]
    ds_write_b128 v1, a[24:27] offset:12288
    v_mfma_f32_16x16x32_bf16 a[52:55], v[148:151], v[236:239], a[52:55]
    v_exp_f32 v163, v163
    v_mfma_f32_16x16x32_bf16 a[52:55], v[116:119], v[176:179], a[52:55]
    v_bitop3_b32 v192, v192, v9, s7 bitop3:0x28
    v_bitop3_b32 v193, v193, v10, s7 bitop3:0x28
    v_cvt_pk_bf16_f32 v233, v162, v163
    v_mfma_f32_16x16x32_bf16 v[172:175], v[80:83], a[208:211], 0
    v_exp_f32 v164, v164
    v_mfma_f32_16x16x32_bf16 v[172:175], v[84:87], a[212:215], v[172:175]
    ds_write_b128 v1, a[28:31] offset:13312
    v_mfma_f32_16x16x32_bf16 v[172:175], v[88:91], a[216:219], v[172:175]
    v_exp_f32 v165, v165
    v_mfma_f32_16x16x32_bf16 v[172:175], v[92:95], a[220:223], v[172:175]
    v_bitop3_b32 v194, v194, v9, s7 bitop3:0x28
    v_bitop3_b32 v195, v195, v10, s7 bitop3:0x28
    v_cvt_pk_bf16_f32 v234, v164, v165
    v_mfma_f32_16x16x32_bf16 a[56:59], v[152:155], v[236:239], a[56:59]
    v_exp_f32 v166, v166
    v_mfma_f32_16x16x32_bf16 a[56:59], v[120:123], v[176:179], a[56:59]
    buffer_load_dwordx4 a[160:163], v20, s[12:15], s40 offen offset:0 sc1
    v_mfma_f32_16x16x32_bf16 a[60:63], v[156:159], v[236:239], a[60:63]
    v_exp_f32 v167, v167
    v_mfma_f32_16x16x32_bf16 a[60:63], v[124:127], v[176:179], a[60:63]
    v_bitop3_b32 v196, v196, v9, s7 bitop3:0x28
    v_bitop3_b32 v197, v197, v10, s7 bitop3:0x28
    v_cvt_pk_bf16_f32 v235, v166, v167
    v_mfma_f32_16x16x32_bf16 v[160:163], v[32:35], a[208:211], 0
    v_exp_f32 v168, v168
    v_mfma_f32_16x16x32_bf16 v[160:163], v[36:39], a[212:215], v[160:163]
    buffer_load_dwordx4 a[164:167], v20, s[12:15], s40 offen offset:1024 sc1
    v_mfma_f32_16x16x32_bf16 v[160:163], v[40:43], a[216:219], v[160:163]
    v_exp_f32 v169, v169
    v_mfma_f32_16x16x32_bf16 v[160:163], v[44:47], a[220:223], v[160:163]
    v_bitop3_b32 v198, v198, v9, s7 bitop3:0x28
    v_bitop3_b32 v199, v199, v10, s7 bitop3:0x28
    v_cvt_pk_bf16_f32 v236, v168, v169
    v_mfma_f32_16x16x32_bf16 a[64:67], v[128:131], v[180:183], a[64:67]
    v_exp_f32 v170, v170
    v_mfma_f32_16x16x32_bf16 a[64:67], v[96:99], v[232:235], a[64:67]
    ds_write_b128 v1, a[40:43] offset:14336
    buffer_load_dwordx4 a[168:171], v20, s[12:15], s40 offen offset:2048 sc1
    v_mfma_f32_16x16x32_bf16 a[68:71], v[132:135], v[180:183], a[68:71]
    s_cmp_gt_u32 s46, 0
    s_cselect_b32 s54, 2560000, 0
    s_add_u32 m0, s30, 0
    v_exp_f32 v171, v171
    v_mfma_f32_16x16x32_bf16 a[68:71], v[100:103], v[232:235], a[68:71]
    buffer_load_dwordx4 v192, s[52:55], 0 offen sc1 lds
    v_cvt_pk_bf16_f32 v237, v170, v171
    v_mfma_f32_16x16x32_bf16 v[164:167], v[48:51], a[208:211], 0
    v_exp_f32 v172, v172
    v_mfma_f32_16x16x32_bf16 v[164:167], v[52:55], a[212:215], v[164:167]
    ds_write_b128 v1, a[44:47] offset:15360
    buffer_load_dwordx4 a[172:175], v20, s[12:15], s40 offen offset:3072 sc1
    v_mfma_f32_16x16x32_bf16 v[164:167], v[56:59], a[216:219], v[164:167]
    s_add_u32 m0, s30, 1024
    v_exp_f32 v173, v173
    v_mfma_f32_16x16x32_bf16 v[164:167], v[60:63], a[220:223], v[164:167]
    buffer_load_dwordx4 v193, s[52:55], 0 offen sc1 lds
    v_cvt_pk_bf16_f32 v238, v172, v173
    v_mfma_f32_16x16x32_bf16 a[72:75], v[136:139], v[180:183], a[72:75]
    v_exp_f32 v174, v174
    v_mfma_f32_16x16x32_bf16 a[72:75], v[104:107], v[232:235], a[72:75]
    ds_write_b128 v1, a[48:51] offset:16384
    buffer_load_dwordx4 a[176:179], v21, s[12:15], s40 offen offset:0 sc1
    v_mfma_f32_16x16x32_bf16 a[76:79], v[140:143], v[180:183], a[76:79]
    s_add_u32 m0, s30, 2048
    v_exp_f32 v175, v175
    v_mfma_f32_16x16x32_bf16 a[76:79], v[108:111], v[232:235], a[76:79]
    buffer_load_dwordx4 v194, s[52:55], 0 offen sc1 lds
    v_cvt_pk_bf16_f32 v239, v174, v175
    v_mfma_f32_16x16x32_bf16 v[168:171], v[64:67], a[224:227], 0
    v_exp_f32 v160, v160
    v_mfma_f32_16x16x32_bf16 v[168:171], v[68:71], a[228:231], v[168:171]
    ds_write_b128 v1, a[52:55] offset:17408
    buffer_load_dwordx4 a[180:183], v21, s[12:15], s40 offen offset:1024 sc1
    v_mfma_f32_16x16x32_bf16 v[168:171], v[72:75], a[232:235], v[168:171]
    s_add_u32 m0, s30, 3072
    v_exp_f32 v161, v161
    v_mfma_f32_16x16x32_bf16 v[168:171], v[76:79], a[236:239], v[168:171]
    buffer_load_dwordx4 v195, s[52:55], 0 offen sc1 lds
    v_cvt_pk_bf16_f32 v176, v160, v161
    v_mfma_f32_16x16x32_bf16 a[80:83], v[144:147], v[180:183], a[80:83]
    v_exp_f32 v162, v162
    v_mfma_f32_16x16x32_bf16 a[80:83], v[112:115], v[232:235], a[80:83]
    ds_write_b128 v1, a[56:59] offset:18432
    buffer_load_dwordx4 a[184:187], v21, s[12:15], s40 offen offset:2048 sc1
    v_mfma_f32_16x16x32_bf16 a[84:87], v[148:151], v[180:183], a[84:87]
    s_add_u32 m0, s30, 4096
    v_exp_f32 v163, v163
    v_mfma_f32_16x16x32_bf16 a[84:87], v[116:119], v[232:235], a[84:87]
    buffer_load_dwordx4 v196, s[52:55], 0 offen sc1 lds
    v_cvt_pk_bf16_f32 v177, v162, v163
    v_mfma_f32_16x16x32_bf16 v[172:175], v[80:83], a[224:227], 0
    v_exp_f32 v164, v164
    v_mfma_f32_16x16x32_bf16 v[172:175], v[84:87], a[228:231], v[172:175]
    ds_write_b128 v1, a[60:63] offset:19456
    buffer_load_dwordx4 a[188:191], v21, s[12:15], s40 offen offset:3072 sc1
    v_mfma_f32_16x16x32_bf16 v[172:175], v[88:91], a[232:235], v[172:175]
    s_add_u32 m0, s30, 5120
    v_exp_f32 v165, v165
    v_mfma_f32_16x16x32_bf16 v[172:175], v[92:95], a[236:239], v[172:175]
    buffer_load_dwordx4 v197, s[52:55], 0 offen sc1 lds
    v_cvt_pk_bf16_f32 v178, v164, v165
    v_mfma_f32_16x16x32_bf16 a[88:91], v[152:155], v[180:183], a[88:91]
    v_exp_f32 v166, v166
    v_mfma_f32_16x16x32_bf16 a[88:91], v[120:123], v[232:235], a[88:91]
    buffer_load_dwordx4 a[192:195], v20, s[12:15], s6 offen offset:0 sc1
    v_mfma_f32_16x16x32_bf16 a[92:95], v[156:159], v[180:183], a[92:95]
    s_add_u32 m0, s30, 6144
    v_exp_f32 v167, v167
    v_mfma_f32_16x16x32_bf16 a[92:95], v[124:127], v[232:235], a[92:95]
    buffer_load_dwordx4 v198, s[52:55], 0 offen sc1 lds
    v_cvt_pk_bf16_f32 v179, v166, v167
    v_mfma_f32_16x16x32_bf16 v[160:163], v[32:35], a[224:227], 0
    v_exp_f32 v168, v168
    v_mfma_f32_16x16x32_bf16 v[160:163], v[36:39], a[228:231], v[160:163]
    ds_write_b128 v1, a[72:75] offset:20480
    buffer_load_dwordx4 a[196:199], v20, s[12:15], s6 offen offset:1024 sc1
    v_mfma_f32_16x16x32_bf16 v[160:163], v[40:43], a[232:235], v[160:163]
    s_add_u32 m0, s30, 7168
    v_exp_f32 v169, v169
    v_mfma_f32_16x16x32_bf16 v[160:163], v[44:47], a[236:239], v[160:163]
    buffer_load_dwordx4 v199, s[52:55], 0 offen sc1 lds
    v_cvt_pk_bf16_f32 v180, v168, v169
    v_mfma_f32_16x16x32_bf16 a[96:99], v[128:131], v[236:239], a[96:99]
    v_exp_f32 v170, v170
    v_mfma_f32_16x16x32_bf16 a[96:99], v[96:99], v[176:179], a[96:99]
    ds_write_b128 v1, a[76:79] offset:21504
    buffer_load_dwordx4 a[200:203], v20, s[12:15], s6 offen offset:2048 sc1
    v_mfma_f32_16x16x32_bf16 a[100:103], v[132:135], v[236:239], a[100:103]
    v_exp_f32 v171, v171
    v_mfma_f32_16x16x32_bf16 a[100:103], v[100:103], v[176:179], a[100:103]
    v_cvt_pk_bf16_f32 v181, v170, v171
    v_mfma_f32_16x16x32_bf16 v[164:167], v[48:51], a[224:227], 0
    v_exp_f32 v172, v172
    v_mfma_f32_16x16x32_bf16 v[164:167], v[52:55], a[228:231], v[164:167]
    ds_write_b128 v1, a[80:83] offset:22528
    buffer_load_dwordx4 a[204:207], v20, s[12:15], s6 offen offset:3072 sc1
    v_mfma_f32_16x16x32_bf16 v[164:167], v[56:59], a[232:235], v[164:167]
    v_exp_f32 v173, v173
    v_mfma_f32_16x16x32_bf16 v[164:167], v[60:63], a[236:239], v[164:167]
    v_cvt_pk_bf16_f32 v182, v172, v173
    v_mfma_f32_16x16x32_bf16 a[104:107], v[136:139], v[236:239], a[104:107]
    v_exp_f32 v174, v174
    v_mfma_f32_16x16x32_bf16 a[104:107], v[104:107], v[176:179], a[104:107]
    ds_write_b128 v1, a[84:87] offset:23552
    buffer_load_dwordx4 a[208:211], v21, s[12:15], s6 offen offset:0 sc1
    v_mfma_f32_16x16x32_bf16 a[108:111], v[140:143], v[236:239], a[108:111]
    v_exp_f32 v175, v175
    v_mfma_f32_16x16x32_bf16 a[108:111], v[108:111], v[176:179], a[108:111]
    v_xor_b32 v3, 32768, v1
    v_xor_b32 v4, 65536, v1
    v_cvt_pk_bf16_f32 v183, v174, v175
    v_exp_f32 v160, v160
    ds_write_b128 v1, a[88:91] offset:24576
    buffer_load_dwordx4 a[212:215], v21, s[12:15], s6 offen offset:1024 sc1
    v_exp_f32 v161, v161
    v_xor_b32 v5, 98304, v1
    v_add_u32 v216, s45, v20
    v_cvt_pk_bf16_f32 v232, v160, v161
    v_mfma_f32_16x16x32_bf16 a[112:115], v[144:147], v[236:239], a[112:115]
    v_exp_f32 v162, v162
    v_mfma_f32_16x16x32_bf16 a[112:115], v[112:115], v[176:179], a[112:115]
    ds_write_b128 v1, a[92:95] offset:25600
    buffer_load_dwordx4 a[216:219], v21, s[12:15], s6 offen offset:2048 sc1
    v_mfma_f32_16x16x32_bf16 a[116:119], v[148:151], v[236:239], a[116:119]
    v_exp_f32 v163, v163
    v_mfma_f32_16x16x32_bf16 a[116:119], v[116:119], v[176:179], a[116:119]
    v_cvt_pk_bf16_f32 v233, v162, v163
    v_exp_f32 v164, v164
    buffer_load_dwordx4 a[220:223], v21, s[12:15], s6 offen offset:3072 sc1
    v_exp_f32 v165, v165
    s_nop 0
    v_cvt_pk_bf16_f32 v234, v164, v165
    v_mfma_f32_16x16x32_bf16 a[120:123], v[152:155], v[236:239], a[120:123]
    v_exp_f32 v166, v166
    v_mfma_f32_16x16x32_bf16 a[120:123], v[120:123], v[176:179], a[120:123]
    v_mfma_f32_16x16x32_bf16 a[124:127], v[156:159], v[236:239], a[124:127]
    v_exp_f32 v167, v167
    v_mfma_f32_16x16x32_bf16 a[124:127], v[124:127], v[176:179], a[124:127]
    v_cvt_pk_bf16_f32 v235, v166, v167
    s_branch L2_epi
L2_slow:
    v_add_u32 v216, 0, v0
    v_min_u32 v216, 249, v216
    v_lshlrev_b32 v216, 7, v216
    buffer_load_dwordx4 v[236:239], v216, s[12:15], s58 offen sc1
    s_waitcnt vmcnt(0)
    s_mov_b32 s49, 0x40000
L2_rdy_c0:
    v_xor_b32 v236, s59, v236
    v_xor_b32 v237, s59, v237
    v_xor_b32 v238, s59, v238
    v_xor_b32 v239, s59, v239
    v_or3_b32 v236, v236, v237, v238
    v_or_b32 v236, v236, v239
    v_cmp_ne_u32 vcc, 0, v236
    s_sub_u32 s49, s49, 1
    s_cselect_b64 vcc, 0, vcc
    s_cbranch_vccz L2_go_c0
    buffer_load_dwordx4 v[236:239], v216, s[12:15], s58 offen sc1
    s_waitcnt vmcnt(0)
    s_branch L2_rdy_c0
L2_go_c0:
    v_add_u32 v216, 64, v0
    v_min_u32 v216, 249, v216
    v_lshlrev_b32 v216, 7, v216
    buffer_load_dwordx4 v[236:239], v216, s[12:15], s58 offen sc1
    s_waitcnt vmcnt(0)
    s_mov_b32 s49, 0x40000
L2_rdy_c1:
    v_xor_b32 v236, s59, v236
    v_xor_b32 v237, s59, v237
    v_xor_b32 v238, s59, v238
    v_xor_b32 v239, s59, v239
    v_or3_b32 v236, v236, v237, v238
    v_or_b32 v236, v236, v239
    v_cmp_ne_u32 vcc, 0, v236
    s_sub_u32 s49, s49, 1
    s_cselect_b64 vcc, 0, vcc
    s_cbranch_vccz L2_go_c1
    buffer_load_dwordx4 v[236:239], v216, s[12:15], s58 offen sc1
    s_waitcnt vmcnt(0)
    s_branch L2_rdy_c1
L2_go_c1:
    v_add_u32 v216, 128, v0
    v_min_u32 v216, 249, v216
    v_lshlrev_b32 v216, 7, v216
    buffer_load_dwordx4 v[236:239], v216, s[12:15], s58 offen sc1
    s_waitcnt vmcnt(0)
    s_mov_b32 s49, 0x40000
L2_rdy_c2:
    v_xor_b32 v236, s59, v236
    v_xor_b32 v237, s59, v237
    v_xor_b32 v238, s59, v238
    v_xor_b32 v239, s59, v239
    v_or3_b32 v236, v236, v237, v238
    v_or_b32 v236, v236, v239
    v_cmp_ne_u32 vcc, 0, v236
    s_sub_u32 s49, s49, 1
    s_cselect_b64 vcc, 0, vcc
    s_cbranch_vccz L2_go_c2
    buffer_load_dwordx4 v[236:239], v216, s[12:15], s58 offen sc1
    s_waitcnt vmcnt(0)
    s_branch L2_rdy_c2
L2_go_c2:
    v_add_u32 v216, 192, v0
    v_min_u32 v216, 249, v216
    v_lshlrev_b32 v216, 7, v216
    buffer_load_dwordx4 v[236:239], v216, s[12:15], s58 offen sc1
    s_waitcnt vmcnt(0)
    s_mov_b32 s49, 0x40000
L2_rdy_c3:
    v_xor_b32 v236, s59, v236
    v_xor_b32 v237, s59, v237
    v_xor_b32 v238, s59, v238
    v_xor_b32 v239, s59, v239
    v_or3_b32 v236, v236, v237, v238
    v_or_b32 v236, v236, v239
    v_cmp_ne_u32 vcc, 0, v236
    s_sub_u32 s49, s49, 1
    s_cselect_b64 vcc, 0, vcc
    s_cbranch_vccz L2_go_c3
    buffer_load_dwordx4 v[236:239], v216, s[12:15], s58 offen sc1
    s_waitcnt vmcnt(0)
    s_branch L2_rdy_c3
L2_go_c3:
    s_waitcnt lgkmcnt(0)
    v_subrev_u32 v232, s30, v8
    v_subrev_u32 v233, s30, v9
    v_subrev_u32 v234, s30, v10
    v_subrev_u32 v235, s30, v11
    v_mov_b32 v200, 0xff800000
    v_mov_b32 v204, 0xff800000
    v_mov_b32 v208, 0xff800000
    v_mov_b32 v212, 0xff800000
    v_mov_b32 v216, 0xff800000
    s_mov_b32 s35, 0
L2_max:
    buffer_load_dwordx4 v[64:67], v232, s[8:11], s35 offen sc1
    buffer_load_dwordx4 v[68:71], v233, s[8:11], s35 offen sc1
    buffer_load_dwordx4 v[72:75], v234, s[8:11], s35 offen sc1
    buffer_load_dwordx4 v[76:79], v235, s[8:11], s35 offen sc1
    s_waitcnt vmcnt(0)
    v_mfma_f32_16x16x32_bf16 v[160:163], v[64:67], a[160:163], 0
    v_mfma_f32_16x16x32_bf16 v[160:163], v[68:71], a[164:167], v[160:163]
    v_mfma_f32_16x16x32_bf16 v[160:163], v[72:75], a[168:171], v[160:163]
    v_mfma_f32_16x16x32_bf16 v[160:163], v[76:79], a[172:175], v[160:163]
    v_mfma_f32_16x16x32_bf16 v[164:167], v[64:67], a[176:179], 0
    v_mfma_f32_16x16x32_bf16 v[164:167], v[68:71], a[180:183], v[164:167]
    v_mfma_f32_16x16x32_bf16 v[164:167], v[72:75], a[184:187], v[164:167]
    v_mfma_f32_16x16x32_bf16 v[164:167], v[76:79], a[188:191], v[164:167]
    v_mfma_f32_16x16x32_bf16 v[168:171], v[64:67], a[192:195], 0
    v_mfma_f32_16x16x32_bf16 v[168:171], v[68:71], a[196:199], v[168:171]
    v_mfma_f32_16x16x32_bf16 v[168:171], v[72:75], a[200:203], v[168:171]
    v_mfma_f32_16x16x32_bf16 v[168:171], v[76:79], a[204:207], v[168:171]
    v_mfma_f32_16x16x32_bf16 v[172:175], v[64:67], a[208:211], 0
    v_mfma_f32_16x16x32_bf16 v[172:175], v[68:71], a[212:215], v[172:175]
    v_mfma_f32_16x16x32_bf16 v[172:175], v[72:75], a[216:219], v[172:175]
    v_mfma_f32_16x16x32_bf16 v[172:175], v[76:79], a[220:223], v[172:175]
    v_mfma_f32_16x16x32_bf16 v[176:179], v[64:67], a[224:227], 0
    v_mfma_f32_16x16x32_bf16 v[176:179], v[68:71], a[228:231], v[176:179]
    v_mfma_f32_16x16x32_bf16 v[176:179], v[72:75], a[232:235], v[176:179]
    v_mfma_f32_16x16x32_bf16 v[176:179], v[76:79], a[236:239], v[176:179]
    v_max3_f32 v200, v200, v160, v161
    v_max3_f32 v200, v200, v162, v163
    v_max3_f32 v204, v204, v164, v165
    v_max3_f32 v204, v204, v166, v167
    v_max3_f32 v208, v208, v168, v169
    v_max3_f32 v208, v208, v170, v171
    v_max3_f32 v212, v212, v172, v173
    v_max3_f32 v212, v212, v174, v175
    v_max3_f32 v216, v216, v176, v177
    v_max3_f32 v216, v216, v178, v179
    s_add_u32 s35, s35, 4096
    s_cmp_lt_u32 s35, 2560000
    s_cbranch_scc1 L2_max
    v_xor_b32 v2, 16, v0
    v_lshlrev_b32 v2, 2, v2
    ds_bpermute_b32 v201, v2, v200
    ds_bpermute_b32 v205, v2, v204
    ds_bpermute_b32 v209, v2, v208
    ds_bpermute_b32 v213, v2, v212
    ds_bpermute_b32 v217, v2, v216
    s_waitcnt lgkmcnt(0)
    v_max_f32 v200, v200, v201
    v_max_f32 v204, v204, v205
    v_max_f32 v208, v208, v209
    v_max_f32 v212, v212, v213
    v_max_f32 v216, v216, v217
    v_xor_b32 v2, 32, v0
    v_lshlrev_b32 v2, 2, v2
    ds_bpermute_b32 v201, v2, v200
    ds_bpermute_b32 v205, v2, v204
    ds_bpermute_b32 v209, v2, v208
    ds_bpermute_b32 v213, v2, v212
    ds_bpermute_b32 v217, v2, v216
    s_waitcnt lgkmcnt(0)
    v_max_f32 v200, v200, v201
    v_max_f32 v204, v204, v205
    v_max_f32 v208, v208, v209
    v_max_f32 v212, v212, v213
    v_max_f32 v216, v216, v217
    v_sub_f32 v200, 0, v200
    v_mov_b32 v201, v200
    v_mov_b32 v202, v200
    v_mov_b32 v203, v200
    v_sub_f32 v204, 0, v204
    v_mov_b32 v205, v204
    v_mov_b32 v206, v204
    v_mov_b32 v207, v204
    v_sub_f32 v208, 0, v208
    v_mov_b32 v209, v208
    v_mov_b32 v210, v208
    v_mov_b32 v211, v208
    v_sub_f32 v212, 0, v212
    v_mov_b32 v213, v212
    v_mov_b32 v214, v212
    v_mov_b32 v215, v212
    v_sub_f32 v216, 0, v216
    v_mov_b32 v217, v216
    v_mov_b32 v218, v216
    v_mov_b32 v219, v216
    v_mfma_f32_16x16x32_bf16 v[160:163], v[32:35], a[160:163], v[200:203]
    v_mfma_f32_16x16x32_bf16 v[160:163], v[36:39], a[164:167], v[160:163]
    v_mfma_f32_16x16x32_bf16 v[160:163], v[40:43], a[168:171], v[160:163]
    v_mfma_f32_16x16x32_bf16 v[160:163], v[44:47], a[172:175], v[160:163]
    v_mfma_f32_16x16x32_bf16 v[164:167], v[48:51], a[160:163], v[200:203]
    v_mfma_f32_16x16x32_bf16 v[164:167], v[52:55], a[164:167], v[164:167]
    v_mfma_f32_16x16x32_bf16 v[164:167], v[56:59], a[168:171], v[164:167]
    v_mfma_f32_16x16x32_bf16 v[164:167], v[60:63], a[172:175], v[164:167]
    s_nop 7
    v_mfma_f32_16x16x32_bf16 v[168:171], v[32:35], a[176:179], v[204:207]
    s_waitcnt vmcnt(16)
    v_exp_f32 v160, v160
    v_mfma_f32_16x16x32_bf16 v[168:171], v[36:39], a[180:183], v[168:171]
    ds_read_b128 v[64:67], v8 offset:8192
    ds_read_b128 v[68:71], v9 offset:8192
    v_mfma_f32_16x16x32_bf16 v[168:171], v[40:43], a[184:187], v[168:171]
    v_exp_f32 v161, v161
    v_mfma_f32_16x16x32_bf16 v[168:171], v[44:47], a[188:191], v[168:171]
    ds_read_b128 v[72:75], v10 offset:8192
    v_cvt_pk_bf16_f32 v176, v160, v161
    v_exp_f32 v162, v162
    ds_read_b128 v[76:79], v11 offset:8192
    ds_read_b128 v[80:83], v8 offset:12288
    v_exp_f32 v163, v163
    ds_read_b128 v[84:87], v9 offset:12288
    v_cvt_pk_bf16_f32 v177, v162, v163
    v_mfma_f32_16x16x32_bf16 v[172:175], v[48:51], a[176:179], v[204:207]
    v_exp_f32 v164, v164
    v_mfma_f32_16x16x32_bf16 v[172:175], v[52:55], a[180:183], v[172:175]
    ds_read_b128 v[88:91], v10 offset:12288
    ds_read_b128 v[92:95], v11 offset:12288
    v_mfma_f32_16x16x32_bf16 v[172:175], v[56:59], a[184:187], v[172:175]
    v_exp_f32 v165, v165
    v_mfma_f32_16x16x32_bf16 v[172:175], v[60:63], a[188:191], v[172:175]
    v_cvt_pk_bf16_f32 v178, v164, v165
    v_exp_f32 v166, v166
    s_waitcnt lgkmcnt(15)
    v_exp_f32 v167, v167
    ds_read_b64_tr_b16 v[128:129], v12 offset:8192
    v_cvt_pk_bf16_f32 v179, v166, v167
    v_mfma_f32_16x16x32_bf16 v[160:163], v[32:35], a[192:195], v[208:211]
    s_add_u32 m0, s30, 24576
    v_exp_f32 v168, v168
    v_mfma_f32_16x16x32_bf16 v[160:163], v[36:39], a[196:199], v[160:163]
    buffer_load_dwordx4 v20, s[8:11], s31 offen offset:0 sc1 lds
    v_mfma_f32_16x16x32_bf16 v[160:163], v[40:43], a[200:203], v[160:163]
    v_exp_f32 v169, v169
    v_mfma_f32_16x16x32_bf16 v[160:163], v[44:47], a[204:207], v[160:163]
    ds_read_b64_tr_b16 v[130:131], v12 offset:12288
    v_cvt_pk_bf16_f32 v180, v168, v169
    v_mfma_f32_16x16x32_bf16 a[0:3], v[96:99], v[176:179], 0
    v_exp_f32 v170, v170
    v_mfma_f32_16x16x32_bf16 a[4:7], v[100:103], v[176:179], 0
    buffer_load_dwordx4 v20, s[8:11], s31 offen offset:1024 sc1 lds
    v_mfma_f32_16x16x32_bf16 a[8:11], v[104:107], v[176:179], 0
    v_exp_f32 v171, v171
    v_mfma_f32_16x16x32_bf16 a[12:15], v[108:111], v[176:179], 0
    ds_read_b64_tr_b16 v[132:133], v13 offset:8192
    v_cvt_pk_bf16_f32 v181, v170, v171
    v_mfma_f32_16x16x32_bf16 v[164:167], v[48:51], a[192:195], v[208:211]
    v_exp_f32 v172, v172
    v_mfma_f32_16x16x32_bf16 v[164:167], v[52:55], a[196:199], v[164:167]
    buffer_load_dwordx4 v20, s[8:11], s31 offen offset:2048 sc1 lds
    v_mfma_f32_16x16x32_bf16 v[164:167], v[56:59], a[200:203], v[164:167]
    v_exp_f32 v173, v173
    v_mfma_f32_16x16x32_bf16 v[164:167], v[60:63], a[204:207], v[164:167]
    ds_read_b64_tr_b16 v[134:135], v13 offset:12288
    v_cvt_pk_bf16_f32 v182, v172, v173
    v_mfma_f32_16x16x32_bf16 a[16:19], v[112:115], v[176:179], 0
    v_exp_f32 v174, v174
    v_mfma_f32_16x16x32_bf16 a[20:23], v[116:119], v[176:179], 0
    buffer_load_dwordx4 v20, s[8:11], s31 offen offset:3072 sc1 lds
    v_mfma_f32_16x16x32_bf16 a[24:27], v[120:123], v[176:179], 0
    v_exp_f32 v175, v175
    v_mfma_f32_16x16x32_bf16 a[28:31], v[124:127], v[176:179], 0
    ds_read_b64_tr_b16 v[136:137], v14 offset:8192
    v_cvt_pk_bf16_f32 v183, v174, v175
    v_mfma_f32_16x16x32_bf16 v[168:171], v[32:35], a[208:211], v[212:215]
    s_add_u32 m0, s30, 28672
    v_exp_f32 v160, v160
    v_mfma_f32_16x16x32_bf16 v[168:171], v[36:39], a[212:215], v[168:171]
    buffer_load_dwordx4 v21, s[8:11], s31 offen offset:0 sc1 lds
    v_mfma_f32_16x16x32_bf16 v[168:171], v[40:43], a[216:219], v[168:171]
    v_exp_f32 v161, v161
    v_mfma_f32_16x16x32_bf16 v[168:171], v[44:47], a[220:223], v[168:171]
    ds_read_b64_tr_b16 v[138:139], v14 offset:12288
    v_cvt_pk_bf16_f32 v232, v160, v161
    v_mfma_f32_16x16x32_bf16 a[32:35], v[96:99], v[180:183], 0
    v_exp_f32 v162, v162
    v_mfma_f32_16x16x32_bf16 a[36:39], v[100:103], v[180:183], 0
    buffer_load_dwordx4 v21, s[8:11], s31 offen offset:1024 sc1 lds
    v_mfma_f32_16x16x32_bf16 a[40:43], v[104:107], v[180:183], 0
    v_exp_f32 v163, v163
    v_mfma_f32_16x16x32_bf16 a[44:47], v[108:111], v[180:183], 0
    ds_read_b64_tr_b16 v[140:141], v15 offset:8192
    v_cvt_pk_bf16_f32 v233, v162, v163
    v_mfma_f32_16x16x32_bf16 v[172:175], v[48:51], a[208:211], v[212:215]
    v_exp_f32 v164, v164
    v_mfma_f32_16x16x32_bf16 v[172:175], v[52:55], a[212:215], v[172:175]
    buffer_load_dwordx4 v21, s[8:11], s31 offen offset:2048 sc1 lds
    v_mfma_f32_16x16x32_bf16 v[172:175], v[56:59], a[216:219], v[172:175]
    v_exp_f32 v165, v165
    v_mfma_f32_16x16x32_bf16 v[172:175], v[60:63], a[220:223], v[172:175]
    ds_read_b64_tr_b16 v[142:143], v15 offset:12288
    v_cvt_pk_bf16_f32 v234, v164, v165
    v_mfma_f32_16x16x32_bf16 a[48:51], v[112:115], v[180:183], 0
    v_exp_f32 v166, v166
    v_mfma_f32_16x16x32_bf16 a[52:55], v[116:119], v[180:183], 0
    buffer_load_dwordx4 v21, s[8:11], s31 offen offset:3072 sc1 lds
    v_mfma_f32_16x16x32_bf16 a[56:59], v[120:123], v[180:183], 0
    s_add_u32 s31, s31, 8192
    v_exp_f32 v167, v167
    v_mfma_f32_16x16x32_bf16 a[60:63], v[124:127], v[180:183], 0
    ds_read_b64_tr_b16 v[144:145], v16 offset:8192
    v_cvt_pk_bf16_f32 v235, v166, v167
    v_mfma_f32_16x16x32_bf16 v[160:163], v[32:35], a[224:227], v[216:219]
    s_add_u32 m0, s30, 0
    v_exp_f32 v168, v168
    v_mfma_f32_16x16x32_bf16 v[160:163], v[36:39], a[228:231], v[160:163]
    buffer_load_dwordx4 v20, s[8:11], s31 offen offset:0 sc1 lds
    v_mfma_f32_16x16x32_bf16 v[160:163], v[40:43], a[232:235], v[160:163]
    v_exp_f32 v169, v169
    v_mfma_f32_16x16x32_bf16 v[160:163], v[44:47], a[236:239], v[160:163]
    ds_read_b64_tr_b16 v[146:147], v16 offset:12288
    v_cvt_pk_bf16_f32 v236, v168, v169
    v_mfma_f32_16x16x32_bf16 a[64:67], v[96:99], v[232:235], 0
    v_exp_f32 v170, v170
    v_mfma_f32_16x16x32_bf16 a[68:71], v[100:103], v[232:235], 0
    buffer_load_dwordx4 v20, s[8:11], s31 offen offset:1024 sc1 lds
    v_mfma_f32_16x16x32_bf16 a[72:75], v[104:107], v[232:235], 0
    v_exp_f32 v171, v171
    v_mfma_f32_16x16x32_bf16 a[76:79], v[108:111], v[232:235], 0
    ds_read_b64_tr_b16 v[148:149], v17 offset:8192
    v_cvt_pk_bf16_f32 v237, v170, v171
    v_mfma_f32_16x16x32_bf16 v[164:167], v[48:51], a[224:227], v[216:219]
    v_exp_f32 v172, v172
    v_mfma_f32_16x16x32_bf16 v[164:167], v[52:55], a[228:231], v[164:167]
    buffer_load_dwordx4 v20, s[8:11], s31 offen offset:2048 sc1 lds
    v_mfma_f32_16x16x32_bf16 v[164:167], v[56:59], a[232:235], v[164:167]
    v_exp_f32 v173, v173
    v_mfma_f32_16x16x32_bf16 v[164:167], v[60:63], a[236:239], v[164:167]
    ds_read_b64_tr_b16 v[150:151], v17 offset:12288
    v_cvt_pk_bf16_f32 v238, v172, v173
    v_mfma_f32_16x16x32_bf16 a[80:83], v[112:115], v[232:235], 0
    v_exp_f32 v174, v174
    v_mfma_f32_16x16x32_bf16 a[84:87], v[116:119], v[232:235], 0
    buffer_load_dwordx4 v20, s[8:11], s31 offen offset:3072 sc1 lds
    v_mfma_f32_16x16x32_bf16 a[88:91], v[120:123], v[232:235], 0
    s_waitcnt lgkmcnt(12)
    s_waitcnt vmcnt(20)
    v_exp_f32 v175, v175
    v_mfma_f32_16x16x32_bf16 a[92:95], v[124:127], v[232:235], 0
    ds_read_b64_tr_b16 v[152:153], v18 offset:8192
    v_cvt_pk_bf16_f32 v239, v174, v175
    v_mfma_f32_16x16x32_bf16 v[168:171], v[64:67], a[160:163], v[200:203]
    v_exp_f32 v160, v160
    v_mfma_f32_16x16x32_bf16 v[168:171], v[68:71], a[164:167], v[168:171]
    ds_read_b128 v[32:35], v8 offset:16384
    ds_read_b128 v[36:39], v9 offset:16384
    v_mfma_f32_16x16x32_bf16 v[168:171], v[72:75], a[168:171], v[168:171]
    v_exp_f32 v161, v161
    v_mfma_f32_16x16x32_bf16 v[168:171], v[76:79], a[172:175], v[168:171]
    ds_read_b64_tr_b16 v[154:155], v18 offset:12288
    v_cvt_pk_bf16_f32 v176, v160, v161
    v_mfma_f32_16x16x32_bf16 a[96:99], v[96:99], v[236:239], 0
    v_exp_f32 v162, v162
    v_mfma_f32_16x16x32_bf16 a[100:103], v[100:103], v[236:239], 0
    ds_read_b128 v[40:43], v10 offset:16384
    ds_read_b128 v[44:47], v11 offset:16384
    v_mfma_f32_16x16x32_bf16 a[104:107], v[104:107], v[236:239], 0
    v_exp_f32 v163, v163
    v_mfma_f32_16x16x32_bf16 a[108:111], v[108:111], v[236:239], 0
    ds_read_b64_tr_b16 v[156:157], v19 offset:8192
    v_cvt_pk_bf16_f32 v177, v162, v163
    v_mfma_f32_16x16x32_bf16 v[172:175], v[80:83], a[160:163], v[200:203]
    v_exp_f32 v164, v164
    v_mfma_f32_16x16x32_bf16 v[172:175], v[84:87], a[164:167], v[172:175]
    ds_read_b128 v[48:51], v8 offset:20480
    ds_read_b128 v[52:55], v9 offset:20480
    v_mfma_f32_16x16x32_bf16 v[172:175], v[88:91], a[168:171], v[172:175]
    v_exp_f32 v165, v165
    v_mfma_f32_16x16x32_bf16 v[172:175], v[92:95], a[172:175], v[172:175]
    ds_read_b64_tr_b16 v[158:159], v19 offset:12288
    v_cvt_pk_bf16_f32 v178, v164, v165
    v_mfma_f32_16x16x32_bf16 a[112:115], v[112:115], v[236:239], 0
    v_exp_f32 v166, v166
    v_mfma_f32_16x16x32_bf16 a[116:119], v[116:119], v[236:239], 0
    ds_read_b128 v[56:59], v10 offset:20480
    ds_read_b128 v[60:63], v11 offset:20480
    v_mfma_f32_16x16x32_bf16 a[120:123], v[120:123], v[236:239], 0
    v_exp_f32 v167, v167
    v_mfma_f32_16x16x32_bf16 a[124:127], v[124:127], v[236:239], 0
    v_cvt_pk_bf16_f32 v179, v166, v167
    s_waitcnt lgkmcnt(6)
    v_mfma_f32_16x16x32_bf16 v[160:163], v[32:35], a[160:163], v[200:203]
    v_exp_f32 v168, v168
    v_mfma_f32_16x16x32_bf16 v[160:163], v[36:39], a[164:167], v[160:163]
    v_mfma_f32_16x16x32_bf16 v[160:163], v[40:43], a[168:171], v[160:163]
    v_exp_f32 v169, v169
    v_mfma_f32_16x16x32_bf16 v[160:163], v[44:47], a[172:175], v[160:163]
    v_cvt_pk_bf16_f32 v180, v168, v169
    v_mfma_f32_16x16x32_bf16 a[128:131], v[96:99], v[176:179], 0
    v_exp_f32 v170, v170
    v_mfma_f32_16x16x32_bf16 a[132:135], v[100:103], v[176:179], 0
    v_mfma_f32_16x16x32_bf16 a[136:139], v[104:107], v[176:179], 0
    s_waitcnt lgkmcnt(0)
    v_exp_f32 v171, v171
    v_mfma_f32_16x16x32_bf16 a[140:143], v[108:111], v[176:179], 0
    ds_read_b64_tr_b16 v[96:97], v12 offset:16384
    v_cvt_pk_bf16_f32 v181, v170, v171
    v_mfma_f32_16x16x32_bf16 v[164:167], v[48:51], a[160:163], v[200:203]
    v_exp_f32 v172, v172
    v_mfma_f32_16x16x32_bf16 v[164:167], v[52:55], a[164:167], v[164:167]
    ds_read_b64_tr_b16 v[98:99], v12 offset:20480
    ds_read_b64_tr_b16 v[100:101], v13 offset:16384
    v_mfma_f32_16x16x32_bf16 v[164:167], v[56:59], a[168:171], v[164:167]
    v_exp_f32 v173, v173
    v_mfma_f32_16x16x32_bf16 v[164:167], v[60:63], a[172:175], v[164:167]
    ds_read_b64_tr_b16 v[102:103], v13 offset:20480
    v_cvt_pk_bf16_f32 v182, v172, v173
    v_mfma_f32_16x16x32_bf16 a[144:147], v[112:115], v[176:179], 0
    v_exp_f32 v174, v174
    v_mfma_f32_16x16x32_bf16 a[148:151], v[116:119], v[176:179], 0
    ds_read_b64_tr_b16 v[104:105], v14 offset:16384
    ds_read_b64_tr_b16 v[106:107], v14 offset:20480
    v_mfma_f32_16x16x32_bf16 a[152:155], v[120:123], v[176:179], 0
    v_exp_f32 v175, v175
    v_mfma_f32_16x16x32_bf16 a[156:159], v[124:127], v[176:179], 0
    ds_read_b64_tr_b16 v[108:109], v15 offset:16384
    v_cvt_pk_bf16_f32 v183, v174, v175
    v_mfma_f32_16x16x32_bf16 v[168:171], v[64:67], a[176:179], v[204:207]
    v_exp_f32 v160, v160
    v_mfma_f32_16x16x32_bf16 v[168:171], v[68:71], a[180:183], v[168:171]
    ds_read_b64_tr_b16 v[110:111], v15 offset:20480
    ds_read_b64_tr_b16 v[112:113], v16 offset:16384
    v_mfma_f32_16x16x32_bf16 v[168:171], v[72:75], a[184:187], v[168:171]
    v_exp_f32 v161, v161
    v_mfma_f32_16x16x32_bf16 v[168:171], v[76:79], a[188:191], v[168:171]
    ds_read_b64_tr_b16 v[114:115], v16 offset:20480
    v_cvt_pk_bf16_f32 v232, v160, v161
    v_exp_f32 v162, v162
    ds_read_b64_tr_b16 v[116:117], v17 offset:16384
    ds_read_b64_tr_b16 v[118:119], v17 offset:20480
    v_exp_f32 v163, v163
    ds_read_b64_tr_b16 v[120:121], v18 offset:16384
    v_cvt_pk_bf16_f32 v233, v162, v163
    v_mfma_f32_16x16x32_bf16 v[172:175], v[80:83], a[176:179], v[204:207]
    v_exp_f32 v164, v164
    v_mfma_f32_16x16x32_bf16 v[172:175], v[84:87], a[180:183], v[172:175]
    ds_read_b64_tr_b16 v[122:123], v18 offset:20480
    ds_read_b64_tr_b16 v[124:125], v19 offset:16384
    v_mfma_f32_16x16x32_bf16 v[172:175], v[88:91], a[184:187], v[172:175]
    v_exp_f32 v165, v165
    v_mfma_f32_16x16x32_bf16 v[172:175], v[92:95], a[188:191], v[172:175]
    ds_read_b64_tr_b16 v[126:127], v19 offset:20480
    v_cvt_pk_bf16_f32 v234, v164, v165
    v_exp_f32 v166, v166
    v_exp_f32 v167, v167
    s_nop 0
    v_cvt_pk_bf16_f32 v235, v166, v167
    v_mfma_f32_16x16x32_bf16 v[160:163], v[32:35], a[176:179], v[204:207]
    s_add_u32 m0, s30, 4096
    v_exp_f32 v168, v168
    v_mfma_f32_16x16x32_bf16 v[160:163], v[36:39], a[180:183], v[160:163]
    buffer_load_dwordx4 v21, s[8:11], s31 offen offset:0 sc1 lds
    v_mfma_f32_16x16x32_bf16 v[160:163], v[40:43], a[184:187], v[160:163]
    s_waitcnt lgkmcnt(12)
    v_exp_f32 v169, v169
    v_mfma_f32_16x16x32_bf16 v[160:163], v[44:47], a[188:191], v[160:163]
    v_cvt_pk_bf16_f32 v236, v168, v169
    v_mfma_f32_16x16x32_bf16 a[0:3], v[128:131], v[180:183], a[0:3]
    v_exp_f32 v170, v170
    v_mfma_f32_16x16x32_bf16 a[0:3], v[96:99], v[232:235], a[0:3]
    buffer_load_dwordx4 v21, s[8:11], s31 offen offset:1024 sc1 lds
    v_mfma_f32_16x16x32_bf16 a[4:7], v[132:135], v[180:183], a[4:7]
    v_exp_f32 v171, v171
    v_mfma_f32_16x16x32_bf16 a[4:7], v[100:103], v[232:235], a[4:7]
    v_cvt_pk_bf16_f32 v237, v170, v171
    v_mfma_f32_16x16x32_bf16 v[164:167], v[48:51], a[176:179], v[204:207]
    v_exp_f32 v172, v172
    v_mfma_f32_16x16x32_bf16 v[164:167], v[52:55], a[180:183], v[164:167]
    buffer_load_dwordx4 v21, s[8:11], s31 offen offset:2048 sc1 lds
    v_mfma_f32_16x16x32_bf16 v[164:167], v[56:59], a[184:187], v[164:167]
    s_waitcnt lgkmcnt(8)
    v_exp_f32 v173, v173
    v_mfma_f32_16x16x32_bf16 v[164:167], v[60:63], a[188:191], v[164:167]
    v_cvt_pk_bf16_f32 v238, v172, v173
    v_mfma_f32_16x16x32_bf16 a[8:11], v[136:139], v[180:183], a[8:11]
    v_exp_f32 v174, v174
    v_mfma_f32_16x16x32_bf16 a[8:11], v[104:107], v[232:235], a[8:11]
    buffer_load_dwordx4 v21, s[8:11], s31 offen offset:3072 sc1 lds
    v_mfma_f32_16x16x32_bf16 a[12:15], v[140:143], v[180:183], a[12:15]
    s_add_u32 s31, s31, 8192
    v_exp_f32 v175, v175
    v_mfma_f32_16x16x32_bf16 a[12:15], v[108:111], v[232:235], a[12:15]
    v_cvt_pk_bf16_f32 v239, v174, v175
    v_mfma_f32_16x16x32_bf16 v[168:171], v[64:67], a[192:195], v[208:211]
    s_mov_b32 s35, 2555904
    s_mov_b32 m0, s45
    v_exp_f32 v160, v160
    v_mfma_f32_16x16x32_bf16 v[168:171], v[68:71], a[196:199], v[168:171]
    buffer_load_dwordx4 v20, s[8:11], s35 offen offset:0 sc1 lds
    v_mfma_f32_16x16x32_bf16 v[168:171], v[72:75], a[200:203], v[168:171]
    s_waitcnt lgkmcnt(4)
    v_exp_f32 v161, v161
    v_mfma_f32_16x16x32_bf16 v[168:171], v[76:79], a[204:207], v[168:171]
    buffer_load_dwordx4 v20, s[8:11], s35 offen offset:1024 sc1 lds
    v_cvt_pk_bf16_f32 v176, v160, v161
    v_mfma_f32_16x16x32_bf16 a[16:19], v[144:147], v[180:183], a[16:19]
    v_exp_f32 v162, v162
    v_mfma_f32_16x16x32_bf16 a[16:19], v[112:115], v[232:235], a[16:19]
    buffer_load_dwordx4 v20, s[8:11], s35 offen offset:2048 sc1 lds
    v_mfma_f32_16x16x32_bf16 a[20:23], v[148:151], v[180:183], a[20:23]
    v_exp_f32 v163, v163
    v_mfma_f32_16x16x32_bf16 a[20:23], v[116:119], v[232:235], a[20:23]
    buffer_load_dwordx4 v20, s[8:11], s35 offen offset:3072 sc1 lds
    v_cvt_pk_bf16_f32 v177, v162, v163
    v_mfma_f32_16x16x32_bf16 v[172:175], v[80:83], a[192:195], v[208:211]
    v_exp_f32 v164, v164
    v_mfma_f32_16x16x32_bf16 v[172:175], v[84:87], a[196:199], v[172:175]
    v_mfma_f32_16x16x32_bf16 v[172:175], v[88:91], a[200:203], v[172:175]
    s_waitcnt lgkmcnt(0)
    v_exp_f32 v165, v165
    v_mfma_f32_16x16x32_bf16 v[172:175], v[92:95], a[204:207], v[172:175]
    v_cvt_pk_bf16_f32 v178, v164, v165
    v_mfma_f32_16x16x32_bf16 a[24:27], v[152:155], v[180:183], a[24:27]
    s_add_u32 m0, s30, 8192
    v_exp_f32 v166, v166
    v_mfma_f32_16x16x32_bf16 a[24:27], v[120:123], v[232:235], a[24:27]
    buffer_load_dwordx4 v20, s[8:11], s31 offen offset:0 sc1 lds
    v_mfma_f32_16x16x32_bf16 a[28:31], v[156:159], v[180:183], a[28:31]
    v_exp_f32 v167, v167
    v_mfma_f32_16x16x32_bf16 a[28:31], v[124:127], v[232:235], a[28:31]
    v_cvt_pk_bf16_f32 v179, v166, v167
    v_mfma_f32_16x16x32_bf16 v[160:163], v[32:35], a[192:195], v[208:211]
    v_exp_f32 v168, v168
    v_mfma_f32_16x16x32_bf16 v[160:163], v[36:39], a[196:199], v[160:163]
    buffer_load_dwordx4 v20, s[8:11], s31 offen offset:1024 sc1 lds
    v_mfma_f32_16x16x32_bf16 v[160:163], v[40:43], a[200:203], v[160:163]
    v_exp_f32 v169, v169
    v_mfma_f32_16x16x32_bf16 v[160:163], v[44:47], a[204:207], v[160:163]
    v_cvt_pk_bf16_f32 v180, v168, v169
    v_mfma_f32_16x16x32_bf16 a[32:35], v[128:131], v[236:239], a[32:35]
    v_exp_f32 v170, v170
    v_mfma_f32_16x16x32_bf16 a[32:35], v[96:99], v[176:179], a[32:35]
    buffer_load_dwordx4 v20, s[8:11], s31 offen offset:2048 sc1 lds
    v_mfma_f32_16x16x32_bf16 a[36:39], v[132:135], v[236:239], a[36:39]
    v_exp_f32 v171, v171
    v_mfma_f32_16x16x32_bf16 a[36:39], v[100:103], v[176:179], a[36:39]
    v_cvt_pk_bf16_f32 v181, v170, v171
    v_mfma_f32_16x16x32_bf16 v[164:167], v[48:51], a[192:195], v[208:211]
    v_exp_f32 v172, v172
    v_mfma_f32_16x16x32_bf16 v[164:167], v[52:55], a[196:199], v[164:167]
    buffer_load_dwordx4 v20, s[8:11], s31 offen offset:3072 sc1 lds
    v_mfma_f32_16x16x32_bf16 v[164:167], v[56:59], a[200:203], v[164:167]
    v_exp_f32 v173, v173
    v_mfma_f32_16x16x32_bf16 v[164:167], v[60:63], a[204:207], v[164:167]
    v_cvt_pk_bf16_f32 v182, v172, v173
    v_mfma_f32_16x16x32_bf16 a[40:43], v[136:139], v[236:239], a[40:43]
    s_add_u32 m0, s30, 12288
    v_exp_f32 v174, v174
    v_mfma_f32_16x16x32_bf16 a[40:43], v[104:107], v[176:179], a[40:43]
    buffer_load_dwordx4 v21, s[8:11], s31 offen offset:0 sc1 lds
    v_mfma_f32_16x16x32_bf16 a[44:47], v[140:143], v[236:239], a[44:47]
    v_exp_f32 v175, v175
    v_mfma_f32_16x16x32_bf16 a[44:47], v[108:111], v[176:179], a[44:47]
    v_cvt_pk_bf16_f32 v183, v174, v175
    v_mfma_f32_16x16x32_bf16 v[168:171], v[64:67], a[208:211], v[212:215]
    v_exp_f32 v160, v160
    v_mfma_f32_16x16x32_bf16 v[168:171], v[68:71], a[212:215], v[168:171]
    buffer_load_dwordx4 v21, s[8:11], s31 offen offset:1024 sc1 lds
    v_mfma_f32_16x16x32_bf16 v[168:171], v[72:75], a[216:219], v[168:171]
    s_waitcnt vmcnt(6)
    v_exp_f32 v161, v161
    v_mfma_f32_16x16x32_bf16 v[168:171], v[76:79], a[220:223], v[168:171]
    ds_read_b128 v[184:187], v244
    v_cvt_pk_bf16_f32 v232, v160, v161
    v_mfma_f32_16x16x32_bf16 a[48:51], v[144:147], v[236:239], a[48:51]
    v_exp_f32 v162, v162
    v_mfma_f32_16x16x32_bf16 a[48:51], v[112:115], v[176:179], a[48:51]
    buffer_load_dwordx4 v21, s[8:11], s31 offen offset:2048 sc1 lds
    v_mfma_f32_16x16x32_bf16 a[52:55], v[148:151], v[236:239], a[52:55]
    v_exp_f32 v163, v163
    v_mfma_f32_16x16x32_bf16 a[52:55], v[116:119], v[176:179], a[52:55]
    ds_read_b128 v[188:191], v245
    v_cvt_pk_bf16_f32 v233, v162, v163
    v_mfma_f32_16x16x32_bf16 v[172:175], v[80:83], a[208:211], v[212:215]
    v_exp_f32 v164, v164
    v_mfma_f32_16x16x32_bf16 v[172:175], v[84:87], a[212:215], v[172:175]
    buffer_load_dwordx4 v21, s[8:11], s31 offen offset:3072 sc1 lds
    v_mfma_f32_16x16x32_bf16 v[172:175], v[88:91], a[216:219], v[172:175]
    s_add_u32 s31, s31, 8192
    v_exp_f32 v165, v165
    v_mfma_f32_16x16x32_bf16 v[172:175], v[92:95], a[220:223], v[172:175]
    ds_read_b128 v[192:195], v246
    v_cvt_pk_bf16_f32 v234, v164, v165
    v_mfma_f32_16x16x32_bf16 a[56:59], v[152:155], v[236:239], a[56:59]
    s_add_u32 m0, s30, 16384
    v_exp_f32 v166, v166
    v_mfma_f32_16x16x32_bf16 a[56:59], v[120:123], v[176:179], a[56:59]
    buffer_load_dwordx4 v20, s[8:11], s31 offen offset:0 sc1 lds
    v_mfma_f32_16x16x32_bf16 a[60:63], v[156:159], v[236:239], a[60:63]
    v_exp_f32 v167, v167
    v_mfma_f32_16x16x32_bf16 a[60:63], v[124:127], v[176:179], a[60:63]
    ds_read_b128 v[196:199], v247
    v_cvt_pk_bf16_f32 v235, v166, v167
    v_mfma_f32_16x16x32_bf16 v[160:163], v[32:35], a[208:211], v[212:215]
    v_exp_f32 v168, v168
    v_mfma_f32_16x16x32_bf16 v[160:163], v[36:39], a[212:215], v[160:163]
    buffer_load_dwordx4 v20, s[8:11], s31 offen offset:1024 sc1 lds
    v_mfma_f32_16x16x32_bf16 v[160:163], v[40:43], a[216:219], v[160:163]
    v_exp_f32 v169, v169
    v_mfma_f32_16x16x32_bf16 v[160:163], v[44:47], a[220:223], v[160:163]
    ds_read_b64_tr_b16 a[240:241], v248
    v_cvt_pk_bf16_f32 v236, v168, v169
    v_mfma_f32_16x16x32_bf16 a[64:67], v[128:131], v[180:183], a[64:67]
    v_exp_f32 v170, v170
    v_mfma_f32_16x16x32_bf16 a[64:67], v[96:99], v[232:235], a[64:67]
    buffer_load_dwordx4 v20, s[8:11], s31 offen offset:2048 sc1 lds
    v_mfma_f32_16x16x32_bf16 a[68:71], v[132:135], v[180:183], a[68:71]
    v_exp_f32 v171, v171
    v_mfma_f32_16x16x32_bf16 a[68:71], v[100:103], v[232:235], a[68:71]
    ds_read_b64_tr_b16 a[242:243], v249
    v_cvt_pk_bf16_f32 v237, v170, v171
    v_mfma_f32_16x16x32_bf16 v[164:167], v[48:51], a[208:211], v[212:215]
    v_exp_f32 v172, v172
    v_mfma_f32_16x16x32_bf16 v[164:167], v[52:55], a[212:215], v[164:167]
    buffer_load_dwordx4 v20, s[8:11], s31 offen offset:3072 sc1 lds
    v_mfma_f32_16x16x32_bf16 v[164:167], v[56:59], a[216:219], v[164:167]
    v_exp_f32 v173, v173
    v_mfma_f32_16x16x32_bf16 v[164:167], v[60:63], a[220:223], v[164:167]
    ds_read_b64_tr_b16 a[244:245], v250
    v_cvt_pk_bf16_f32 v238, v172, v173
    v_mfma_f32_16x16x32_bf16 a[72:75], v[136:139], v[180:183], a[72:75]
    s_add_u32 m0, s30, 20480
    v_exp_f32 v174, v174
    v_mfma_f32_16x16x32_bf16 a[72:75], v[104:107], v[232:235], a[72:75]
    buffer_load_dwordx4 v21, s[8:11], s31 offen offset:0 sc1 lds
    v_mfma_f32_16x16x32_bf16 a[76:79], v[140:143], v[180:183], a[76:79]
    v_exp_f32 v175, v175
    v_mfma_f32_16x16x32_bf16 a[76:79], v[108:111], v[232:235], a[76:79]
    ds_read_b64_tr_b16 a[246:247], v251
    v_cvt_pk_bf16_f32 v239, v174, v175
    s_waitcnt lgkmcnt(4)
    s_cmp_ge_u32 s34, 4
    s_cbranch_scc1 L2_lqs_x
    s_cmp_eq_u32 s34, 0
    s_cbranch_scc1 L2_lqs_0
    s_cmp_eq_u32 s34, 1
    s_cbranch_scc1 L2_lqs_1
    s_cmp_eq_u32 s34, 2
    s_cbranch_scc1 L2_lqs_2
    v_mfma_f32_16x16x32_bf16 v[240:243], v[184:187], a[208:211], v[212:215]
    v_mfma_f32_16x16x32_bf16 v[240:243], v[188:191], a[212:215], v[240:243]
    v_mfma_f32_16x16x32_bf16 v[240:243], v[192:195], a[216:219], v[240:243]
    v_mfma_f32_16x16x32_bf16 v[240:243], v[196:199], a[220:223], v[240:243]
    s_branch L2_lqs_x
L2_lqs_2:
    s_nop 4
    v_mfma_f32_16x16x32_bf16 v[240:243], v[184:187], a[192:195], v[208:211]
    v_mfma_f32_16x16x32_bf16 v[240:243], v[188:191], a[196:199], v[240:243]
    v_mfma_f32_16x16x32_bf16 v[240:243], v[192:195], a[200:203], v[240:243]
    v_mfma_f32_16x16x32_bf16 v[240:243], v[196:199], a[204:207], v[240:243]
    s_branch L2_lqs_x
L2_lqs_1:
    s_nop 4
    v_mfma_f32_16x16x32_bf16 v[240:243], v[184:187], a[176:179], v[204:207]
    v_mfma_f32_16x16x32_bf16 v[240:243], v[188:191], a[180:183], v[240:243]
    v_mfma_f32_16x16x32_bf16 v[240:243], v[192:195], a[184:187], v[240:243]
    v_mfma_f32_16x16x32_bf16 v[240:243], v[196:199], a[188:191], v[240:243]
    s_branch L2_lqs_x
L2_lqs_0:
    s_nop 4
    v_mfma_f32_16x16x32_bf16 v[240:243], v[184:187], a[160:163], v[200:203]
    v_mfma_f32_16x16x32_bf16 v[240:243], v[188:191], a[164:167], v[240:243]
    v_mfma_f32_16x16x32_bf16 v[240:243], v[192:195], a[168:171], v[240:243]
    v_mfma_f32_16x16x32_bf16 v[240:243], v[196:199], a[172:175], v[240:243]
L2_lqs_x:
    v_mfma_f32_16x16x32_bf16 v[168:171], v[64:67], a[224:227], v[216:219]
    v_exp_f32 v160, v160
    v_mfma_f32_16x16x32_bf16 v[168:171], v[68:71], a[228:231], v[168:171]
    buffer_load_dwordx4 v21, s[8:11], s31 offen offset:1024 sc1 lds
    v_mfma_f32_16x16x32_bf16 v[168:171], v[72:75], a[232:235], v[168:171]
    v_exp_f32 v161, v161
    v_mfma_f32_16x16x32_bf16 v[168:171], v[76:79], a[236:239], v[168:171]
    ds_read_b64_tr_b16 a[248:249], v252
    v_cvt_pk_bf16_f32 v176, v160, v161
    v_mfma_f32_16x16x32_bf16 a[80:83], v[144:147], v[180:183], a[80:83]
    s_waitcnt vmcnt(18)
    v_exp_f32 v162, v162
    v_mfma_f32_16x16x32_bf16 a[80:83], v[112:115], v[232:235], a[80:83]
    buffer_load_dwordx4 v21, s[8:11], s31 offen offset:2048 sc1 lds
    v_mfma_f32_16x16x32_bf16 a[84:87], v[148:151], v[180:183], a[84:87]
    v_exp_f32 v163, v163
    v_mfma_f32_16x16x32_bf16 a[84:87], v[116:119], v[232:235], a[84:87]
    ds_read_b128 v[64:67], v8 offset:24576
    v_cvt_pk_bf16_f32 v177, v162, v163
    v_mfma_f32_16x16x32_bf16 v[172:175], v[80:83], a[224:227], v[216:219]
    v_exp_f32 v164, v164
    v_mfma_f32_16x16x32_bf16 v[172:175], v[84:87], a[228:231], v[172:175]
    buffer_load_dwordx4 v21, s[8:11], s31 offen offset:3072 sc1 lds
    v_mfma_f32_16x16x32_bf16 v[172:175], v[88:91], a[232:235], v[172:175]
    s_add_u32 s31, s31, 8192
    v_exp_f32 v165, v165
    v_mfma_f32_16x16x32_bf16 v[172:175], v[92:95], a[236:239], v[172:175]
    ds_read_b128 v[68:71], v9 offset:24576
    v_cvt_pk_bf16_f32 v178, v164, v165
    v_mfma_f32_16x16x32_bf16 a[88:91], v[152:155], v[180:183], a[88:91]
    v_exp_f32 v166, v166
    v_mfma_f32_16x16x32_bf16 a[88:91], v[120:123], v[232:235], a[88:91]
    ds_read_b64_tr_b16 a[250:251], v253
    ds_read_b64_tr_b16 a[252:253], v254
    v_mfma_f32_16x16x32_bf16 a[92:95], v[156:159], v[180:183], a[92:95]
    v_exp_f32 v167, v167
    v_mfma_f32_16x16x32_bf16 a[92:95], v[124:127], v[232:235], a[92:95]
    ds_read_b128 v[72:75], v10 offset:24576
    v_cvt_pk_bf16_f32 v179, v166, v167
    v_mfma_f32_16x16x32_bf16 v[160:163], v[32:35], a[224:227], v[216:219]
    v_exp_f32 v168, v168
    v_mfma_f32_16x16x32_bf16 v[160:163], v[36:39], a[228:231], v[160:163]
    ds_read_b128 v[80:83], v8 offset:28672
    ds_read_b128 v[84:87], v9 offset:28672
    v_mfma_f32_16x16x32_bf16 v[160:163], v[40:43], a[232:235], v[160:163]
    v_exp_f32 v169, v169
    v_mfma_f32_16x16x32_bf16 v[160:163], v[44:47], a[236:239], v[160:163]
    ds_read_b128 v[76:79], v11 offset:24576
    v_cvt_pk_bf16_f32 v180, v168, v169
    v_mfma_f32_16x16x32_bf16 a[96:99], v[128:131], v[236:239], a[96:99]
    v_exp_f32 v170, v170
    v_mfma_f32_16x16x32_bf16 a[96:99], v[96:99], v[176:179], a[96:99]
    ds_read_b128 v[88:91], v10 offset:28672
    ds_read_b128 v[92:95], v11 offset:28672
    v_mfma_f32_16x16x32_bf16 a[100:103], v[132:135], v[236:239], a[100:103]
    v_exp_f32 v171, v171
    v_mfma_f32_16x16x32_bf16 a[100:103], v[100:103], v[176:179], a[100:103]
    ds_read_b128 v[32:35], v8 offset:0
    v_cvt_pk_bf16_f32 v181, v170, v171
    v_mfma_f32_16x16x32_bf16 v[164:167], v[48:51], a[224:227], v[216:219]
    v_exp_f32 v172, v172
    v_mfma_f32_16x16x32_bf16 v[164:167], v[52:55], a[228:231], v[164:167]
    ds_read_b64_tr_b16 a[254:255], v255
    v_exp_f32 v240, v240
    v_mfma_f32_16x16x32_bf16 v[164:167], v[56:59], a[232:235], v[164:167]
    v_exp_f32 v173, v173
    v_mfma_f32_16x16x32_bf16 v[164:167], v[60:63], a[236:239], v[164:167]
    ds_read_b128 v[36:39], v9 offset:0
    v_cvt_pk_bf16_f32 v182, v172, v173
    v_mfma_f32_16x16x32_bf16 a[104:107], v[136:139], v[236:239], a[104:107]
    v_exp_f32 v174, v174
    v_mfma_f32_16x16x32_bf16 a[104:107], v[104:107], v[176:179], a[104:107]
    v_exp_f32 v241, v241
    v_exp_f32 v242, v242
    v_mfma_f32_16x16x32_bf16 a[108:111], v[140:143], v[236:239], a[108:111]
    s_waitcnt lgkmcnt(5)
    v_exp_f32 v175, v175
    v_mfma_f32_16x16x32_bf16 a[108:111], v[108:111], v[176:179], a[108:111]
    ds_read_b128 v[40:43], v10 offset:0
    v_cvt_pk_bf16_f32 v183, v174, v175
    v_mfma_f32_16x16x32_bf16 v[168:171], v[64:67], a[160:163], v[200:203]
    v_exp_f32 v160, v160
    v_mfma_f32_16x16x32_bf16 v[168:171], v[68:71], a[164:167], v[168:171]
    ds_read_b128 v[48:51], v8 offset:4096
    ds_read_b128 v[52:55], v9 offset:4096
    v_exp_f32 v243, v243
    v_mfma_f32_16x16x32_bf16 v[168:171], v[72:75], a[168:171], v[168:171]
    v_exp_f32 v161, v161
    v_mfma_f32_16x16x32_bf16 v[168:171], v[76:79], a[172:175], v[168:171]
    ds_read_b128 v[44:47], v11 offset:0
    v_cvt_pk_bf16_f32 v232, v160, v161
    v_mfma_f32_16x16x32_bf16 a[112:115], v[144:147], v[236:239], a[112:115]
    v_exp_f32 v162, v162
    v_mfma_f32_16x16x32_bf16 a[112:115], v[112:115], v[176:179], a[112:115]
    ds_read_b128 v[56:59], v10 offset:4096
    ds_read_b128 v[60:63], v11 offset:4096
    v_cvt_pk_bf16_f32 v240, v240, v241
    v_cvt_pk_bf16_f32 v241, v242, v243
    v_mfma_f32_16x16x32_bf16 a[116:119], v[148:151], v[236:239], a[116:119]
    s_waitcnt lgkmcnt(9)
    v_exp_f32 v163, v163
    v_mfma_f32_16x16x32_bf16 a[116:119], v[116:119], v[176:179], a[116:119]
    v_cvt_pk_bf16_f32 v233, v162, v163
    v_mfma_f32_16x16x32_bf16 v[172:175], v[80:83], a[160:163], v[200:203]
    v_exp_f32 v164, v164
    v_mfma_f32_16x16x32_bf16 v[172:175], v[84:87], a[164:167], v[172:175]
    v_mfma_f32_16x16x32_bf16 v[172:175], v[88:91], a[168:171], v[172:175]
    v_exp_f32 v165, v165
    v_mfma_f32_16x16x32_bf16 v[172:175], v[92:95], a[172:175], v[172:175]
    v_cvt_pk_bf16_f32 v234, v164, v165
    v_mfma_f32_16x16x32_bf16 a[120:123], v[152:155], v[236:239], a[120:123]
    v_exp_f32 v166, v166
    v_mfma_f32_16x16x32_bf16 a[120:123], v[120:123], v[176:179], a[120:123]
    v_mfma_f32_16x16x32_bf16 a[124:127], v[156:159], v[236:239], a[124:127]
    s_waitcnt lgkmcnt(2)
    v_exp_f32 v167, v167
    v_mfma_f32_16x16x32_bf16 a[124:127], v[124:127], v[176:179], a[124:127]
    v_cvt_pk_bf16_f32 v235, v166, v167
    s_waitcnt lgkmcnt(7)
    s_cmp_ge_u32 s34, 4
    s_cbranch_scc1 L2_lvs_x
    s_cmp_eq_u32 s34, 0
    s_cbranch_scc1 L2_lvs_0
    s_cmp_eq_u32 s34, 1
    s_cbranch_scc1 L2_lvs_1
    s_cmp_eq_u32 s34, 2
    s_cbranch_scc1 L2_lvs_2
    v_mfma_f32_16x16x16_bf16 a[96:99], a[240:241], v[240:241], a[96:99]
    v_mfma_f32_16x16x16_bf16 a[100:103], a[242:243], v[240:241], a[100:103]
    v_mfma_f32_16x16x16_bf16 a[104:107], a[244:245], v[240:241], a[104:107]
    v_mfma_f32_16x16x16_bf16 a[108:111], a[246:247], v[240:241], a[108:111]
    v_mfma_f32_16x16x16_bf16 a[112:115], a[248:249], v[240:241], a[112:115]
    v_mfma_f32_16x16x16_bf16 a[116:119], a[250:251], v[240:241], a[116:119]
    v_mfma_f32_16x16x16_bf16 a[120:123], a[252:253], v[240:241], a[120:123]
    v_mfma_f32_16x16x16_bf16 a[124:127], a[254:255], v[240:241], a[124:127]
    s_branch L2_lvs_x
L2_lvs_2:
    v_mfma_f32_16x16x16_bf16 a[64:67], a[240:241], v[240:241], a[64:67]
    v_mfma_f32_16x16x16_bf16 a[68:71], a[242:243], v[240:241], a[68:71]
    v_mfma_f32_16x16x16_bf16 a[72:75], a[244:245], v[240:241], a[72:75]
    v_mfma_f32_16x16x16_bf16 a[76:79], a[246:247], v[240:241], a[76:79]
    v_mfma_f32_16x16x16_bf16 a[80:83], a[248:249], v[240:241], a[80:83]
    v_mfma_f32_16x16x16_bf16 a[84:87], a[250:251], v[240:241], a[84:87]
    v_mfma_f32_16x16x16_bf16 a[88:91], a[252:253], v[240:241], a[88:91]
    v_mfma_f32_16x16x16_bf16 a[92:95], a[254:255], v[240:241], a[92:95]
    s_branch L2_lvs_x
L2_lvs_1:
    v_mfma_f32_16x16x16_bf16 a[32:35], a[240:241], v[240:241], a[32:35]
    v_mfma_f32_16x16x16_bf16 a[36:39], a[242:243], v[240:241], a[36:39]
    v_mfma_f32_16x16x16_bf16 a[40:43], a[244:245], v[240:241], a[40:43]
    v_mfma_f32_16x16x16_bf16 a[44:47], a[246:247], v[240:241], a[44:47]
    v_mfma_f32_16x16x16_bf16 a[48:51], a[248:249], v[240:241], a[48:51]
    v_mfma_f32_16x16x16_bf16 a[52:55], a[250:251], v[240:241], a[52:55]
    v_mfma_f32_16x16x16_bf16 a[56:59], a[252:253], v[240:241], a[56:59]
    v_mfma_f32_16x16x16_bf16 a[60:63], a[254:255], v[240:241], a[60:63]
    s_branch L2_lvs_x
L2_lvs_0:
    v_mfma_f32_16x16x16_bf16 a[0:3], a[240:241], v[240:241], a[0:3]
    v_mfma_f32_16x16x16_bf16 a[4:7], a[242:243], v[240:241], a[4:7]
    v_mfma_f32_16x16x16_bf16 a[8:11], a[244:245], v[240:241], a[8:11]
    v_mfma_f32_16x16x16_bf16 a[12:15], a[246:247], v[240:241], a[12:15]
    v_mfma_f32_16x16x16_bf16 a[16:19], a[248:249], v[240:241], a[16:19]
    v_mfma_f32_16x16x16_bf16 a[20:23], a[250:251], v[240:241], a[20:23]
    v_mfma_f32_16x16x16_bf16 a[24:27], a[252:253], v[240:241], a[24:27]
    v_mfma_f32_16x16x16_bf16 a[28:31], a[254:255], v[240:241], a[28:31]
L2_lvs_x:
.p2align 6
L2_loop_s:
    v_mfma_f32_16x16x32_bf16 v[160:163], v[32:35], a[160:163], v[200:203]
    v_exp_f32 v168, v168
    v_mfma_f32_16x16x32_bf16 v[160:163], v[36:39], a[164:167], v[160:163]
    v_mfma_f32_16x16x32_bf16 v[160:163], v[40:43], a[168:171], v[160:163]
    v_exp_f32 v169, v169
    v_mfma_f32_16x16x32_bf16 v[160:163], v[44:47], a[172:175], v[160:163]
    v_cvt_pk_bf16_f32 v236, v168, v169
    v_mfma_f32_16x16x32_bf16 a[128:131], v[128:131], v[180:183], a[128:131]
    v_exp_f32 v170, v170
    v_mfma_f32_16x16x32_bf16 a[128:131], v[96:99], v[232:235], a[128:131]
    v_mfma_f32_16x16x32_bf16 a[132:135], v[132:135], v[180:183], a[132:135]
    s_waitcnt lgkmcnt(0)
    v_exp_f32 v171, v171
    v_mfma_f32_16x16x32_bf16 a[132:135], v[100:103], v[232:235], a[132:135]
    ds_read_b64_tr_b16 v[128:129], v12 offset:24576
    v_cvt_pk_bf16_f32 v237, v170, v171
    v_mfma_f32_16x16x32_bf16 v[164:167], v[48:51], a[160:163], v[200:203]
    v_exp_f32 v172, v172
    v_mfma_f32_16x16x32_bf16 v[164:167], v[52:55], a[164:167], v[164:167]
    ds_read_b64_tr_b16 v[130:131], v12 offset:28672
    ds_read_b64_tr_b16 v[96:97], v12 offset:0
    v_mfma_f32_16x16x32_bf16 v[164:167], v[56:59], a[168:171], v[164:167]
    v_exp_f32 v173, v173
    v_mfma_f32_16x16x32_bf16 v[164:167], v[60:63], a[172:175], v[164:167]
    ds_read_b64_tr_b16 v[98:99], v12 offset:4096
    v_cvt_pk_bf16_f32 v238, v172, v173
    v_mfma_f32_16x16x32_bf16 a[136:139], v[136:139], v[180:183], a[136:139]
    v_exp_f32 v174, v174
    v_mfma_f32_16x16x32_bf16 a[136:139], v[104:107], v[232:235], a[136:139]
    ds_read_b64_tr_b16 v[132:133], v13 offset:24576
    ds_read_b64_tr_b16 v[134:135], v13 offset:28672
    v_mfma_f32_16x16x32_bf16 a[140:143], v[140:143], v[180:183], a[140:143]
    v_exp_f32 v175, v175
    v_mfma_f32_16x16x32_bf16 a[140:143], v[108:111], v[232:235], a[140:143]
    ds_read_b64_tr_b16 v[100:101], v13 offset:0
    v_cvt_pk_bf16_f32 v239, v174, v175
    v_mfma_f32_16x16x32_bf16 v[168:171], v[64:67], a[176:179], v[204:207]
    v_exp_f32 v160, v160
    v_mfma_f32_16x16x32_bf16 v[168:171], v[68:71], a[180:183], v[168:171]
    ds_read_b64_tr_b16 v[102:103], v13 offset:4096
    ds_read_b64_tr_b16 v[136:137], v14 offset:24576
    v_mfma_f32_16x16x32_bf16 v[168:171], v[72:75], a[184:187], v[168:171]
    v_exp_f32 v161, v161
    v_mfma_f32_16x16x32_bf16 v[168:171], v[76:79], a[188:191], v[168:171]
    ds_read_b64_tr_b16 v[138:139], v14 offset:28672
    v_cvt_pk_bf16_f32 v176, v160, v161
    v_mfma_f32_16x16x32_bf16 a[144:147], v[144:147], v[180:183], a[144:147]
    v_exp_f32 v162, v162
    v_mfma_f32_16x16x32_bf16 a[144:147], v[112:115], v[232:235], a[144:147]
    ds_read_b64_tr_b16 v[104:105], v14 offset:0
    ds_read_b64_tr_b16 v[106:107], v14 offset:4096
    v_mfma_f32_16x16x32_bf16 a[148:151], v[148:151], v[180:183], a[148:151]
    v_exp_f32 v163, v163
    v_mfma_f32_16x16x32_bf16 a[148:151], v[116:119], v[232:235], a[148:151]
    ds_read_b64_tr_b16 v[140:141], v15 offset:24576
    v_cvt_pk_bf16_f32 v177, v162, v163
    v_mfma_f32_16x16x32_bf16 v[172:175], v[80:83], a[176:179], v[204:207]
    v_exp_f32 v164, v164
    v_mfma_f32_16x16x32_bf16 v[172:175], v[84:87], a[180:183], v[172:175]
    ds_read_b64_tr_b16 v[142:143], v15 offset:28672
    ds_read_b64_tr_b16 v[108:109], v15 offset:0
    v_mfma_f32_16x16x32_bf16 v[172:175], v[88:91], a[184:187], v[172:175]
    v_exp_f32 v165, v165
    v_mfma_f32_16x16x32_bf16 v[172:175], v[92:95], a[188:191], v[172:175]
    ds_read_b64_tr_b16 v[110:111], v15 offset:4096
    v_cvt_pk_bf16_f32 v178, v164, v165
    v_mfma_f32_16x16x32_bf16 a[152:155], v[152:155], v[180:183], a[152:155]
    v_exp_f32 v166, v166
    v_mfma_f32_16x16x32_bf16 a[152:155], v[120:123], v[232:235], a[152:155]
    ds_read_b64_tr_b16 v[144:145], v16 offset:24576
    ds_read_b64_tr_b16 v[146:147], v16 offset:28672
    v_mfma_f32_16x16x32_bf16 a[156:159], v[156:159], v[180:183], a[156:159]
    v_exp_f32 v167, v167
    v_mfma_f32_16x16x32_bf16 a[156:159], v[124:127], v[232:235], a[156:159]
    ds_read_b64_tr_b16 v[112:113], v16 offset:0
    v_cvt_pk_bf16_f32 v179, v166, v167
    v_mfma_f32_16x16x32_bf16 v[160:163], v[32:35], a[176:179], v[204:207]
    v_exp_f32 v168, v168
    v_mfma_f32_16x16x32_bf16 v[160:163], v[36:39], a[180:183], v[160:163]
    ds_read_b64_tr_b16 v[114:115], v16 offset:4096
    ds_read_b64_tr_b16 v[148:149], v17 offset:24576
    v_mfma_f32_16x16x32_bf16 v[160:163], v[40:43], a[184:187], v[160:163]
    s_waitcnt lgkmcnt(13)
    v_exp_f32 v169, v169
    v_mfma_f32_16x16x32_bf16 v[160:163], v[44:47], a[188:191], v[160:163]
    ds_read_b64_tr_b16 v[150:151], v17 offset:28672
    v_cvt_pk_bf16_f32 v180, v168, v169
    v_mfma_f32_16x16x32_bf16 a[0:3], v[128:131], v[236:239], a[0:3]
    v_exp_f32 v170, v170
    v_mfma_f32_16x16x32_bf16 a[0:3], v[96:99], v[176:179], a[0:3]
    ds_read_b64_tr_b16 v[116:117], v17 offset:0
    ds_read_b64_tr_b16 v[118:119], v17 offset:4096
    v_mfma_f32_16x16x32_bf16 a[4:7], v[132:135], v[236:239], a[4:7]
    v_exp_f32 v171, v171
    v_mfma_f32_16x16x32_bf16 a[4:7], v[100:103], v[176:179], a[4:7]
    ds_read_b64_tr_b16 v[152:153], v18 offset:24576
    v_cvt_pk_bf16_f32 v181, v170, v171
    v_mfma_f32_16x16x32_bf16 v[164:167], v[48:51], a[176:179], v[204:207]
    v_exp_f32 v172, v172
    v_mfma_f32_16x16x32_bf16 v[164:167], v[52:55], a[180:183], v[164:167]
    ds_read_b64_tr_b16 v[154:155], v18 offset:28672
    ds_read_b64_tr_b16 v[120:121], v18 offset:0
    v_mfma_f32_16x16x32_bf16 v[164:167], v[56:59], a[184:187], v[164:167]
    s_waitcnt lgkmcnt(11)
    v_exp_f32 v173, v173
    v_mfma_f32_16x16x32_bf16 v[164:167], v[60:63], a[188:191], v[164:167]
    ds_read_b64_tr_b16 v[122:123], v18 offset:4096
    v_cvt_pk_bf16_f32 v182, v172, v173
    v_mfma_f32_16x16x32_bf16 a[8:11], v[136:139], v[236:239], a[8:11]
    v_exp_f32 v174, v174
    v_mfma_f32_16x16x32_bf16 a[8:11], v[104:107], v[176:179], a[8:11]
    ds_read_b64_tr_b16 v[156:157], v19 offset:24576
    ds_read_b64_tr_b16 v[158:159], v19 offset:28672
    v_mfma_f32_16x16x32_bf16 a[12:15], v[140:143], v[236:239], a[12:15]
    v_exp_f32 v175, v175
    v_mfma_f32_16x16x32_bf16 a[12:15], v[108:111], v[176:179], a[12:15]
    ds_read_b64_tr_b16 v[124:125], v19 offset:0
    v_cvt_pk_bf16_f32 v183, v174, v175
    v_mfma_f32_16x16x32_bf16 v[168:171], v[64:67], a[192:195], v[208:211]
    v_exp_f32 v160, v160
    v_mfma_f32_16x16x32_bf16 v[168:171], v[68:71], a[196:199], v[168:171]
    ds_read_b64_tr_b16 v[126:127], v19 offset:4096
    v_mfma_f32_16x16x32_bf16 v[168:171], v[72:75], a[200:203], v[168:171]
    s_waitcnt lgkmcnt(8)
    v_exp_f32 v161, v161
    v_mfma_f32_16x16x32_bf16 v[168:171], v[76:79], a[204:207], v[168:171]
    v_cvt_pk_bf16_f32 v232, v160, v161
    v_mfma_f32_16x16x32_bf16 a[16:19], v[144:147], v[236:239], a[16:19]
    v_exp_f32 v162, v162
    v_mfma_f32_16x16x32_bf16 a[16:19], v[112:115], v[176:179], a[16:19]
    v_mfma_f32_16x16x32_bf16 a[20:23], v[148:151], v[236:239], a[20:23]
    v_exp_f32 v163, v163
    v_mfma_f32_16x16x32_bf16 a[20:23], v[116:119], v[176:179], a[20:23]
    v_cvt_pk_bf16_f32 v233, v162, v163
    v_mfma_f32_16x16x32_bf16 v[172:175], v[80:83], a[192:195], v[208:211]
    v_exp_f32 v164, v164
    v_mfma_f32_16x16x32_bf16 v[172:175], v[84:87], a[196:199], v[172:175]
    v_mfma_f32_16x16x32_bf16 v[172:175], v[88:91], a[200:203], v[172:175]
    s_waitcnt lgkmcnt(0)
    v_exp_f32 v165, v165
    v_mfma_f32_16x16x32_bf16 v[172:175], v[92:95], a[204:207], v[172:175]
    v_cvt_pk_bf16_f32 v234, v164, v165
    v_mfma_f32_16x16x32_bf16 a[24:27], v[152:155], v[236:239], a[24:27]
    s_add_u32 m0, s30, 24576
    v_exp_f32 v166, v166
    v_mfma_f32_16x16x32_bf16 a[24:27], v[120:123], v[176:179], a[24:27]
    buffer_load_dwordx4 v20, s[8:11], s31 offen offset:0 sc1 lds
    v_mfma_f32_16x16x32_bf16 a[28:31], v[156:159], v[236:239], a[28:31]
    v_exp_f32 v167, v167
    v_mfma_f32_16x16x32_bf16 a[28:31], v[124:127], v[176:179], a[28:31]
    v_cvt_pk_bf16_f32 v235, v166, v167
    v_mfma_f32_16x16x32_bf16 v[160:163], v[32:35], a[192:195], v[208:211]
    v_exp_f32 v168, v168
    v_mfma_f32_16x16x32_bf16 v[160:163], v[36:39], a[196:199], v[160:163]
    buffer_load_dwordx4 v20, s[8:11], s31 offen offset:1024 sc1 lds
    v_mfma_f32_16x16x32_bf16 v[160:163], v[40:43], a[200:203], v[160:163]
    v_exp_f32 v169, v169
    v_mfma_f32_16x16x32_bf16 v[160:163], v[44:47], a[204:207], v[160:163]
    v_cvt_pk_bf16_f32 v236, v168, v169
    v_mfma_f32_16x16x32_bf16 a[32:35], v[128:131], v[180:183], a[32:35]
    v_exp_f32 v170, v170
    v_mfma_f32_16x16x32_bf16 a[32:35], v[96:99], v[232:235], a[32:35]
    buffer_load_dwordx4 v20, s[8:11], s31 offen offset:2048 sc1 lds
    v_mfma_f32_16x16x32_bf16 a[36:39], v[132:135], v[180:183], a[36:39]
    v_exp_f32 v171, v171
    v_mfma_f32_16x16x32_bf16 a[36:39], v[100:103], v[232:235], a[36:39]
    v_cvt_pk_bf16_f32 v237, v170, v171
    v_mfma_f32_16x16x32_bf16 v[164:167], v[48:51], a[192:195], v[208:211]
    v_exp_f32 v172, v172
    v_mfma_f32_16x16x32_bf16 v[164:167], v[52:55], a[196:199], v[164:167]
    buffer_load_dwordx4 v20, s[8:11], s31 offen offset:3072 sc1 lds
    v_mfma_f32_16x16x32_bf16 v[164:167], v[56:59], a[200:203], v[164:167]
    v_exp_f32 v173, v173
    v_mfma_f32_16x16x32_bf16 v[164:167], v[60:63], a[204:207], v[164:167]
    v_cvt_pk_bf16_f32 v238, v172, v173
    v_mfma_f32_16x16x32_bf16 a[40:43], v[136:139], v[180:183], a[40:43]
    s_add_u32 m0, s30, 28672
    v_exp_f32 v174, v174
    v_mfma_f32_16x16x32_bf16 a[40:43], v[104:107], v[232:235], a[40:43]
    buffer_load_dwordx4 v21, s[8:11], s31 offen offset:0 sc1 lds
    v_mfma_f32_16x16x32_bf16 a[44:47], v[140:143], v[180:183], a[44:47]
    v_exp_f32 v175, v175
    v_mfma_f32_16x16x32_bf16 a[44:47], v[108:111], v[232:235], a[44:47]
    v_cvt_pk_bf16_f32 v239, v174, v175
    v_mfma_f32_16x16x32_bf16 v[168:171], v[64:67], a[208:211], v[212:215]
    v_exp_f32 v160, v160
    v_mfma_f32_16x16x32_bf16 v[168:171], v[68:71], a[212:215], v[168:171]
    buffer_load_dwordx4 v21, s[8:11], s31 offen offset:1024 sc1 lds
    v_mfma_f32_16x16x32_bf16 v[168:171], v[72:75], a[216:219], v[168:171]
    v_exp_f32 v161, v161
    v_mfma_f32_16x16x32_bf16 v[168:171], v[76:79], a[220:223], v[168:171]
    v_cvt_pk_bf16_f32 v176, v160, v161
    v_mfma_f32_16x16x32_bf16 a[48:51], v[144:147], v[180:183], a[48:51]
    v_exp_f32 v162, v162
    v_mfma_f32_16x16x32_bf16 a[48:51], v[112:115], v[232:235], a[48:51]
    buffer_load_dwordx4 v21, s[8:11], s31 offen offset:2048 sc1 lds
    v_mfma_f32_16x16x32_bf16 a[52:55], v[148:151], v[180:183], a[52:55]
    v_exp_f32 v163, v163
    v_mfma_f32_16x16x32_bf16 a[52:55], v[116:119], v[232:235], a[52:55]
    v_cvt_pk_bf16_f32 v177, v162, v163
    v_mfma_f32_16x16x32_bf16 v[172:175], v[80:83], a[208:211], v[212:215]
    v_exp_f32 v164, v164
    v_mfma_f32_16x16x32_bf16 v[172:175], v[84:87], a[212:215], v[172:175]
    buffer_load_dwordx4 v21, s[8:11], s31 offen offset:3072 sc1 lds
    v_mfma_f32_16x16x32_bf16 v[172:175], v[88:91], a[216:219], v[172:175]
    s_add_u32 s31, s31, 8192
    v_exp_f32 v165, v165
    v_mfma_f32_16x16x32_bf16 v[172:175], v[92:95], a[220:223], v[172:175]
    v_cvt_pk_bf16_f32 v178, v164, v165
    v_mfma_f32_16x16x32_bf16 a[56:59], v[152:155], v[180:183], a[56:59]
    s_add_u32 m0, s30, 0
    v_exp_f32 v166, v166
    v_mfma_f32_16x16x32_bf16 a[56:59], v[120:123], v[232:235], a[56:59]
    buffer_load_dwordx4 v20, s[8:11], s31 offen offset:0 sc1 lds
    v_mfma_f32_16x16x32_bf16 a[60:63], v[156:159], v[180:183], a[60:63]
    v_exp_f32 v167, v167
    v_mfma_f32_16x16x32_bf16 a[60:63], v[124:127], v[232:235], a[60:63]
    v_cvt_pk_bf16_f32 v179, v166, v167
    v_mfma_f32_16x16x32_bf16 v[160:163], v[32:35], a[208:211], v[212:215]
    v_exp_f32 v168, v168
    v_mfma_f32_16x16x32_bf16 v[160:163], v[36:39], a[212:215], v[160:163]
    buffer_load_dwordx4 v20, s[8:11], s31 offen offset:1024 sc1 lds
    v_mfma_f32_16x16x32_bf16 v[160:163], v[40:43], a[216:219], v[160:163]
    v_exp_f32 v169, v169
    v_mfma_f32_16x16x32_bf16 v[160:163], v[44:47], a[220:223], v[160:163]
    v_cvt_pk_bf16_f32 v180, v168, v169
    v_mfma_f32_16x16x32_bf16 a[64:67], v[128:131], v[236:239], a[64:67]
    v_exp_f32 v170, v170
    v_mfma_f32_16x16x32_bf16 a[64:67], v[96:99], v[176:179], a[64:67]
    buffer_load_dwordx4 v20, s[8:11], s31 offen offset:2048 sc1 lds
    v_mfma_f32_16x16x32_bf16 a[68:71], v[132:135], v[236:239], a[68:71]
    v_exp_f32 v171, v171
    v_mfma_f32_16x16x32_bf16 a[68:71], v[100:103], v[176:179], a[68:71]
    v_cvt_pk_bf16_f32 v181, v170, v171
    v_mfma_f32_16x16x32_bf16 v[164:167], v[48:51], a[208:211], v[212:215]
    v_exp_f32 v172, v172
    v_mfma_f32_16x16x32_bf16 v[164:167], v[52:55], a[212:215], v[164:167]
    buffer_load_dwordx4 v20, s[8:11], s31 offen offset:3072 sc1 lds
    v_mfma_f32_16x16x32_bf16 v[164:167], v[56:59], a[216:219], v[164:167]
    v_exp_f32 v173, v173
    v_mfma_f32_16x16x32_bf16 v[164:167], v[60:63], a[220:223], v[164:167]
    v_cvt_pk_bf16_f32 v182, v172, v173
    v_mfma_f32_16x16x32_bf16 a[72:75], v[136:139], v[236:239], a[72:75]
    s_add_u32 m0, s30, 4096
    v_exp_f32 v174, v174
    v_mfma_f32_16x16x32_bf16 a[72:75], v[104:107], v[176:179], a[72:75]
    buffer_load_dwordx4 v21, s[8:11], s31 offen offset:0 sc1 lds
    v_mfma_f32_16x16x32_bf16 a[76:79], v[140:143], v[236:239], a[76:79]
    v_exp_f32 v175, v175
    v_mfma_f32_16x16x32_bf16 a[76:79], v[108:111], v[176:179], a[76:79]
    v_cvt_pk_bf16_f32 v183, v174, v175
    v_mfma_f32_16x16x32_bf16 v[168:171], v[64:67], a[224:227], v[216:219]
    v_exp_f32 v160, v160
    v_mfma_f32_16x16x32_bf16 v[168:171], v[68:71], a[228:231], v[168:171]
    buffer_load_dwordx4 v21, s[8:11], s31 offen offset:1024 sc1 lds
    v_mfma_f32_16x16x32_bf16 v[168:171], v[72:75], a[232:235], v[168:171]
    v_exp_f32 v161, v161
    v_mfma_f32_16x16x32_bf16 v[168:171], v[76:79], a[236:239], v[168:171]
    v_cvt_pk_bf16_f32 v232, v160, v161
    v_mfma_f32_16x16x32_bf16 a[80:83], v[144:147], v[236:239], a[80:83]
    s_waitcnt vmcnt(14)
    v_exp_f32 v162, v162
    v_mfma_f32_16x16x32_bf16 a[80:83], v[112:115], v[176:179], a[80:83]
    buffer_load_dwordx4 v21, s[8:11], s31 offen offset:2048 sc1 lds
    v_mfma_f32_16x16x32_bf16 a[84:87], v[148:151], v[236:239], a[84:87]
    v_exp_f32 v163, v163
    v_mfma_f32_16x16x32_bf16 a[84:87], v[116:119], v[176:179], a[84:87]
    ds_read_b128 v[64:67], v8 offset:8192
    v_cvt_pk_bf16_f32 v233, v162, v163
    v_mfma_f32_16x16x32_bf16 v[172:175], v[80:83], a[224:227], v[216:219]
    v_exp_f32 v164, v164
    v_mfma_f32_16x16x32_bf16 v[172:175], v[84:87], a[228:231], v[172:175]
    buffer_load_dwordx4 v21, s[8:11], s31 offen offset:3072 sc1 lds
    v_mfma_f32_16x16x32_bf16 v[172:175], v[88:91], a[232:235], v[172:175]
    s_add_u32 s31, s31, 8192
    v_exp_f32 v165, v165
    v_mfma_f32_16x16x32_bf16 v[172:175], v[92:95], a[236:239], v[172:175]
    ds_read_b128 v[68:71], v9 offset:8192
    v_cvt_pk_bf16_f32 v234, v164, v165
    v_mfma_f32_16x16x32_bf16 a[88:91], v[152:155], v[236:239], a[88:91]
    v_exp_f32 v166, v166
    v_mfma_f32_16x16x32_bf16 a[88:91], v[120:123], v[176:179], a[88:91]
    v_mfma_f32_16x16x32_bf16 a[92:95], v[156:159], v[236:239], a[92:95]
    v_exp_f32 v167, v167
    v_mfma_f32_16x16x32_bf16 a[92:95], v[124:127], v[176:179], a[92:95]
    ds_read_b128 v[72:75], v10 offset:8192
    v_cvt_pk_bf16_f32 v235, v166, v167
    v_mfma_f32_16x16x32_bf16 v[160:163], v[32:35], a[224:227], v[216:219]
    v_exp_f32 v168, v168
    v_mfma_f32_16x16x32_bf16 v[160:163], v[36:39], a[228:231], v[160:163]
    ds_read_b128 v[80:83], v8 offset:12288
    ds_read_b128 v[84:87], v9 offset:12288
    v_mfma_f32_16x16x32_bf16 v[160:163], v[40:43], a[232:235], v[160:163]
    v_exp_f32 v169, v169
    v_mfma_f32_16x16x32_bf16 v[160:163], v[44:47], a[236:239], v[160:163]
    ds_read_b128 v[76:79], v11 offset:8192
    v_cvt_pk_bf16_f32 v236, v168, v169
    v_mfma_f32_16x16x32_bf16 a[96:99], v[128:131], v[180:183], a[96:99]
    v_exp_f32 v170, v170
    v_mfma_f32_16x16x32_bf16 a[96:99], v[96:99], v[232:235], a[96:99]
    ds_read_b128 v[88:91], v10 offset:12288
    ds_read_b128 v[92:95], v11 offset:12288
    v_mfma_f32_16x16x32_bf16 a[100:103], v[132:135], v[180:183], a[100:103]
    v_exp_f32 v171, v171
    v_mfma_f32_16x16x32_bf16 a[100:103], v[100:103], v[232:235], a[100:103]
    ds_read_b128 v[32:35], v8 offset:16384
    v_cvt_pk_bf16_f32 v237, v170, v171
    v_mfma_f32_16x16x32_bf16 v[164:167], v[48:51], a[224:227], v[216:219]
    v_exp_f32 v172, v172
    v_mfma_f32_16x16x32_bf16 v[164:167], v[52:55], a[228:231], v[164:167]
    v_mfma_f32_16x16x32_bf16 v[164:167], v[56:59], a[232:235], v[164:167]
    v_exp_f32 v173, v173
    v_mfma_f32_16x16x32_bf16 v[164:167], v[60:63], a[236:239], v[164:167]
    ds_read_b128 v[36:39], v9 offset:16384
    v_cvt_pk_bf16_f32 v238, v172, v173
    v_mfma_f32_16x16x32_bf16 a[104:107], v[136:139], v[180:183], a[104:107]
    v_exp_f32 v174, v174
    v_mfma_f32_16x16x32_bf16 a[104:107], v[104:107], v[232:235], a[104:107]
    v_mfma_f32_16x16x32_bf16 a[108:111], v[140:143], v[180:183], a[108:111]
    s_waitcnt lgkmcnt(4)
    v_exp_f32 v175, v175
    v_mfma_f32_16x16x32_bf16 a[108:111], v[108:111], v[232:235], a[108:111]
    ds_read_b128 v[40:43], v10 offset:16384
    v_cvt_pk_bf16_f32 v239, v174, v175
    v_mfma_f32_16x16x32_bf16 v[168:171], v[64:67], a[160:163], v[200:203]
    v_exp_f32 v160, v160
    v_mfma_f32_16x16x32_bf16 v[168:171], v[68:71], a[164:167], v[168:171]
    ds_read_b128 v[48:51], v8 offset:20480
    ds_read_b128 v[52:55], v9 offset:20480
    v_mfma_f32_16x16x32_bf16 v[168:171], v[72:75], a[168:171], v[168:171]
    v_exp_f32 v161, v161
    v_mfma_f32_16x16x32_bf16 v[168:171], v[76:79], a[172:175], v[168:171]
    ds_read_b128 v[44:47], v11 offset:16384
    v_cvt_pk_bf16_f32 v176, v160, v161
    v_mfma_f32_16x16x32_bf16 a[112:115], v[144:147], v[180:183], a[112:115]
    v_exp_f32 v162, v162
    v_mfma_f32_16x16x32_bf16 a[112:115], v[112:115], v[232:235], a[112:115]
    ds_read_b128 v[56:59], v10 offset:20480
    ds_read_b128 v[60:63], v11 offset:20480
    v_mfma_f32_16x16x32_bf16 a[116:119], v[148:151], v[180:183], a[116:119]
    s_waitcnt lgkmcnt(8)
    v_exp_f32 v163, v163
    v_mfma_f32_16x16x32_bf16 a[116:119], v[116:119], v[232:235], a[116:119]
    v_cvt_pk_bf16_f32 v177, v162, v163
    v_mfma_f32_16x16x32_bf16 v[172:175], v[80:83], a[160:163], v[200:203]
    v_exp_f32 v164, v164
    v_mfma_f32_16x16x32_bf16 v[172:175], v[84:87], a[164:167], v[172:175]
    v_mfma_f32_16x16x32_bf16 v[172:175], v[88:91], a[168:171], v[172:175]
    v_exp_f32 v165, v165
    v_mfma_f32_16x16x32_bf16 v[172:175], v[92:95], a[172:175], v[172:175]
    v_cvt_pk_bf16_f32 v178, v164, v165
    v_mfma_f32_16x16x32_bf16 a[120:123], v[152:155], v[180:183], a[120:123]
    v_exp_f32 v166, v166
    v_mfma_f32_16x16x32_bf16 a[120:123], v[120:123], v[232:235], a[120:123]
    v_mfma_f32_16x16x32_bf16 a[124:127], v[156:159], v[180:183], a[124:127]
    s_waitcnt lgkmcnt(2)
    v_exp_f32 v167, v167
    v_mfma_f32_16x16x32_bf16 a[124:127], v[124:127], v[232:235], a[124:127]
    v_cvt_pk_bf16_f32 v179, v166, v167
    v_mfma_f32_16x16x32_bf16 v[160:163], v[32:35], a[160:163], v[200:203]
    v_exp_f32 v168, v168
    v_mfma_f32_16x16x32_bf16 v[160:163], v[36:39], a[164:167], v[160:163]
    v_mfma_f32_16x16x32_bf16 v[160:163], v[40:43], a[168:171], v[160:163]
    v_exp_f32 v169, v169
    v_mfma_f32_16x16x32_bf16 v[160:163], v[44:47], a[172:175], v[160:163]
    v_cvt_pk_bf16_f32 v180, v168, v169
    v_mfma_f32_16x16x32_bf16 a[128:131], v[128:131], v[236:239], a[128:131]
    v_exp_f32 v170, v170
    v_mfma_f32_16x16x32_bf16 a[128:131], v[96:99], v[176:179], a[128:131]
    v_mfma_f32_16x16x32_bf16 a[132:135], v[132:135], v[236:239], a[132:135]
    s_waitcnt lgkmcnt(0)
    v_exp_f32 v171, v171
    v_mfma_f32_16x16x32_bf16 a[132:135], v[100:103], v[176:179], a[132:135]
    ds_read_b64_tr_b16 v[128:129], v12 offset:8192
    v_cvt_pk_bf16_f32 v181, v170, v171
    v_mfma_f32_16x16x32_bf16 v[164:167], v[48:51], a[160:163], v[200:203]
    v_exp_f32 v172, v172
    v_mfma_f32_16x16x32_bf16 v[164:167], v[52:55], a[164:167], v[164:167]
    ds_read_b64_tr_b16 v[130:131], v12 offset:12288
    ds_read_b64_tr_b16 v[96:97], v12 offset:16384
    v_mfma_f32_16x16x32_bf16 v[164:167], v[56:59], a[168:171], v[164:167]
    v_exp_f32 v173, v173
    v_mfma_f32_16x16x32_bf16 v[164:167], v[60:63], a[172:175], v[164:167]
    ds_read_b64_tr_b16 v[98:99], v12 offset:20480
    v_cvt_pk_bf16_f32 v182, v172, v173
    v_mfma_f32_16x16x32_bf16 a[136:139], v[136:139], v[236:239], a[136:139]
    v_exp_f32 v174, v174
    v_mfma_f32_16x16x32_bf16 a[136:139], v[104:107], v[176:179], a[136:139]
    ds_read_b64_tr_b16 v[132:133], v13 offset:8192
    ds_read_b64_tr_b16 v[134:135], v13 offset:12288
    v_mfma_f32_16x16x32_bf16 a[140:143], v[140:143], v[236:239], a[140:143]
    v_exp_f32 v175, v175
    v_mfma_f32_16x16x32_bf16 a[140:143], v[108:111], v[176:179], a[140:143]
    ds_read_b64_tr_b16 v[100:101], v13 offset:16384
    v_cvt_pk_bf16_f32 v183, v174, v175
    v_mfma_f32_16x16x32_bf16 v[168:171], v[64:67], a[176:179], v[204:207]
    v_exp_f32 v160, v160
    v_mfma_f32_16x16x32_bf16 v[168:171], v[68:71], a[180:183], v[168:171]
    ds_read_b64_tr_b16 v[102:103], v13 offset:20480
    ds_read_b64_tr_b16 v[136:137], v14 offset:8192
    v_mfma_f32_16x16x32_bf16 v[168:171], v[72:75], a[184:187], v[168:171]
    v_exp_f32 v161, v161
    v_mfma_f32_16x16x32_bf16 v[168:171], v[76:79], a[188:191], v[168:171]
    ds_read_b64_tr_b16 v[138:139], v14 offset:12288
    v_cvt_pk_bf16_f32 v232, v160, v161
    v_mfma_f32_16x16x32_bf16 a[144:147], v[144:147], v[236:239], a[144:147]
    v_exp_f32 v162, v162
    v_mfma_f32_16x16x32_bf16 a[144:147], v[112:115], v[176:179], a[144:147]
    ds_read_b64_tr_b16 v[104:105], v14 offset:16384
    ds_read_b64_tr_b16 v[106:107], v14 offset:20480
    v_mfma_f32_16x16x32_bf16 a[148:151], v[148:151], v[236:239], a[148:151]
    v_exp_f32 v163, v163
    v_mfma_f32_16x16x32_bf16 a[148:151], v[116:119], v[176:179], a[148:151]
    ds_read_b64_tr_b16 v[140:141], v15 offset:8192
    v_cvt_pk_bf16_f32 v233, v162, v163
    v_mfma_f32_16x16x32_bf16 v[172:175], v[80:83], a[176:179], v[204:207]
    v_exp_f32 v164, v164
    v_mfma_f32_16x16x32_bf16 v[172:175], v[84:87], a[180:183], v[172:175]
    ds_read_b64_tr_b16 v[142:143], v15 offset:12288
    ds_read_b64_tr_b16 v[108:109], v15 offset:16384
    v_mfma_f32_16x16x32_bf16 v[172:175], v[88:91], a[184:187], v[172:175]
    v_exp_f32 v165, v165
    v_mfma_f32_16x16x32_bf16 v[172:175], v[92:95], a[188:191], v[172:175]
    ds_read_b64_tr_b16 v[110:111], v15 offset:20480
    v_cvt_pk_bf16_f32 v234, v164, v165
    v_mfma_f32_16x16x32_bf16 a[152:155], v[152:155], v[236:239], a[152:155]
    v_exp_f32 v166, v166
    v_mfma_f32_16x16x32_bf16 a[152:155], v[120:123], v[176:179], a[152:155]
    ds_read_b64_tr_b16 v[144:145], v16 offset:8192
    ds_read_b64_tr_b16 v[146:147], v16 offset:12288
    v_mfma_f32_16x16x32_bf16 a[156:159], v[156:159], v[236:239], a[156:159]
    v_exp_f32 v167, v167
    v_mfma_f32_16x16x32_bf16 a[156:159], v[124:127], v[176:179], a[156:159]
    ds_read_b64_tr_b16 v[112:113], v16 offset:16384
    v_cvt_pk_bf16_f32 v235, v166, v167
    v_mfma_f32_16x16x32_bf16 v[160:163], v[32:35], a[176:179], v[204:207]
    v_exp_f32 v168, v168
    v_mfma_f32_16x16x32_bf16 v[160:163], v[36:39], a[180:183], v[160:163]
    ds_read_b64_tr_b16 v[114:115], v16 offset:20480
    ds_read_b64_tr_b16 v[148:149], v17 offset:8192
    v_mfma_f32_16x16x32_bf16 v[160:163], v[40:43], a[184:187], v[160:163]
    s_waitcnt lgkmcnt(13)
    v_exp_f32 v169, v169
    v_mfma_f32_16x16x32_bf16 v[160:163], v[44:47], a[188:191], v[160:163]
    ds_read_b64_tr_b16 v[150:151], v17 offset:12288
    v_cvt_pk_bf16_f32 v236, v168, v169
    v_mfma_f32_16x16x32_bf16 a[0:3], v[128:131], v[180:183], a[0:3]
    v_exp_f32 v170, v170
    v_mfma_f32_16x16x32_bf16 a[0:3], v[96:99], v[232:235], a[0:3]
    ds_read_b64_tr_b16 v[116:117], v17 offset:16384
    ds_read_b64_tr_b16 v[118:119], v17 offset:20480
    v_mfma_f32_16x16x32_bf16 a[4:7], v[132:135], v[180:183], a[4:7]
    v_exp_f32 v171, v171
    v_mfma_f32_16x16x32_bf16 a[4:7], v[100:103], v[232:235], a[4:7]
    ds_read_b64_tr_b16 v[152:153], v18 offset:8192
    v_cvt_pk_bf16_f32 v237, v170, v171
    v_mfma_f32_16x16x32_bf16 v[164:167], v[48:51], a[176:179], v[204:207]
    v_exp_f32 v172, v172
    v_mfma_f32_16x16x32_bf16 v[164:167], v[52:55], a[180:183], v[164:167]
    ds_read_b64_tr_b16 v[154:155], v18 offset:12288
    ds_read_b64_tr_b16 v[120:121], v18 offset:16384
    v_mfma_f32_16x16x32_bf16 v[164:167], v[56:59], a[184:187], v[164:167]
    s_waitcnt lgkmcnt(11)
    v_exp_f32 v173, v173
    v_mfma_f32_16x16x32_bf16 v[164:167], v[60:63], a[188:191], v[164:167]
    ds_read_b64_tr_b16 v[122:123], v18 offset:20480
    v_cvt_pk_bf16_f32 v238, v172, v173
    v_mfma_f32_16x16x32_bf16 a[8:11], v[136:139], v[180:183], a[8:11]
    v_exp_f32 v174, v174
    v_mfma_f32_16x16x32_bf16 a[8:11], v[104:107], v[232:235], a[8:11]
    ds_read_b64_tr_b16 v[156:157], v19 offset:8192
    ds_read_b64_tr_b16 v[158:159], v19 offset:12288
    v_mfma_f32_16x16x32_bf16 a[12:15], v[140:143], v[180:183], a[12:15]
    v_exp_f32 v175, v175
    v_mfma_f32_16x16x32_bf16 a[12:15], v[108:111], v[232:235], a[12:15]
    ds_read_b64_tr_b16 v[124:125], v19 offset:16384
    v_cvt_pk_bf16_f32 v239, v174, v175
    v_mfma_f32_16x16x32_bf16 v[168:171], v[64:67], a[192:195], v[208:211]
    v_exp_f32 v160, v160
    v_mfma_f32_16x16x32_bf16 v[168:171], v[68:71], a[196:199], v[168:171]
    ds_read_b64_tr_b16 v[126:127], v19 offset:20480
    v_mfma_f32_16x16x32_bf16 v[168:171], v[72:75], a[200:203], v[168:171]
    s_waitcnt lgkmcnt(8)
    v_exp_f32 v161, v161
    v_mfma_f32_16x16x32_bf16 v[168:171], v[76:79], a[204:207], v[168:171]
    v_cvt_pk_bf16_f32 v176, v160, v161
    v_mfma_f32_16x16x32_bf16 a[16:19], v[144:147], v[180:183], a[16:19]
    v_exp_f32 v162, v162
    v_mfma_f32_16x16x32_bf16 a[16:19], v[112:115], v[232:235], a[16:19]
    buffer_load_dwordx4 v[240:243], v22, s[12:15], s58 offen sc1
    v_mfma_f32_16x16x32_bf16 a[20:23], v[148:151], v[180:183], a[20:23]
    v_exp_f32 v163, v163
    v_mfma_f32_16x16x32_bf16 a[20:23], v[116:119], v[232:235], a[20:23]
    v_cvt_pk_bf16_f32 v177, v162, v163
    v_mfma_f32_16x16x32_bf16 v[172:175], v[80:83], a[192:195], v[208:211]
    v_exp_f32 v164, v164
    v_mfma_f32_16x16x32_bf16 v[172:175], v[84:87], a[196:199], v[172:175]
    v_mfma_f32_16x16x32_bf16 v[172:175], v[88:91], a[200:203], v[172:175]
    s_waitcnt lgkmcnt(0)
    v_exp_f32 v165, v165
    v_mfma_f32_16x16x32_bf16 v[172:175], v[92:95], a[204:207], v[172:175]
    v_cvt_pk_bf16_f32 v178, v164, v165
    v_mfma_f32_16x16x32_bf16 a[24:27], v[152:155], v[180:183], a[24:27]
    s_add_u32 m0, s30, 8192
    v_exp_f32 v166, v166
    v_mfma_f32_16x16x32_bf16 a[24:27], v[120:123], v[232:235], a[24:27]
    buffer_load_dwordx4 v20, s[8:11], s31 offen offset:0 sc1 lds
    v_mfma_f32_16x16x32_bf16 a[28:31], v[156:159], v[180:183], a[28:31]
    v_exp_f32 v167, v167
    v_mfma_f32_16x16x32_bf16 a[28:31], v[124:127], v[232:235], a[28:31]
    v_cvt_pk_bf16_f32 v179, v166, v167
    v_mfma_f32_16x16x32_bf16 v[160:163], v[32:35], a[192:195], v[208:211]
    v_exp_f32 v168, v168
    v_mfma_f32_16x16x32_bf16 v[160:163], v[36:39], a[196:199], v[160:163]
    buffer_load_dwordx4 v20, s[8:11], s31 offen offset:1024 sc1 lds
    v_mfma_f32_16x16x32_bf16 v[160:163], v[40:43], a[200:203], v[160:163]
    v_exp_f32 v169, v169
    v_mfma_f32_16x16x32_bf16 v[160:163], v[44:47], a[204:207], v[160:163]
    v_cvt_pk_bf16_f32 v180, v168, v169
    v_mfma_f32_16x16x32_bf16 a[32:35], v[128:131], v[236:239], a[32:35]
    v_exp_f32 v170, v170
    v_mfma_f32_16x16x32_bf16 a[32:35], v[96:99], v[176:179], a[32:35]
    buffer_load_dwordx4 v20, s[8:11], s31 offen offset:2048 sc1 lds
    v_mfma_f32_16x16x32_bf16 a[36:39], v[132:135], v[236:239], a[36:39]
    v_exp_f32 v171, v171
    v_mfma_f32_16x16x32_bf16 a[36:39], v[100:103], v[176:179], a[36:39]
    v_cvt_pk_bf16_f32 v181, v170, v171
    v_mfma_f32_16x16x32_bf16 v[164:167], v[48:51], a[192:195], v[208:211]
    v_exp_f32 v172, v172
    v_mfma_f32_16x16x32_bf16 v[164:167], v[52:55], a[196:199], v[164:167]
    buffer_load_dwordx4 v20, s[8:11], s31 offen offset:3072 sc1 lds
    v_mfma_f32_16x16x32_bf16 v[164:167], v[56:59], a[200:203], v[164:167]
    v_exp_f32 v173, v173
    v_mfma_f32_16x16x32_bf16 v[164:167], v[60:63], a[204:207], v[164:167]
    v_cvt_pk_bf16_f32 v182, v172, v173
    v_mfma_f32_16x16x32_bf16 a[40:43], v[136:139], v[236:239], a[40:43]
    s_add_u32 m0, s30, 12288
    v_exp_f32 v174, v174
    v_mfma_f32_16x16x32_bf16 a[40:43], v[104:107], v[176:179], a[40:43]
    buffer_load_dwordx4 v21, s[8:11], s31 offen offset:0 sc1 lds
    v_mfma_f32_16x16x32_bf16 a[44:47], v[140:143], v[236:239], a[44:47]
    v_exp_f32 v175, v175
    v_mfma_f32_16x16x32_bf16 a[44:47], v[108:111], v[176:179], a[44:47]
    v_cvt_pk_bf16_f32 v183, v174, v175
    v_mfma_f32_16x16x32_bf16 v[168:171], v[64:67], a[208:211], v[212:215]
    v_exp_f32 v160, v160
    v_mfma_f32_16x16x32_bf16 v[168:171], v[68:71], a[212:215], v[168:171]
    buffer_load_dwordx4 v21, s[8:11], s31 offen offset:1024 sc1 lds
    v_mfma_f32_16x16x32_bf16 v[168:171], v[72:75], a[216:219], v[168:171]
    v_exp_f32 v161, v161
    v_mfma_f32_16x16x32_bf16 v[168:171], v[76:79], a[220:223], v[168:171]
    v_cvt_pk_bf16_f32 v232, v160, v161
    v_mfma_f32_16x16x32_bf16 a[48:51], v[144:147], v[236:239], a[48:51]
    v_exp_f32 v162, v162
    v_mfma_f32_16x16x32_bf16 a[48:51], v[112:115], v[176:179], a[48:51]
    buffer_load_dwordx4 v21, s[8:11], s31 offen offset:2048 sc1 lds
    v_mfma_f32_16x16x32_bf16 a[52:55], v[148:151], v[236:239], a[52:55]
    v_exp_f32 v163, v163
    v_mfma_f32_16x16x32_bf16 a[52:55], v[116:119], v[176:179], a[52:55]
    v_cvt_pk_bf16_f32 v233, v162, v163
    v_mfma_f32_16x16x32_bf16 v[172:175], v[80:83], a[208:211], v[212:215]
    v_exp_f32 v164, v164
    v_mfma_f32_16x16x32_bf16 v[172:175], v[84:87], a[212:215], v[172:175]
    buffer_load_dwordx4 v21, s[8:11], s31 offen offset:3072 sc1 lds
    v_mfma_f32_16x16x32_bf16 v[172:175], v[88:91], a[216:219], v[172:175]
    s_add_u32 s31, s31, 8192
    v_exp_f32 v165, v165
    v_mfma_f32_16x16x32_bf16 v[172:175], v[92:95], a[220:223], v[172:175]
    v_cvt_pk_bf16_f32 v234, v164, v165
    v_mfma_f32_16x16x32_bf16 a[56:59], v[152:155], v[236:239], a[56:59]
    s_add_u32 m0, s30, 16384
    v_exp_f32 v166, v166
    v_mfma_f32_16x16x32_bf16 a[56:59], v[120:123], v[176:179], a[56:59]
    buffer_load_dwordx4 v20, s[8:11], s31 offen offset:0 sc1 lds
    v_mfma_f32_16x16x32_bf16 a[60:63], v[156:159], v[236:239], a[60:63]
    v_exp_f32 v167, v167
    v_mfma_f32_16x16x32_bf16 a[60:63], v[124:127], v[176:179], a[60:63]
    v_cvt_pk_bf16_f32 v235, v166, v167
    v_mfma_f32_16x16x32_bf16 v[160:163], v[32:35], a[208:211], v[212:215]
    v_exp_f32 v168, v168
    v_mfma_f32_16x16x32_bf16 v[160:163], v[36:39], a[212:215], v[160:163]
    buffer_load_dwordx4 v20, s[8:11], s31 offen offset:1024 sc1 lds
    v_mfma_f32_16x16x32_bf16 v[160:163], v[40:43], a[216:219], v[160:163]
    v_exp_f32 v169, v169
    v_mfma_f32_16x16x32_bf16 v[160:163], v[44:47], a[220:223], v[160:163]
    v_cvt_pk_bf16_f32 v236, v168, v169
    v_mfma_f32_16x16x32_bf16 a[64:67], v[128:131], v[180:183], a[64:67]
    v_exp_f32 v170, v170
    v_mfma_f32_16x16x32_bf16 a[64:67], v[96:99], v[232:235], a[64:67]
    buffer_load_dwordx4 v20, s[8:11], s31 offen offset:2048 sc1 lds
    v_mfma_f32_16x16x32_bf16 a[68:71], v[132:135], v[180:183], a[68:71]
    v_exp_f32 v171, v171
    v_mfma_f32_16x16x32_bf16 a[68:71], v[100:103], v[232:235], a[68:71]
    v_cvt_pk_bf16_f32 v237, v170, v171
    v_mfma_f32_16x16x32_bf16 v[164:167], v[48:51], a[208:211], v[212:215]
    v_exp_f32 v172, v172
    v_mfma_f32_16x16x32_bf16 v[164:167], v[52:55], a[212:215], v[164:167]
    buffer_load_dwordx4 v20, s[8:11], s31 offen offset:3072 sc1 lds
    v_mfma_f32_16x16x32_bf16 v[164:167], v[56:59], a[216:219], v[164:167]
    v_exp_f32 v173, v173
    v_mfma_f32_16x16x32_bf16 v[164:167], v[60:63], a[220:223], v[164:167]
    v_cvt_pk_bf16_f32 v238, v172, v173
    v_mfma_f32_16x16x32_bf16 a[72:75], v[136:139], v[180:183], a[72:75]
    s_add_u32 m0, s30, 20480
    v_exp_f32 v174, v174
    v_mfma_f32_16x16x32_bf16 a[72:75], v[104:107], v[232:235], a[72:75]
    buffer_load_dwordx4 v21, s[8:11], s31 offen offset:0 sc1 lds
    v_mfma_f32_16x16x32_bf16 a[76:79], v[140:143], v[180:183], a[76:79]
    v_exp_f32 v175, v175
    v_mfma_f32_16x16x32_bf16 a[76:79], v[108:111], v[232:235], a[76:79]
    v_cvt_pk_bf16_f32 v239, v174, v175
    v_mfma_f32_16x16x32_bf16 v[168:171], v[64:67], a[224:227], v[216:219]
    v_exp_f32 v160, v160
    v_mfma_f32_16x16x32_bf16 v[168:171], v[68:71], a[228:231], v[168:171]
    buffer_load_dwordx4 v21, s[8:11], s31 offen offset:1024 sc1 lds
    v_mfma_f32_16x16x32_bf16 v[168:171], v[72:75], a[232:235], v[168:171]
    v_exp_f32 v161, v161
    v_mfma_f32_16x16x32_bf16 v[168:171], v[76:79], a[236:239], v[168:171]
    v_cvt_pk_bf16_f32 v176, v160, v161
    v_mfma_f32_16x16x32_bf16 a[80:83], v[144:147], v[180:183], a[80:83]
    s_waitcnt vmcnt(15)
    v_exp_f32 v162, v162
    v_mfma_f32_16x16x32_bf16 a[80:83], v[112:115], v[232:235], a[80:83]
    buffer_load_dwordx4 v21, s[8:11], s31 offen offset:2048 sc1 lds
    v_mfma_f32_16x16x32_bf16 a[84:87], v[148:151], v[180:183], a[84:87]
    v_exp_f32 v163, v163
    v_mfma_f32_16x16x32_bf16 a[84:87], v[116:119], v[232:235], a[84:87]
    ds_read_b128 v[64:67], v8 offset:24576
    v_cvt_pk_bf16_f32 v177, v162, v163
    v_mfma_f32_16x16x32_bf16 v[172:175], v[80:83], a[224:227], v[216:219]
    v_exp_f32 v164, v164
    v_mfma_f32_16x16x32_bf16 v[172:175], v[84:87], a[228:231], v[172:175]
    buffer_load_dwordx4 v21, s[8:11], s31 offen offset:3072 sc1 lds
    v_mfma_f32_16x16x32_bf16 v[172:175], v[88:91], a[232:235], v[172:175]
    s_add_u32 s31, s31, 8192
    v_exp_f32 v165, v165
    v_mfma_f32_16x16x32_bf16 v[172:175], v[92:95], a[236:239], v[172:175]
    ds_read_b128 v[68:71], v9 offset:24576
    v_cvt_pk_bf16_f32 v178, v164, v165
    v_mfma_f32_16x16x32_bf16 a[88:91], v[152:155], v[180:183], a[88:91]
    v_exp_f32 v166, v166
    v_mfma_f32_16x16x32_bf16 a[88:91], v[120:123], v[232:235], a[88:91]
    v_mfma_f32_16x16x32_bf16 a[92:95], v[156:159], v[180:183], a[92:95]
    v_exp_f32 v167, v167
    v_mfma_f32_16x16x32_bf16 a[92:95], v[124:127], v[232:235], a[92:95]
    ds_read_b128 v[72:75], v10 offset:24576
    v_cvt_pk_bf16_f32 v179, v166, v167
    v_mfma_f32_16x16x32_bf16 v[160:163], v[32:35], a[224:227], v[216:219]
    v_exp_f32 v168, v168
    v_mfma_f32_16x16x32_bf16 v[160:163], v[36:39], a[228:231], v[160:163]
    ds_read_b128 v[80:83], v8 offset:28672
    ds_read_b128 v[84:87], v9 offset:28672
    v_mfma_f32_16x16x32_bf16 v[160:163], v[40:43], a[232:235], v[160:163]
    v_exp_f32 v169, v169
    v_mfma_f32_16x16x32_bf16 v[160:163], v[44:47], a[236:239], v[160:163]
    ds_read_b128 v[76:79], v11 offset:24576
    v_cvt_pk_bf16_f32 v180, v168, v169
    v_mfma_f32_16x16x32_bf16 a[96:99], v[128:131], v[236:239], a[96:99]
    v_exp_f32 v170, v170
    v_mfma_f32_16x16x32_bf16 a[96:99], v[96:99], v[176:179], a[96:99]
    ds_read_b128 v[88:91], v10 offset:28672
    ds_read_b128 v[92:95], v11 offset:28672
    v_mfma_f32_16x16x32_bf16 a[100:103], v[132:135], v[236:239], a[100:103]
    v_exp_f32 v171, v171
    v_mfma_f32_16x16x32_bf16 a[100:103], v[100:103], v[176:179], a[100:103]
    ds_read_b128 v[32:35], v8 offset:0
    v_cvt_pk_bf16_f32 v181, v170, v171
    v_mfma_f32_16x16x32_bf16 v[164:167], v[48:51], a[224:227], v[216:219]
    v_exp_f32 v172, v172
    v_mfma_f32_16x16x32_bf16 v[164:167], v[52:55], a[228:231], v[164:167]
    v_mfma_f32_16x16x32_bf16 v[164:167], v[56:59], a[232:235], v[164:167]
    v_exp_f32 v173, v173
    v_mfma_f32_16x16x32_bf16 v[164:167], v[60:63], a[236:239], v[164:167]
    ds_read_b128 v[36:39], v9 offset:0
    v_cvt_pk_bf16_f32 v182, v172, v173
    v_mfma_f32_16x16x32_bf16 a[104:107], v[136:139], v[236:239], a[104:107]
    v_exp_f32 v174, v174
    v_mfma_f32_16x16x32_bf16 a[104:107], v[104:107], v[176:179], a[104:107]
    v_mfma_f32_16x16x32_bf16 a[108:111], v[140:143], v[236:239], a[108:111]
    s_waitcnt lgkmcnt(4)
    v_exp_f32 v175, v175
    v_mfma_f32_16x16x32_bf16 a[108:111], v[108:111], v[176:179], a[108:111]
    ds_read_b128 v[40:43], v10 offset:0
    v_cvt_pk_bf16_f32 v183, v174, v175
    v_mfma_f32_16x16x32_bf16 v[168:171], v[64:67], a[160:163], v[200:203]
    v_exp_f32 v160, v160
    v_mfma_f32_16x16x32_bf16 v[168:171], v[68:71], a[164:167], v[168:171]
    ds_read_b128 v[48:51], v8 offset:4096
    ds_read_b128 v[52:55], v9 offset:4096
    v_mfma_f32_16x16x32_bf16 v[168:171], v[72:75], a[168:171], v[168:171]
    v_exp_f32 v161, v161
    v_mfma_f32_16x16x32_bf16 v[168:171], v[76:79], a[172:175], v[168:171]
    ds_read_b128 v[44:47], v11 offset:0
    v_cvt_pk_bf16_f32 v232, v160, v161
    v_mfma_f32_16x16x32_bf16 a[112:115], v[144:147], v[236:239], a[112:115]
    v_exp_f32 v162, v162
    v_mfma_f32_16x16x32_bf16 a[112:115], v[112:115], v[176:179], a[112:115]
    ds_read_b128 v[56:59], v10 offset:4096
    ds_read_b128 v[60:63], v11 offset:4096
    v_mfma_f32_16x16x32_bf16 a[116:119], v[148:151], v[236:239], a[116:119]
    s_waitcnt lgkmcnt(8)
    v_exp_f32 v163, v163
    v_mfma_f32_16x16x32_bf16 a[116:119], v[116:119], v[176:179], a[116:119]
    v_cvt_pk_bf16_f32 v233, v162, v163
    v_mfma_f32_16x16x32_bf16 v[172:175], v[80:83], a[160:163], v[200:203]
    v_exp_f32 v164, v164
    v_mfma_f32_16x16x32_bf16 v[172:175], v[84:87], a[164:167], v[172:175]
    v_mfma_f32_16x16x32_bf16 v[172:175], v[88:91], a[168:171], v[172:175]
    s_sub_u32 s33, s33, 1
    v_exp_f32 v165, v165
    v_mfma_f32_16x16x32_bf16 v[172:175], v[92:95], a[172:175], v[172:175]
    v_cvt_pk_bf16_f32 v234, v164, v165
    v_mfma_f32_16x16x32_bf16 a[120:123], v[152:155], v[236:239], a[120:123]
    s_cmp_lg_u32 s33, 0
    v_exp_f32 v166, v166
    v_mfma_f32_16x16x32_bf16 a[120:123], v[120:123], v[176:179], a[120:123]
    v_mfma_f32_16x16x32_bf16 a[124:127], v[156:159], v[236:239], a[124:127]
    s_waitcnt lgkmcnt(2)
    v_exp_f32 v167, v167
    v_mfma_f32_16x16x32_bf16 a[124:127], v[124:127], v[176:179], a[124:127]
    v_cvt_pk_bf16_f32 v235, v166, v167
    s_cbranch_scc1 L2_loop_s
    s_waitcnt vmcnt(16)
    s_mov_b32 s49, 0x40000
L2_rdy_bs:
    v_xor_b32 v240, s59, v240
    v_xor_b32 v241, s59, v241
    v_xor_b32 v242, s59, v242
    v_xor_b32 v243, s59, v243
    v_or3_b32 v240, v240, v241, v242
    v_or_b32 v240, v240, v243
    v_cmp_ne_u32 vcc, 0, v240
    s_sub_u32 s49, s49, 1
    s_cselect_b64 vcc, 0, vcc
    s_cbranch_vccz L2_go_bs
    buffer_load_dwordx4 v[240:243], v22, s[12:15], s58 offen sc1
    s_waitcnt vmcnt(0)
    s_branch L2_rdy_bs
L2_go_bs:
    v_mfma_f32_16x16x32_bf16 v[160:163], v[32:35], a[160:163], v[200:203]
    v_exp_f32 v168, v168
    v_mfma_f32_16x16x32_bf16 v[160:163], v[36:39], a[164:167], v[160:163]
    buffer_load_dword v22, v23, s[12:15], s39 offen sc1
    v_mfma_f32_16x16x32_bf16 v[160:163], v[40:43], a[168:171], v[160:163]
    v_exp_f32 v169, v169
    v_mfma_f32_16x16x32_bf16 v[160:163], v[44:47], a[172:175], v[160:163]
    v_cvt_pk_bf16_f32 v236, v168, v169
    v_mfma_f32_16x16x32_bf16 a[128:131], v[128:131], v[180:183], a[128:131]
    v_exp_f32 v170, v170
    v_mfma_f32_16x16x32_bf16 a[128:131], v[96:99], v[232:235], a[128:131]
    v_add_u32 v250, 1, v0
    v_add_u32 v251, s45, v23
    v_mfma_f32_16x16x32_bf16 a[132:135], v[132:135], v[180:183], a[132:135]
    s_waitcnt lgkmcnt(0)
    v_exp_f32 v171, v171
    v_mfma_f32_16x16x32_bf16 a[132:135], v[100:103], v[232:235], a[132:135]
    ds_read_b64_tr_b16 v[128:129], v12 offset:24576
    v_cvt_pk_bf16_f32 v237, v170, v171
    v_mfma_f32_16x16x32_bf16 v[164:167], v[48:51], a[160:163], v[200:203]
    v_exp_f32 v172, v172
    v_mfma_f32_16x16x32_bf16 v[164:167], v[52:55], a[164:167], v[164:167]
    ds_read_b64_tr_b16 v[130:131], v12 offset:28672
    ds_read_b64_tr_b16 v[96:97], v12 offset:0
    v_mfma_f32_16x16x32_bf16 v[164:167], v[56:59], a[168:171], v[164:167]
    v_exp_f32 v173, v173
    v_mfma_f32_16x16x32_bf16 v[164:167], v[60:63], a[172:175], v[164:167]
    ds_read_b64_tr_b16 v[98:99], v12 offset:4096
    v_cvt_pk_bf16_f32 v238, v172, v173
    v_mfma_f32_16x16x32_bf16 a[136:139], v[136:139], v[180:183], a[136:139]
    v_exp_f32 v174, v174
    v_mfma_f32_16x16x32_bf16 a[136:139], v[104:107], v[232:235], a[136:139]
    ds_read_b64_tr_b16 v[132:133], v13 offset:24576
    ds_read_b64_tr_b16 v[134:135], v13 offset:28672
    v_mfma_f32_16x16x32_bf16 a[140:143], v[140:143], v[180:183], a[140:143]
    v_exp_f32 v175, v175
    v_mfma_f32_16x16x32_bf16 a[140:143], v[108:111], v[232:235], a[140:143]
    ds_read_b64_tr_b16 v[100:101], v13 offset:0
    v_cvt_pk_bf16_f32 v239, v174, v175
    v_mfma_f32_16x16x32_bf16 v[168:171], v[64:67], a[176:179], v[204:207]
    v_exp_f32 v160, v160
    v_mfma_f32_16x16x32_bf16 v[168:171], v[68:71], a[180:183], v[168:171]
    ds_read_b64_tr_b16 v[102:103], v13 offset:4096
    ds_read_b64_tr_b16 v[136:137], v14 offset:24576
    v_mfma_f32_16x16x32_bf16 v[168:171], v[72:75], a[184:187], v[168:171]
    v_exp_f32 v161, v161
    v_mfma_f32_16x16x32_bf16 v[168:171], v[76:79], a[188:191], v[168:171]
    ds_read_b64_tr_b16 v[138:139], v14 offset:28672
    v_cvt_pk_bf16_f32 v176, v160, v161
    v_mfma_f32_16x16x32_bf16 a[144:147], v[144:147], v[180:183], a[144:147]
    v_exp_f32 v162, v162
    v_mfma_f32_16x16x32_bf16 a[144:147], v[112:115], v[232:235], a[144:147]
    ds_read_b64_tr_b16 v[104:105], v14 offset:0
    ds_read_b64_tr_b16 v[106:107], v14 offset:4096
    v_mfma_f32_16x16x32_bf16 a[148:151], v[148:151], v[180:183], a[148:151]
    v_exp_f32 v163, v163
    v_mfma_f32_16x16x32_bf16 a[148:151], v[116:119], v[232:235], a[148:151]
    ds_read_b64_tr_b16 v[140:141], v15 offset:24576
    v_cvt_pk_bf16_f32 v177, v162, v163
    v_mfma_f32_16x16x32_bf16 v[172:175], v[80:83], a[176:179], v[204:207]
    v_exp_f32 v164, v164
    v_mfma_f32_16x16x32_bf16 v[172:175], v[84:87], a[180:183], v[172:175]
    ds_read_b64_tr_b16 v[142:143], v15 offset:28672
    ds_read_b64_tr_b16 v[108:109], v15 offset:0
    v_mfma_f32_16x16x32_bf16 v[172:175], v[88:91], a[184:187], v[172:175]
    v_exp_f32 v165, v165
    v_mfma_f32_16x16x32_bf16 v[172:175], v[92:95], a[188:191], v[172:175]
    ds_read_b64_tr_b16 v[110:111], v15 offset:4096
    v_cvt_pk_bf16_f32 v178, v164, v165
    v_mfma_f32_16x16x32_bf16 a[152:155], v[152:155], v[180:183], a[152:155]
    v_exp_f32 v166, v166
    v_mfma_f32_16x16x32_bf16 a[152:155], v[120:123], v[232:235], a[152:155]
    ds_read_b64_tr_b16 v[144:145], v16 offset:24576
    ds_read_b64_tr_b16 v[146:147], v16 offset:28672
    v_mfma_f32_16x16x32_bf16 a[156:159], v[156:159], v[180:183], a[156:159]
    v_exp_f32 v167, v167
    v_mfma_f32_16x16x32_bf16 a[156:159], v[124:127], v[232:235], a[156:159]
    ds_read_b64_tr_b16 v[112:113], v16 offset:0
    v_cvt_pk_bf16_f32 v179, v166, v167
    v_mfma_f32_16x16x32_bf16 v[160:163], v[32:35], a[176:179], v[204:207]
    v_exp_f32 v168, v168
    v_mfma_f32_16x16x32_bf16 v[160:163], v[36:39], a[180:183], v[160:163]
    ds_read_b64_tr_b16 v[114:115], v16 offset:4096
    ds_read_b64_tr_b16 v[148:149], v17 offset:24576
    v_mfma_f32_16x16x32_bf16 v[160:163], v[40:43], a[184:187], v[160:163]
    s_waitcnt lgkmcnt(13)
    v_exp_f32 v169, v169
    v_mfma_f32_16x16x32_bf16 v[160:163], v[44:47], a[188:191], v[160:163]
    ds_read_b64_tr_b16 v[150:151], v17 offset:28672
    v_cvt_pk_bf16_f32 v180, v168, v169
    v_mfma_f32_16x16x32_bf16 a[0:3], v[128:131], v[236:239], a[0:3]
    v_exp_f32 v170, v170
    v_mfma_f32_16x16x32_bf16 a[0:3], v[96:99], v[176:179], a[0:3]
    ds_read_b64_tr_b16 v[116:117], v17 offset:0
    ds_read_b64_tr_b16 v[118:119], v17 offset:4096
    v_mfma_f32_16x16x32_bf16 a[4:7], v[132:135], v[236:239], a[4:7]
    v_exp_f32 v171, v171
    v_mfma_f32_16x16x32_bf16 a[4:7], v[100:103], v[176:179], a[4:7]
    ds_read_b64_tr_b16 v[152:153], v18 offset:24576
    v_cvt_pk_bf16_f32 v181, v170, v171
    v_mfma_f32_16x16x32_bf16 v[164:167], v[48:51], a[176:179], v[204:207]
    v_exp_f32 v172, v172
    v_mfma_f32_16x16x32_bf16 v[164:167], v[52:55], a[180:183], v[164:167]
    ds_read_b64_tr_b16 v[154:155], v18 offset:28672
    ds_read_b64_tr_b16 v[120:121], v18 offset:0
    v_mfma_f32_16x16x32_bf16 v[164:167], v[56:59], a[184:187], v[164:167]
    s_waitcnt lgkmcnt(11)
    v_exp_f32 v173, v173
    v_mfma_f32_16x16x32_bf16 v[164:167], v[60:63], a[188:191], v[164:167]
    ds_read_b64_tr_b16 v[122:123], v18 offset:4096
    v_cvt_pk_bf16_f32 v182, v172, v173
    v_mfma_f32_16x16x32_bf16 a[8:11], v[136:139], v[236:239], a[8:11]
    v_exp_f32 v174, v174
    v_mfma_f32_16x16x32_bf16 a[8:11], v[104:107], v[176:179], a[8:11]
    ds_read_b64_tr_b16 v[156:157], v19 offset:24576
    ds_read_b64_tr_b16 v[158:159], v19 offset:28672
    v_mfma_f32_16x16x32_bf16 a[12:15], v[140:143], v[236:239], a[12:15]
    v_exp_f32 v175, v175
    v_mfma_f32_16x16x32_bf16 a[12:15], v[108:111], v[176:179], a[12:15]
    ds_read_b64_tr_b16 v[124:125], v19 offset:0
    v_cvt_pk_bf16_f32 v183, v174, v175
    v_mfma_f32_16x16x32_bf16 v[168:171], v[64:67], a[192:195], v[208:211]
    v_exp_f32 v160, v160
    v_mfma_f32_16x16x32_bf16 v[168:171], v[68:71], a[196:199], v[168:171]
    ds_read_b64_tr_b16 v[126:127], v19 offset:4096
    v_mfma_f32_16x16x32_bf16 v[168:171], v[72:75], a[200:203], v[168:171]
    s_waitcnt lgkmcnt(8)
    v_exp_f32 v161, v161
    v_mfma_f32_16x16x32_bf16 v[168:171], v[76:79], a[204:207], v[168:171]
    v_cvt_pk_bf16_f32 v232, v160, v161
    v_mfma_f32_16x16x32_bf16 a[16:19], v[144:147], v[236:239], a[16:19]
    v_exp_f32 v162, v162
    v_mfma_f32_16x16x32_bf16 a[16:19], v[112:115], v[176:179], a[16:19]
    v_mfma_f32_16x16x32_bf16 a[20:23], v[148:151], v[236:239], a[20:23]
    v_exp_f32 v163, v163
    v_mfma_f32_16x16x32_bf16 a[20:23], v[116:119], v[176:179], a[20:23]
    v_cvt_pk_bf16_f32 v233, v162, v163
    v_mfma_f32_16x16x32_bf16 v[172:175], v[80:83], a[192:195], v[208:211]
    s_waitcnt vmcnt(0)
    v_exp_f32 v164, v164
    v_mfma_f32_16x16x32_bf16 v[172:175], v[84:87], a[196:199], v[172:175]
    v_readlane_b32 s84, v22, 0
    v_readlane_b32 s85, v22, 1
    v_mfma_f32_16x16x32_bf16 v[172:175], v[88:91], a[200:203], v[172:175]
    s_waitcnt lgkmcnt(0)
    v_exp_f32 v165, v165
    v_mfma_f32_16x16x32_bf16 v[172:175], v[92:95], a[204:207], v[172:175]
    v_readlane_b32 s86, v22, 2
    v_cvt_pk_bf16_f32 v234, v164, v165
    v_mfma_f32_16x16x32_bf16 a[24:27], v[152:155], v[236:239], a[24:27]
    v_exp_f32 v166, v166
    v_mfma_f32_16x16x32_bf16 a[24:27], v[120:123], v[176:179], a[24:27]
    v_readlane_b32 s87, v22, 3
    v_readlane_b32 s88, v22, 4
    v_mfma_f32_16x16x32_bf16 a[28:31], v[156:159], v[236:239], a[28:31]
    v_exp_f32 v167, v167
    v_mfma_f32_16x16x32_bf16 a[28:31], v[124:127], v[176:179], a[28:31]
    v_readlane_b32 s89, v22, 5
    v_cvt_pk_bf16_f32 v235, v166, v167
    v_mfma_f32_16x16x32_bf16 v[160:163], v[32:35], a[192:195], v[208:211]
    s_and_b32 s90, s84, 0xffff
    s_lshr_b32 s84, s84, 16
    v_exp_f32 v168, v168
    v_mfma_f32_16x16x32_bf16 v[160:163], v[36:39], a[196:199], v[160:163]
    v_mfma_f32_16x16x32_bf16 v[160:163], v[40:43], a[200:203], v[160:163]
    s_lshl2_add_u32 s90, s90, 2818048
    s_min_u32 s60, s84, 64
    v_exp_f32 v169, v169
    v_mfma_f32_16x16x32_bf16 v[160:163], v[44:47], a[204:207], v[160:163]
    v_cvt_pk_bf16_f32 v236, v168, v169
    v_mfma_f32_16x16x32_bf16 a[32:35], v[128:131], v[180:183], a[32:35]
    s_mov_b32 s46, s60
    s_and_b32 s91, s85, 0xffff
    v_exp_f32 v170, v170
    v_mfma_f32_16x16x32_bf16 a[32:35], v[96:99], v[232:235], a[32:35]
    v_mfma_f32_16x16x32_bf16 a[36:39], v[132:135], v[180:183], a[36:39]
    v_exp_f32 v171, v171
    v_mfma_f32_16x16x32_bf16 a[36:39], v[100:103], v[232:235], a[36:39]
    v_cvt_pk_bf16_f32 v237, v170, v171
    v_mfma_f32_16x16x32_bf16 v[164:167], v[48:51], a[192:195], v[208:211]
    s_lshr_b32 s85, s85, 16
    s_lshl2_add_u32 s91, s91, 2925568
    v_exp_f32 v172, v172
    v_mfma_f32_16x16x32_bf16 v[164:167], v[52:55], a[196:199], v[164:167]
    v_sub_u32 v244, v250, s60 clamp
    v_lshl_add_u32 v192, v244, 26, v23
    v_mfma_f32_16x16x32_bf16 v[164:167], v[56:59], a[200:203], v[164:167]
    s_min_u32 s61, s85, 64
    s_lshl_b32 s42, s46, 2
    v_exp_f32 v173, v173
    v_mfma_f32_16x16x32_bf16 v[164:167], v[60:63], a[204:207], v[164:167]
    v_cvt_pk_bf16_f32 v238, v172, v173
    v_mfma_f32_16x16x32_bf16 a[40:43], v[136:139], v[180:183], a[40:43]
    s_add_u32 s46, s46, s61
    s_and_b32 s92, s86, 0xffff
    v_exp_f32 v174, v174
    v_mfma_f32_16x16x32_bf16 a[40:43], v[104:107], v[232:235], a[40:43]
    buffer_load_dword v184, v192, s[12:15], s90 offen sc1
    v_mfma_f32_16x16x32_bf16 a[44:47], v[140:143], v[180:183], a[44:47]
    v_exp_f32 v175, v175
    v_mfma_f32_16x16x32_bf16 a[44:47], v[108:111], v[232:235], a[44:47]
    v_cvt_pk_bf16_f32 v239, v174, v175
    v_mfma_f32_16x16x32_bf16 v[168:171], v[64:67], a[208:211], v[212:215]
    s_lshr_b32 s86, s86, 16
    s_lshl2_add_u32 s92, s92, 3033088
    v_exp_f32 v160, v160
    v_mfma_f32_16x16x32_bf16 v[168:171], v[68:71], a[212:215], v[168:171]
    v_sub_u32 v245, v250, s61 clamp
    v_lshl_add_u32 v193, v245, 26, v23
    v_mfma_f32_16x16x32_bf16 v[168:171], v[72:75], a[216:219], v[168:171]
    s_min_u32 s62, s86, 64
    s_lshl_b32 s43, s46, 2
    v_exp_f32 v161, v161
    v_mfma_f32_16x16x32_bf16 v[168:171], v[76:79], a[220:223], v[168:171]
    v_cvt_pk_bf16_f32 v176, v160, v161
    v_mfma_f32_16x16x32_bf16 a[48:51], v[144:147], v[180:183], a[48:51]
    s_add_u32 s46, s46, s62
    s_and_b32 s93, s87, 0xffff
    v_exp_f32 v162, v162
    v_mfma_f32_16x16x32_bf16 a[48:51], v[112:115], v[232:235], a[48:51]
    buffer_load_dword v185, v193, s[12:15], s91 offen sc1
    v_mfma_f32_16x16x32_bf16 a[52:55], v[148:151], v[180:183], a[52:55]
    v_exp_f32 v163, v163
    v_mfma_f32_16x16x32_bf16 a[52:55], v[116:119], v[232:235], a[52:55]
    v_cvt_pk_bf16_f32 v177, v162, v163
    v_mfma_f32_16x16x32_bf16 v[172:175], v[80:83], a[208:211], v[212:215]
    s_lshr_b32 s87, s87, 16
    s_lshl2_add_u32 s93, s93, 3140608
    v_exp_f32 v164, v164
    v_mfma_f32_16x16x32_bf16 v[172:175], v[84:87], a[212:215], v[172:175]
    v_sub_u32 v246, v250, s62 clamp
    v_lshl_add_u32 v194, v246, 26, v23
    v_mfma_f32_16x16x32_bf16 v[172:175], v[88:91], a[216:219], v[172:175]
    s_min_u32 s63, s87, 64
    s_lshl_b32 s44, s46, 2
    v_exp_f32 v165, v165
    v_mfma_f32_16x16x32_bf16 v[172:175], v[92:95], a[220:223], v[172:175]
    v_cvt_pk_bf16_f32 v178, v164, v165
    v_mfma_f32_16x16x32_bf16 a[56:59], v[152:155], v[180:183], a[56:59]
    s_add_u32 s46, s46, s63
    s_and_b32 s94, s88, 0xffff
    v_exp_f32 v166, v166
    v_mfma_f32_16x16x32_bf16 a[56:59], v[120:123], v[232:235], a[56:59]
    buffer_load_dword v186, v194, s[12:15], s92 offen sc1
    v_mfma_f32_16x16x32_bf16 a[60:63], v[156:159], v[180:183], a[60:63]
    v_exp_f32 v167, v167
    v_mfma_f32_16x16x32_bf16 a[60:63], v[124:127], v[232:235], a[60:63]
    v_cvt_pk_bf16_f32 v179, v166, v167
    v_mfma_f32_16x16x32_bf16 v[160:163], v[32:35], a[208:211], v[212:215]
    s_lshr_b32 s88, s88, 16
    s_lshl2_add_u32 s94, s94, 3248128
    v_exp_f32 v168, v168
    v_mfma_f32_16x16x32_bf16 v[160:163], v[36:39], a[212:215], v[160:163]
    v_sub_u32 v247, v250, s63 clamp
    v_lshl_add_u32 v195, v247, 26, v23
    v_mfma_f32_16x16x32_bf16 v[160:163], v[40:43], a[216:219], v[160:163]
    s_min_u32 s50, s88, 64
    s_lshl_b32 s48, s46, 2
    v_exp_f32 v169, v169
    v_mfma_f32_16x16x32_bf16 v[160:163], v[44:47], a[220:223], v[160:163]
    v_cvt_pk_bf16_f32 v180, v168, v169
    v_mfma_f32_16x16x32_bf16 a[64:67], v[128:131], v[236:239], a[64:67]
    s_add_u32 s46, s46, s50
    s_and_b32 s95, s89, 0xffff
    v_exp_f32 v170, v170
    v_mfma_f32_16x16x32_bf16 a[64:67], v[96:99], v[176:179], a[64:67]
    buffer_load_dword v187, v195, s[12:15], s93 offen sc1
    v_mfma_f32_16x16x32_bf16 a[68:71], v[132:135], v[236:239], a[68:71]
    v_exp_f32 v171, v171
    v_mfma_f32_16x16x32_bf16 a[68:71], v[100:103], v[176:179], a[68:71]
    v_cvt_pk_bf16_f32 v181, v170, v171
    v_mfma_f32_16x16x32_bf16 v[164:167], v[48:51], a[208:211], v[212:215]
    s_lshr_b32 s89, s89, 16
    s_lshl2_add_u32 s95, s95, 3355648
    v_exp_f32 v172, v172
    v_mfma_f32_16x16x32_bf16 v[164:167], v[52:55], a[212:215], v[164:167]
    v_sub_u32 v248, v250, s50 clamp
    v_lshl_add_u32 v196, v248, 26, v23
    v_mfma_f32_16x16x32_bf16 v[164:167], v[56:59], a[216:219], v[164:167]
    s_min_u32 s51, s89, 64
    s_lshl_b32 s49, s46, 2
    v_exp_f32 v173, v173
    v_mfma_f32_16x16x32_bf16 v[164:167], v[60:63], a[220:223], v[164:167]
    v_cvt_pk_bf16_f32 v182, v172, v173
    v_mfma_f32_16x16x32_bf16 a[72:75], v[136:139], v[236:239], a[72:75]
    s_add_u32 s46, s46, s51
    v_exp_f32 v174, v174
    v_mfma_f32_16x16x32_bf16 a[72:75], v[104:107], v[176:179], a[72:75]
    buffer_load_dword v188, v196, s[12:15], s94 offen sc1
    v_mfma_f32_16x16x32_bf16 a[76:79], v[140:143], v[236:239], a[76:79]
    v_exp_f32 v175, v175
    v_mfma_f32_16x16x32_bf16 a[76:79], v[108:111], v[176:179], a[76:79]
    v_cvt_pk_bf16_f32 v183, v174, v175
    v_mfma_f32_16x16x32_bf16 v[168:171], v[64:67], a[224:227], v[216:219]
    v_exp_f32 v160, v160
    v_mfma_f32_16x16x32_bf16 v[168:171], v[68:71], a[228:231], v[168:171]
    v_sub_u32 v249, v250, s51 clamp
    v_lshl_add_u32 v197, v249, 26, v23
    v_mfma_f32_16x16x32_bf16 v[168:171], v[72:75], a[232:235], v[168:171]
    v_exp_f32 v161, v161
    v_mfma_f32_16x16x32_bf16 v[168:171], v[76:79], a[236:239], v[168:171]
    v_cvt_pk_bf16_f32 v232, v160, v161
    v_mfma_f32_16x16x32_bf16 a[80:83], v[144:147], v[236:239], a[80:83]
    s_waitcnt vmcnt(6)
    v_exp_f32 v162, v162
    v_mfma_f32_16x16x32_bf16 a[80:83], v[112:115], v[176:179], a[80:83]
    buffer_load_dword v189, v197, s[12:15], s95 offen sc1
    v_mfma_f32_16x16x32_bf16 a[84:87], v[148:151], v[236:239], a[84:87]
    v_exp_f32 v163, v163
    v_mfma_f32_16x16x32_bf16 a[84:87], v[116:119], v[176:179], a[84:87]
    ds_read_b128 v[64:67], v8 offset:8192
    v_cvt_pk_bf16_f32 v233, v162, v163
    v_mfma_f32_16x16x32_bf16 v[172:175], v[80:83], a[224:227], v[216:219]
    v_exp_f32 v164, v164
    v_mfma_f32_16x16x32_bf16 v[172:175], v[84:87], a[228:231], v[172:175]
    v_mfma_f32_16x16x32_bf16 v[172:175], v[88:91], a[232:235], v[172:175]
    v_exp_f32 v165, v165
    v_mfma_f32_16x16x32_bf16 v[172:175], v[92:95], a[236:239], v[172:175]
    ds_read_b128 v[68:71], v9 offset:8192
    v_cvt_pk_bf16_f32 v234, v164, v165
    v_mfma_f32_16x16x32_bf16 a[88:91], v[152:155], v[236:239], a[88:91]
    v_exp_f32 v166, v166
    v_mfma_f32_16x16x32_bf16 a[88:91], v[120:123], v[176:179], a[88:91]
    v_lshl_add_u32 v252, s46, 2, v251
    v_mov_b32 v253, 0x7fffff0f
    v_mfma_f32_16x16x32_bf16 a[92:95], v[156:159], v[236:239], a[92:95]
    v_exp_f32 v167, v167
    v_mfma_f32_16x16x32_bf16 a[92:95], v[124:127], v[176:179], a[92:95]
    ds_read_b128 v[72:75], v10 offset:8192
    v_cvt_pk_bf16_f32 v235, v166, v167
    v_mfma_f32_16x16x32_bf16 v[160:163], v[32:35], a[224:227], v[216:219]
    s_add_u32 s6, s40, 32768
    v_exp_f32 v168, v168
    v_mfma_f32_16x16x32_bf16 v[160:163], v[36:39], a[228:231], v[160:163]
    ds_read_b128 v[80:83], v8 offset:12288
    ds_read_b128 v[84:87], v9 offset:12288
    v_mfma_f32_16x16x32_bf16 v[160:163], v[40:43], a[232:235], v[160:163]
    s_mov_b32 s7, 0xfffffff0
    v_exp_f32 v169, v169
    v_mfma_f32_16x16x32_bf16 v[160:163], v[44:47], a[236:239], v[160:163]
    ds_read_b128 v[76:79], v11 offset:8192
    v_cvt_pk_bf16_f32 v236, v168, v169
    v_mfma_f32_16x16x32_bf16 a[96:99], v[128:131], v[180:183], a[96:99]
    s_mov_b32 s52, s8
    v_exp_f32 v170, v170
    v_mfma_f32_16x16x32_bf16 a[96:99], v[96:99], v[232:235], a[96:99]
    ds_read_b128 v[88:91], v10 offset:12288
    ds_read_b128 v[92:95], v11 offset:12288
    v_mfma_f32_16x16x32_bf16 a[100:103], v[132:135], v[180:183], a[100:103]
    s_mov_b32 s53, s9
    v_exp_f32 v171, v171
    v_mfma_f32_16x16x32_bf16 a[100:103], v[100:103], v[232:235], a[100:103]
    ds_read_b128 v[32:35], v8 offset:16384
    v_cvt_pk_bf16_f32 v237, v170, v171
    v_mfma_f32_16x16x32_bf16 v[164:167], v[48:51], a[224:227], v[216:219]
    s_mov_b32 s55, 0x00020000
    v_exp_f32 v172, v172
    v_mfma_f32_16x16x32_bf16 v[164:167], v[52:55], a[228:231], v[164:167]
    ds_write_b32 v252, v253
    v_mfma_f32_16x16x32_bf16 v[164:167], v[56:59], a[232:235], v[164:167]
    v_exp_f32 v173, v173
    v_mfma_f32_16x16x32_bf16 v[164:167], v[60:63], a[236:239], v[164:167]
    ds_read_b128 v[36:39], v9 offset:16384
    v_cvt_pk_bf16_f32 v238, v172, v173
    v_mfma_f32_16x16x32_bf16 a[104:107], v[136:139], v[180:183], a[104:107]
    v_exp_f32 v174, v174
    v_mfma_f32_16x16x32_bf16 a[104:107], v[104:107], v[232:235], a[104:107]
    v_mfma_f32_16x16x32_bf16 a[108:111], v[140:143], v[180:183], a[108:111]
    s_waitcnt lgkmcnt(5)
    v_exp_f32 v175, v175
    v_mfma_f32_16x16x32_bf16 a[108:111], v[108:111], v[232:235], a[108:111]
    ds_read_b128 v[40:43], v10 offset:16384
    v_cvt_pk_bf16_f32 v239, v174, v175
    v_mfma_f32_16x16x32_bf16 v[168:171], v[64:67], a[160:163], v[200:203]
    v_exp_f32 v160, v160
    v_mfma_f32_16x16x32_bf16 v[168:171], v[68:71], a[164:167], v[168:171]
    ds_read_b128 v[48:51], v8 offset:20480
    ds_read_b128 v[52:55], v9 offset:20480
    v_mfma_f32_16x16x32_bf16 v[168:171], v[72:75], a[168:171], v[168:171]
    v_exp_f32 v161, v161
    v_mfma_f32_16x16x32_bf16 v[168:171], v[76:79], a[172:175], v[168:171]
    ds_read_b128 v[44:47], v11 offset:16384
    v_cvt_pk_bf16_f32 v176, v160, v161
    v_mfma_f32_16x16x32_bf16 a[112:115], v[144:147], v[180:183], a[112:115]
    v_exp_f32 v162, v162
    v_mfma_f32_16x16x32_bf16 a[112:115], v[112:115], v[232:235], a[112:115]
    ds_read_b128 v[56:59], v10 offset:20480
    ds_read_b128 v[60:63], v11 offset:20480
    v_mfma_f32_16x16x32_bf16 a[116:119], v[148:151], v[180:183], a[116:119]
    s_waitcnt lgkmcnt(9)
    v_exp_f32 v163, v163
    v_mfma_f32_16x16x32_bf16 a[116:119], v[116:119], v[232:235], a[116:119]
    v_cvt_pk_bf16_f32 v177, v162, v163
    v_mfma_f32_16x16x32_bf16 v[172:175], v[80:83], a[160:163], v[200:203]
    v_exp_f32 v164, v164
    v_mfma_f32_16x16x32_bf16 v[172:175], v[84:87], a[164:167], v[172:175]
    v_mfma_f32_16x16x32_bf16 v[172:175], v[88:91], a[168:171], v[172:175]
    v_exp_f32 v165, v165
    v_mfma_f32_16x16x32_bf16 v[172:175], v[92:95], a[172:175], v[172:175]
    v_cvt_pk_bf16_f32 v178, v164, v165
    v_mfma_f32_16x16x32_bf16 a[120:123], v[152:155], v[180:183], a[120:123]
    v_exp_f32 v166, v166
    v_mfma_f32_16x16x32_bf16 a[120:123], v[120:123], v[232:235], a[120:123]
    v_mfma_f32_16x16x32_bf16 a[124:127], v[156:159], v[180:183], a[124:127]
    s_waitcnt lgkmcnt(2)
    v_exp_f32 v167, v167
    v_mfma_f32_16x16x32_bf16 a[124:127], v[124:127], v[232:235], a[124:127]
    v_cvt_pk_bf16_f32 v179, v166, v167
    v_mfma_f32_16x16x32_bf16 v[160:163], v[32:35], a[160:163], v[200:203]
    v_exp_f32 v168, v168
    v_mfma_f32_16x16x32_bf16 v[160:163], v[36:39], a[164:167], v[160:163]
    v_lshrrev_b32 v9, 1, v24
    v_and_b32 v10, 1, v24
    v_mfma_f32_16x16x32_bf16 v[160:163], v[40:43], a[168:171], v[160:163]
    v_exp_f32 v169, v169
    v_mfma_f32_16x16x32_bf16 v[160:163], v[44:47], a[172:175], v[160:163]
    v_xor_b32 v9, v9, v25
    v_cvt_pk_bf16_f32 v180, v168, v169
    v_mfma_f32_16x16x32_bf16 a[128:131], v[128:131], v[236:239], a[128:131]
    v_exp_f32 v170, v170
    v_mfma_f32_16x16x32_bf16 a[128:131], v[96:99], v[176:179], a[128:131]
    v_lshlrev_b32 v10, 4, v10
    v_mfma_f32_16x16x32_bf16 a[132:135], v[132:135], v[236:239], a[132:135]
    s_waitcnt lgkmcnt(0)
    v_exp_f32 v171, v171
    v_mfma_f32_16x16x32_bf16 a[132:135], v[100:103], v[176:179], a[132:135]
    ds_read_b64_tr_b16 v[128:129], v12 offset:8192
    v_cvt_pk_bf16_f32 v181, v170, v171
    v_mfma_f32_16x16x32_bf16 v[164:167], v[48:51], a[160:163], v[200:203]
    v_exp_f32 v172, v172
    v_mfma_f32_16x16x32_bf16 v[164:167], v[52:55], a[164:167], v[164:167]
    ds_read_b64_tr_b16 v[130:131], v12 offset:12288
    ds_read_b64_tr_b16 v[96:97], v12 offset:16384
    v_mfma_f32_16x16x32_bf16 v[164:167], v[56:59], a[168:171], v[164:167]
    v_exp_f32 v173, v173
    v_mfma_f32_16x16x32_bf16 v[164:167], v[60:63], a[172:175], v[164:167]
    ds_read_b64_tr_b16 v[98:99], v12 offset:20480
    v_cvt_pk_bf16_f32 v182, v172, v173
    v_mfma_f32_16x16x32_bf16 a[136:139], v[136:139], v[236:239], a[136:139]
    v_exp_f32 v174, v174
    v_mfma_f32_16x16x32_bf16 a[136:139], v[104:107], v[176:179], a[136:139]
    ds_read_b64_tr_b16 v[132:133], v13 offset:8192
    ds_read_b64_tr_b16 v[134:135], v13 offset:12288
    v_mfma_f32_16x16x32_bf16 a[140:143], v[140:143], v[236:239], a[140:143]
    v_exp_f32 v175, v175
    v_mfma_f32_16x16x32_bf16 a[140:143], v[108:111], v[176:179], a[140:143]
    ds_read_b64_tr_b16 v[100:101], v13 offset:16384
    v_cvt_pk_bf16_f32 v183, v174, v175
    v_mfma_f32_16x16x32_bf16 v[168:171], v[64:67], a[176:179], v[204:207]
    v_exp_f32 v160, v160
    v_mfma_f32_16x16x32_bf16 v[168:171], v[68:71], a[180:183], v[168:171]
    ds_read_b64_tr_b16 v[102:103], v13 offset:20480
    ds_read_b64_tr_b16 v[136:137], v14 offset:8192
    v_mfma_f32_16x16x32_bf16 v[168:171], v[72:75], a[184:187], v[168:171]
    v_exp_f32 v161, v161
    v_mfma_f32_16x16x32_bf16 v[168:171], v[76:79], a[188:191], v[168:171]
    ds_read_b64_tr_b16 v[138:139], v14 offset:12288
    v_cvt_pk_bf16_f32 v232, v160, v161
    v_mfma_f32_16x16x32_bf16 a[144:147], v[144:147], v[236:239], a[144:147]
    v_exp_f32 v162, v162
    v_mfma_f32_16x16x32_bf16 a[144:147], v[112:115], v[176:179], a[144:147]
    ds_read_b64_tr_b16 v[104:105], v14 offset:16384
    ds_read_b64_tr_b16 v[106:107], v14 offset:20480
    v_mfma_f32_16x16x32_bf16 a[148:151], v[148:151], v[236:239], a[148:151]
    v_exp_f32 v163, v163
    v_mfma_f32_16x16x32_bf16 a[148:151], v[116:119], v[176:179], a[148:151]
    ds_read_b64_tr_b16 v[140:141], v15 offset:8192
    v_cvt_pk_bf16_f32 v233, v162, v163
    v_mfma_f32_16x16x32_bf16 v[172:175], v[80:83], a[176:179], v[204:207]
    v_exp_f32 v164, v164
    v_mfma_f32_16x16x32_bf16 v[172:175], v[84:87], a[180:183], v[172:175]
    ds_read_b64_tr_b16 v[142:143], v15 offset:12288
    ds_read_b64_tr_b16 v[108:109], v15 offset:16384
    v_mfma_f32_16x16x32_bf16 v[172:175], v[88:91], a[184:187], v[172:175]
    v_exp_f32 v165, v165
    v_mfma_f32_16x16x32_bf16 v[172:175], v[92:95], a[188:191], v[172:175]
    ds_read_b64_tr_b16 v[110:111], v15 offset:20480
    v_cvt_pk_bf16_f32 v234, v164, v165
    v_mfma_f32_16x16x32_bf16 a[152:155], v[152:155], v[236:239], a[152:155]
    v_exp_f32 v166, v166
    v_mfma_f32_16x16x32_bf16 a[152:155], v[120:123], v[176:179], a[152:155]
    ds_read_b64_tr_b16 v[144:145], v16 offset:8192
    ds_read_b64_tr_b16 v[146:147], v16 offset:12288
    v_mfma_f32_16x16x32_bf16 a[156:159], v[156:159], v[236:239], a[156:159]
    v_exp_f32 v167, v167
    v_mfma_f32_16x16x32_bf16 a[156:159], v[124:127], v[176:179], a[156:159]
    ds_read_b64_tr_b16 v[112:113], v16 offset:16384
    v_cvt_pk_bf16_f32 v235, v166, v167
    v_mfma_f32_16x16x32_bf16 v[160:163], v[32:35], a[176:179], v[204:207]
    v_exp_f32 v168, v168
    v_mfma_f32_16x16x32_bf16 v[160:163], v[36:39], a[180:183], v[160:163]
    ds_read_b64_tr_b16 v[114:115], v16 offset:20480
    ds_read_b64_tr_b16 v[148:149], v17 offset:8192
    v_mfma_f32_16x16x32_bf16 v[160:163], v[40:43], a[184:187], v[160:163]
    s_waitcnt lgkmcnt(13)
    v_exp_f32 v169, v169
    v_mfma_f32_16x16x32_bf16 v[160:163], v[44:47], a[188:191], v[160:163]
    ds_read_b64_tr_b16 v[150:151], v17 offset:12288
    v_cvt_pk_bf16_f32 v236, v168, v169
    v_mfma_f32_16x16x32_bf16 a[0:3], v[128:131], v[180:183], a[0:3]
    v_exp_f32 v170, v170
    v_mfma_f32_16x16x32_bf16 a[0:3], v[96:99], v[232:235], a[0:3]
    ds_read_b64_tr_b16 v[116:117], v17 offset:16384
    ds_read_b64_tr_b16 v[118:119], v17 offset:20480
    v_mfma_f32_16x16x32_bf16 a[4:7], v[132:135], v[180:183], a[4:7]
    v_exp_f32 v171, v171
    v_mfma_f32_16x16x32_bf16 a[4:7], v[100:103], v[232:235], a[4:7]
    ds_read_b64_tr_b16 v[152:153], v18 offset:8192
    v_cvt_pk_bf16_f32 v237, v170, v171
    v_mfma_f32_16x16x32_bf16 v[164:167], v[48:51], a[176:179], v[204:207]
    v_exp_f32 v172, v172
    v_mfma_f32_16x16x32_bf16 v[164:167], v[52:55], a[180:183], v[164:167]
    ds_read_b64_tr_b16 v[154:155], v18 offset:12288
    ds_read_b64_tr_b16 v[120:121], v18 offset:16384
    v_mfma_f32_16x16x32_bf16 v[164:167], v[56:59], a[184:187], v[164:167]
    s_waitcnt lgkmcnt(11)
    v_exp_f32 v173, v173
    v_mfma_f32_16x16x32_bf16 v[164:167], v[60:63], a[188:191], v[164:167]
    ds_read_b64_tr_b16 v[122:123], v18 offset:20480
    v_cvt_pk_bf16_f32 v238, v172, v173
    v_mfma_f32_16x16x32_bf16 a[8:11], v[136:139], v[180:183], a[8:11]
    v_exp_f32 v174, v174
    v_mfma_f32_16x16x32_bf16 a[8:11], v[104:107], v[232:235], a[8:11]
    ds_read_b64_tr_b16 v[156:157], v19 offset:8192
    ds_read_b64_tr_b16 v[158:159], v19 offset:12288
    v_mfma_f32_16x16x32_bf16 a[12:15], v[140:143], v[180:183], a[12:15]
    v_exp_f32 v175, v175
    v_mfma_f32_16x16x32_bf16 a[12:15], v[108:111], v[232:235], a[12:15]
    ds_read_b64_tr_b16 v[124:125], v19 offset:16384
    v_cvt_pk_bf16_f32 v239, v174, v175
    v_mfma_f32_16x16x32_bf16 v[168:171], v[64:67], a[192:195], v[208:211]
    s_waitcnt vmcnt(0)
    v_exp_f32 v160, v160
    v_mfma_f32_16x16x32_bf16 v[168:171], v[68:71], a[196:199], v[168:171]
    ds_read_b64_tr_b16 v[126:127], v19 offset:20480
    v_lshl_add_u32 v244, v244, 18, v251
    v_lshl_or_b32 v9, v9, 5, v10
    v_mfma_f32_16x16x32_bf16 v[168:171], v[72:75], a[200:203], v[168:171]
    s_waitcnt lgkmcnt(8)
    v_exp_f32 v161, v161
    v_mfma_f32_16x16x32_bf16 v[168:171], v[76:79], a[204:207], v[168:171]
    ds_write_b32 v244, v184
    v_lshl_add_u32 v245, v245, 18, v251
    v_cvt_pk_bf16_f32 v176, v160, v161
    v_mfma_f32_16x16x32_bf16 a[16:19], v[144:147], v[180:183], a[16:19]
    v_exp_f32 v162, v162
    v_mfma_f32_16x16x32_bf16 a[16:19], v[112:115], v[232:235], a[16:19]
    v_add_u32 v245, s42, v245
    v_lshl_add_u32 v254, v25, 5, s45
    v_xor_b32 v10, 0x80, v9
    v_mfma_f32_16x16x32_bf16 a[20:23], v[148:151], v[180:183], a[20:23]
    v_exp_f32 v163, v163
    v_mfma_f32_16x16x32_bf16 a[20:23], v[116:119], v[232:235], a[20:23]
    ds_write_b32 v245, v185
    v_lshl_add_u32 v246, v246, 18, v251
    v_cvt_pk_bf16_f32 v177, v162, v163
    v_mfma_f32_16x16x32_bf16 v[172:175], v[80:83], a[192:195], v[208:211]
    v_exp_f32 v164, v164
    v_mfma_f32_16x16x32_bf16 v[172:175], v[84:87], a[196:199], v[172:175]
    v_add_u32 v246, s43, v246
    v_mfma_f32_16x16x32_bf16 v[172:175], v[88:91], a[200:203], v[172:175]
    s_waitcnt lgkmcnt(2)
    v_exp_f32 v165, v165
    v_mfma_f32_16x16x32_bf16 v[172:175], v[92:95], a[204:207], v[172:175]
    ds_write_b32 v246, v186
    v_lshl_add_u32 v247, v247, 18, v251
    v_cvt_pk_bf16_f32 v178, v164, v165
    v_mfma_f32_16x16x32_bf16 a[24:27], v[152:155], v[180:183], a[24:27]
    v_exp_f32 v166, v166
    v_mfma_f32_16x16x32_bf16 a[24:27], v[120:123], v[232:235], a[24:27]
    v_add_u32 v247, s44, v247
    v_mfma_f32_16x16x32_bf16 a[28:31], v[156:159], v[180:183], a[28:31]
    v_exp_f32 v167, v167
    v_mfma_f32_16x16x32_bf16 a[28:31], v[124:127], v[232:235], a[28:31]
    ds_write_b32 v247, v187
    v_lshl_add_u32 v248, v248, 18, v251
    v_cvt_pk_bf16_f32 v179, v166, v167
    v_mfma_f32_16x16x32_bf16 v[160:163], v[32:35], a[192:195], v[208:211]
    v_exp_f32 v168, v168
    v_mfma_f32_16x16x32_bf16 v[160:163], v[36:39], a[196:199], v[160:163]
    v_add_u32 v248, s48, v248
    v_mfma_f32_16x16x32_bf16 v[160:163], v[40:43], a[200:203], v[160:163]
    v_exp_f32 v169, v169
    v_mfma_f32_16x16x32_bf16 v[160:163], v[44:47], a[204:207], v[160:163]
    ds_write_b32 v248, v188
    v_lshl_add_u32 v249, v249, 18, v251
    v_cvt_pk_bf16_f32 v180, v168, v169
    v_mfma_f32_16x16x32_bf16 a[32:35], v[128:131], v[236:239], a[32:35]
    v_exp_f32 v170, v170
    v_mfma_f32_16x16x32_bf16 a[32:35], v[96:99], v[176:179], a[32:35]
    ds_write_b128 v1, a[8:11] offset:8192
    v_add_u32 v249, s49, v249
    v_mfma_f32_16x16x32_bf16 a[36:39], v[132:135], v[236:239], a[36:39]
    v_exp_f32 v171, v171
    v_mfma_f32_16x16x32_bf16 a[36:39], v[100:103], v[176:179], a[36:39]
    ds_write_b32 v249, v189
    v_cvt_pk_bf16_f32 v181, v170, v171
    v_mfma_f32_16x16x32_bf16 v[164:167], v[48:51], a[192:195], v[208:211]
    v_exp_f32 v172, v172
    v_mfma_f32_16x16x32_bf16 v[164:167], v[52:55], a[196:199], v[164:167]
    ds_write_b128 v1, a[12:15] offset:9216
    v_mfma_f32_16x16x32_bf16 v[164:167], v[56:59], a[200:203], v[164:167]
    v_exp_f32 v173, v173
    v_mfma_f32_16x16x32_bf16 v[164:167], v[60:63], a[204:207], v[164:167]
    ds_read_b128 v[192:195], v254
    v_cvt_pk_bf16_f32 v182, v172, v173
    v_mfma_f32_16x16x32_bf16 a[40:43], v[136:139], v[236:239], a[40:43]
    v_exp_f32 v174, v174
    v_mfma_f32_16x16x32_bf16 a[40:43], v[104:107], v[176:179], a[40:43]
    ds_write_b128 v1, a[16:19] offset:10240
    v_mfma_f32_16x16x32_bf16 a[44:47], v[140:143], v[236:239], a[44:47]
    v_exp_f32 v175, v175
    v_mfma_f32_16x16x32_bf16 a[44:47], v[108:111], v[176:179], a[44:47]
    ds_read_b128 v[196:199], v254 offset:16
    v_cvt_pk_bf16_f32 v183, v174, v175
    v_mfma_f32_16x16x32_bf16 v[168:171], v[64:67], a[208:211], v[212:215]
    v_exp_f32 v160, v160
    v_mfma_f32_16x16x32_bf16 v[168:171], v[68:71], a[212:215], v[168:171]
    ds_write_b128 v1, a[20:23] offset:11264
    v_mfma_f32_16x16x32_bf16 v[168:171], v[72:75], a[216:219], v[168:171]
    v_exp_f32 v161, v161
    v_mfma_f32_16x16x32_bf16 v[168:171], v[76:79], a[220:223], v[168:171]
    v_cvt_pk_bf16_f32 v232, v160, v161
    v_mfma_f32_16x16x32_bf16 a[48:51], v[144:147], v[236:239], a[48:51]
    s_waitcnt lgkmcnt(1)
    v_exp_f32 v162, v162
    v_mfma_f32_16x16x32_bf16 a[48:51], v[112:115], v[176:179], a[48:51]
    ds_write_b128 v1, a[24:27] offset:12288
    v_mfma_f32_16x16x32_bf16 a[52:55], v[148:151], v[236:239], a[52:55]
    v_exp_f32 v163, v163
    v_mfma_f32_16x16x32_bf16 a[52:55], v[116:119], v[176:179], a[52:55]
    v_bitop3_b32 v192, v192, v9, s7 bitop3:0x28
    v_bitop3_b32 v193, v193, v10, s7 bitop3:0x28
    v_cvt_pk_bf16_f32 v233, v162, v163
    v_mfma_f32_16x16x32_bf16 v[172:175], v[80:83], a[208:211], v[212:215]
    v_exp_f32 v164, v164
    v_mfma_f32_16x16x32_bf16 v[172:175], v[84:87], a[212:215], v[172:175]
    ds_write_b128 v1, a[28:31] offset:13312
    v_mfma_f32_16x16x32_bf16 v[172:175], v[88:91], a[216:219], v[172:175]
    v_exp_f32 v165, v165
    v_mfma_f32_16x16x32_bf16 v[172:175], v[92:95], a[220:223], v[172:175]
    v_bitop3_b32 v194, v194, v9, s7 bitop3:0x28
    v_bitop3_b32 v195, v195, v10, s7 bitop3:0x28
    v_cvt_pk_bf16_f32 v234, v164, v165
    v_mfma_f32_16x16x32_bf16 a[56:59], v[152:155], v[236:239], a[56:59]
    v_exp_f32 v166, v166
    v_mfma_f32_16x16x32_bf16 a[56:59], v[120:123], v[176:179], a[56:59]
    buffer_load_dwordx4 a[160:163], v20, s[12:15], s40 offen offset:0 sc1
    v_mfma_f32_16x16x32_bf16 a[60:63], v[156:159], v[236:239], a[60:63]
    v_exp_f32 v167, v167
    v_mfma_f32_16x16x32_bf16 a[60:63], v[124:127], v[176:179], a[60:63]
    v_bitop3_b32 v196, v196, v9, s7 bitop3:0x28
    v_bitop3_b32 v197, v197, v10, s7 bitop3:0x28
    v_cvt_pk_bf16_f32 v235, v166, v167
    v_mfma_f32_16x16x32_bf16 v[160:163], v[32:35], a[208:211], v[212:215]
    v_exp_f32 v168, v168
    v_mfma_f32_16x16x32_bf16 v[160:163], v[36:39], a[212:215], v[160:163]
    buffer_load_dwordx4 a[164:167], v20, s[12:15], s40 offen offset:1024 sc1
    v_mfma_f32_16x16x32_bf16 v[160:163], v[40:43], a[216:219], v[160:163]
    v_exp_f32 v169, v169
    v_mfma_f32_16x16x32_bf16 v[160:163], v[44:47], a[220:223], v[160:163]
    v_bitop3_b32 v198, v198, v9, s7 bitop3:0x28
    v_bitop3_b32 v199, v199, v10, s7 bitop3:0x28
    v_cvt_pk_bf16_f32 v236, v168, v169
    v_mfma_f32_16x16x32_bf16 a[64:67], v[128:131], v[180:183], a[64:67]
    v_exp_f32 v170, v170
    v_mfma_f32_16x16x32_bf16 a[64:67], v[96:99], v[232:235], a[64:67]
    ds_write_b128 v1, a[40:43] offset:14336
    buffer_load_dwordx4 a[168:171], v20, s[12:15], s40 offen offset:2048 sc1
    v_mfma_f32_16x16x32_bf16 a[68:71], v[132:135], v[180:183], a[68:71]
    s_cmp_gt_u32 s46, 0
    s_cselect_b32 s54, 2560000, 0
    s_add_u32 m0, s30, 0
    v_exp_f32 v171, v171
    v_mfma_f32_16x16x32_bf16 a[68:71], v[100:103], v[232:235], a[68:71]
    buffer_load_dwordx4 v192, s[52:55], 0 offen sc1 lds
    v_cvt_pk_bf16_f32 v237, v170, v171
    v_mfma_f32_16x16x32_bf16 v[164:167], v[48:51], a[208:211], v[212:215]
    v_exp_f32 v172, v172
    v_mfma_f32_16x16x32_bf16 v[164:167], v[52:55], a[212:215], v[164:167]
    ds_write_b128 v1, a[44:47] offset:15360
    buffer_load_dwordx4 a[172:175], v20, s[12:15], s40 offen offset:3072 sc1
    v_mfma_f32_16x16x32_bf16 v[164:167], v[56:59], a[216:219], v[164:167]
    s_add_u32 m0, s30, 1024
    v_exp_f32 v173, v173
    v_mfma_f32_16x16x32_bf16 v[164:167], v[60:63], a[220:223], v[164:167]
    buffer_load_dwordx4 v193, s[52:55], 0 offen sc1 lds
    v_cvt_pk_bf16_f32 v238, v172, v173
    v_mfma_f32_16x16x32_bf16 a[72:75], v[136:139], v[180:183], a[72:75]
    v_exp_f32 v174, v174
    v_mfma_f32_16x16x32_bf16 a[72:75], v[104:107], v[232:235], a[72:75]
    ds_write_b128 v1, a[48:51] offset:16384
    buffer_load_dwordx4 a[176:179], v21, s[12:15], s40 offen offset:0 sc1
    v_mfma_f32_16x16x32_bf16 a[76:79], v[140:143], v[180:183], a[76:79]
    s_add_u32 m0, s30, 2048
    v_exp_f32 v175, v175
    v_mfma_f32_16x16x32_bf16 a[76:79], v[108:111], v[232:235], a[76:79]
    buffer_load_dwordx4 v194, s[52:55], 0 offen sc1 lds
    v_cvt_pk_bf16_f32 v239, v174, v175
    v_mfma_f32_16x16x32_bf16 v[168:171], v[64:67], a[224:227], v[216:219]
    v_exp_f32 v160, v160
    v_mfma_f32_16x16x32_bf16 v[168:171], v[68:71], a[228:231], v[168:171]
    ds_write_b128 v1, a[52:55] offset:17408
    buffer_load_dwordx4 a[180:183], v21, s[12:15], s40 offen offset:1024 sc1
    v_mfma_f32_16x16x32_bf16 v[168:171], v[72:75], a[232:235], v[168:171]
    s_add_u32 m0, s30, 3072
    v_exp_f32 v161, v161
    v_mfma_f32_16x16x32_bf16 v[168:171], v[76:79], a[236:239], v[168:171]
    buffer_load_dwordx4 v195, s[52:55], 0 offen sc1 lds
    v_cvt_pk_bf16_f32 v176, v160, v161
    v_mfma_f32_16x16x32_bf16 a[80:83], v[144:147], v[180:183], a[80:83]
    v_exp_f32 v162, v162
    v_mfma_f32_16x16x32_bf16 a[80:83], v[112:115], v[232:235], a[80:83]
    ds_write_b128 v1, a[56:59] offset:18432
    buffer_load_dwordx4 a[184:187], v21, s[12:15], s40 offen offset:2048 sc1
    v_mfma_f32_16x16x32_bf16 a[84:87], v[148:151], v[180:183], a[84:87]
    s_add_u32 m0, s30, 4096
    v_exp_f32 v163, v163
    v_mfma_f32_16x16x32_bf16 a[84:87], v[116:119], v[232:235], a[84:87]
    buffer_load_dwordx4 v196, s[52:55], 0 offen sc1 lds
    v_cvt_pk_bf16_f32 v177, v162, v163
    v_mfma_f32_16x16x32_bf16 v[172:175], v[80:83], a[224:227], v[216:219]
    v_exp_f32 v164, v164
    v_mfma_f32_16x16x32_bf16 v[172:175], v[84:87], a[228:231], v[172:175]
    ds_write_b128 v1, a[60:63] offset:19456
    buffer_load_dwordx4 a[188:191], v21, s[12:15], s40 offen offset:3072 sc1
    v_mfma_f32_16x16x32_bf16 v[172:175], v[88:91], a[232:235], v[172:175]
    s_add_u32 m0, s30, 5120
    v_exp_f32 v165, v165
    v_mfma_f32_16x16x32_bf16 v[172:175], v[92:95], a[236:239], v[172:175]
    buffer_load_dwordx4 v197, s[52:55], 0 offen sc1 lds
    v_cvt_pk_bf16_f32 v178, v164, v165
    v_mfma_f32_16x16x32_bf16 a[88:91], v[152:155], v[180:183], a[88:91]
    v_exp_f32 v166, v166
    v_mfma_f32_16x16x32_bf16 a[88:91], v[120:123], v[232:235], a[88:91]
    buffer_load_dwordx4 a[192:195], v20, s[12:15], s6 offen offset:0 sc1
    v_mfma_f32_16x16x32_bf16 a[92:95], v[156:159], v[180:183], a[92:95]
    s_add_u32 m0, s30, 6144
    v_exp_f32 v167, v167
    v_mfma_f32_16x16x32_bf16 a[92:95], v[124:127], v[232:235], a[92:95]
    buffer_load_dwordx4 v198, s[52:55], 0 offen sc1 lds
    v_cvt_pk_bf16_f32 v179, v166, v167
    v_mfma_f32_16x16x32_bf16 v[160:163], v[32:35], a[224:227], v[216:219]
    v_exp_f32 v168, v168
    v_mfma_f32_16x16x32_bf16 v[160:163], v[36:39], a[228:231], v[160:163]
    ds_write_b128 v1, a[72:75] offset:20480
    buffer_load_dwordx4 a[196:199], v20, s[12:15], s6 offen offset:1024 sc1
    v_mfma_f32_16x16x32_bf16 v[160:163], v[40:43], a[232:235], v[160:163]
    s_add_u32 m0, s30, 7168
    v_exp_f32 v169, v169
    v_mfma_f32_16x16x32_bf16 v[160:163], v[44:47], a[236:239], v[160:163]
    buffer_load_dwordx4 v199, s[52:55], 0 offen sc1 lds
    v_cvt_pk_bf16_f32 v180, v168, v169
    v_mfma_f32_16x16x32_bf16 a[96:99], v[128:131], v[236:239], a[96:99]
    v_exp_f32 v170, v170
    v_mfma_f32_16x16x32_bf16 a[96:99], v[96:99], v[176:179], a[96:99]
    ds_write_b128 v1, a[76:79] offset:21504
    buffer_load_dwordx4 a[200:203], v20, s[12:15], s6 offen offset:2048 sc1
    v_mfma_f32_16x16x32_bf16 a[100:103], v[132:135], v[236:239], a[100:103]
    v_exp_f32 v171, v171
    v_mfma_f32_16x16x32_bf16 a[100:103], v[100:103], v[176:179], a[100:103]
    v_cvt_pk_bf16_f32 v181, v170, v171
    v_mfma_f32_16x16x32_bf16 v[164:167], v[48:51], a[224:227], v[216:219]
    v_exp_f32 v172, v172
    v_mfma_f32_16x16x32_bf16 v[164:167], v[52:55], a[228:231], v[164:167]
    ds_write_b128 v1, a[80:83] offset:22528
    buffer_load_dwordx4 a[204:207], v20, s[12:15], s6 offen offset:3072 sc1
    v_mfma_f32_16x16x32_bf16 v[164:167], v[56:59], a[232:235], v[164:167]
    v_exp_f32 v173, v173
    v_mfma_f32_16x16x32_bf16 v[164:167], v[60:63], a[236:239], v[164:167]
    v_cvt_pk_bf16_f32 v182, v172, v173
    v_mfma_f32_16x16x32_bf16 a[104:107], v[136:139], v[236:239], a[104:107]
    v_exp_f32 v174, v174
    v_mfma_f32_16x16x32_bf16 a[104:107], v[104:107], v[176:179], a[104:107]
    ds_write_b128 v1, a[84:87] offset:23552
    buffer_load_dwordx4 a[208:211], v21, s[12:15], s6 offen offset:0 sc1
    v_mfma_f32_16x16x32_bf16 a[108:111], v[140:143], v[236:239], a[108:111]
    v_exp_f32 v175, v175
    v_mfma_f32_16x16x32_bf16 a[108:111], v[108:111], v[176:179], a[108:111]
    v_xor_b32 v3, 32768, v1
    v_xor_b32 v4, 65536, v1
    v_cvt_pk_bf16_f32 v183, v174, v175
    v_exp_f32 v160, v160
    ds_write_b128 v1, a[88:91] offset:24576
    buffer_load_dwordx4 a[212:215], v21, s[12:15], s6 offen offset:1024 sc1
    v_exp_f32 v161, v161
    v_xor_b32 v5, 98304, v1
    v_add_u32 v216, s45, v20
    v_cvt_pk_bf16_f32 v232, v160, v161
    v_mfma_f32_16x16x32_bf16 a[112:115], v[144:147], v[236:239], a[112:115]
    v_exp_f32 v162, v162
    v_mfma_f32_16x16x32_bf16 a[112:115], v[112:115], v[176:179], a[112:115]
    ds_write_b128 v1, a[92:95] offset:25600
    buffer_load_dwordx4 a[216:219], v21, s[12:15], s6 offen offset:2048 sc1
    v_mfma_f32_16x16x32_bf16 a[116:119], v[148:151], v[236:239], a[116:119]
    v_exp_f32 v163, v163
    v_mfma_f32_16x16x32_bf16 a[116:119], v[116:119], v[176:179], a[116:119]
    v_cvt_pk_bf16_f32 v233, v162, v163
    v_exp_f32 v164, v164
    buffer_load_dwordx4 a[220:223], v21, s[12:15], s6 offen offset:3072 sc1
    v_exp_f32 v165, v165
    s_nop 0
    v_cvt_pk_bf16_f32 v234, v164, v165
    v_mfma_f32_16x16x32_bf16 a[120:123], v[152:155], v[236:239], a[120:123]
    v_exp_f32 v166, v166
    v_mfma_f32_16x16x32_bf16 a[120:123], v[120:123], v[176:179], a[120:123]
    v_mfma_f32_16x16x32_bf16 a[124:127], v[156:159], v[236:239], a[124:127]
    v_exp_f32 v167, v167
    v_mfma_f32_16x16x32_bf16 a[124:127], v[124:127], v[176:179], a[124:127]
    v_cvt_pk_bf16_f32 v235, v166, v167
L2_epi:
    s_waitcnt lgkmcnt(0)
    s_barrier
    v_mfma_f32_16x16x32_bf16 a[128:131], v[128:131], v[180:183], a[128:131]
    ds_read_b128 v[72:75], v3 offset:8192
    ds_read_b128 v[76:79], v3 offset:9216
    v_mfma_f32_16x16x32_bf16 a[128:131], v[96:99], v[232:235], a[128:131]
    ds_read_b128 v[80:83], v4 offset:10240
    ds_read_b128 v[84:87], v4 offset:11264
    v_mfma_f32_16x16x32_bf16 a[132:135], v[132:135], v[180:183], a[132:135]
    ds_read_b128 v[88:91], v5 offset:12288
    ds_read_b128 v[92:95], v5 offset:13312
    v_mfma_f32_16x16x32_bf16 a[132:135], v[100:103], v[232:235], a[132:135]
    ds_read_b128 v[160:163], v3 offset:14336
    ds_read_b128 v[164:167], v3 offset:15360
    v_mfma_f32_16x16x32_bf16 a[136:139], v[136:139], v[180:183], a[136:139]
    ds_read_b128 v[168:171], v4 offset:16384
    ds_read_b128 v[172:175], v4 offset:17408
    v_mfma_f32_16x16x32_bf16 a[136:139], v[104:107], v[232:235], a[136:139]
    ds_read_b128 v[184:187], v5 offset:18432
    ds_read_b128 v[188:191], v5 offset:19456
    v_mfma_f32_16x16x32_bf16 a[140:143], v[140:143], v[180:183], a[140:143]
    ds_read_b128 v[192:195], v3 offset:20480
    ds_read_b128 v[196:199], v3 offset:21504
    v_mfma_f32_16x16x32_bf16 a[140:143], v[108:111], v[232:235], a[140:143]
    ds_read_b128 v[200:203], v4 offset:22528
    ds_read_b128 v[204:207], v4 offset:23552
    v_mfma_f32_16x16x32_bf16 a[144:147], v[144:147], v[180:183], a[144:147]
    ds_read_b128 v[208:211], v5 offset:24576
    ds_read_b128 v[212:215], v5 offset:25600
    v_mfma_f32_16x16x32_bf16 a[144:147], v[112:115], v[232:235], a[144:147]
    v_accvgpr_read_b32 v32, a0
    v_accvgpr_read_b32 v33, a1
    v_mfma_f32_16x16x32_bf16 a[148:151], v[148:151], v[180:183], a[148:151]
    v_accvgpr_read_b32 v34, a2
    v_accvgpr_read_b32 v35, a3
    v_mfma_f32_16x16x32_bf16 a[148:151], v[116:119], v[232:235], a[148:151]
    v_accvgpr_read_b32 v36, a4
    v_accvgpr_read_b32 v37, a5
    v_mfma_f32_16x16x32_bf16 a[152:155], v[152:155], v[180:183], a[152:155]
    v_accvgpr_read_b32 v38, a6
    v_accvgpr_read_b32 v39, a7
    v_mfma_f32_16x16x32_bf16 a[152:155], v[120:123], v[232:235], a[152:155]
    v_accvgpr_read_b32 v40, a32
    v_accvgpr_read_b32 v41, a33
    v_mfma_f32_16x16x32_bf16 a[156:159], v[156:159], v[180:183], a[156:159]
    v_accvgpr_read_b32 v42, a34
    v_accvgpr_read_b32 v43, a35
    v_mfma_f32_16x16x32_bf16 a[156:159], v[124:127], v[232:235], a[156:159]
    v_accvgpr_read_b32 v44, a36
    v_accvgpr_read_b32 v45, a37
    v_accvgpr_read_b32 v46, a38
    v_accvgpr_read_b32 v47, a39
    v_accvgpr_read_b32 v48, a64
    v_accvgpr_read_b32 v49, a65
    v_accvgpr_read_b32 v50, a66
    v_accvgpr_read_b32 v51, a67
    v_accvgpr_read_b32 v52, a68
    v_accvgpr_read_b32 v53, a69
    v_accvgpr_read_b32 v54, a70
    v_accvgpr_read_b32 v55, a71
    s_mul_i32 s42, s56, 10240
    s_mul_i32 s43, s3, 2560
    s_add_u32 s43, s43, 3473408
    s_add_u32 s42, s42, s43
    s_mul_i32 s44, s2, 10240
    s_add_u32 s43, s43, s44
    v_sub_u32 v6, 23, v24
    v_lshlrev_b32 v6, 6, v6
    v_lshl_add_u32 v6, v25, 4, v6
    v_cmp_gt_u32 vcc, 8, v24
    v_subrev_u32 v7, 1024, v6
    v_mov_b32 v31, 0x7fffff00
    v_cndmask_b32 v7, v31, v7, vcc
    s_waitcnt lgkmcnt(15)
    v_pk_add_f32 v[32:33], v[32:33], v[72:73]
    v_pk_add_f32 v[34:35], v[34:35], v[74:75]
    v_pk_add_f32 v[36:37], v[36:37], v[76:77]
    v_pk_add_f32 v[38:39], v[38:39], v[78:79]
    ds_write_b128 v1, a[104:107] offset:26624
    s_waitcnt lgkmcnt(15)
    v_pk_add_f32 v[32:33], v[32:33], v[80:81]
    v_pk_add_f32 v[34:35], v[34:35], v[82:83]
    v_pk_add_f32 v[36:37], v[36:37], v[84:85]
    v_pk_add_f32 v[38:39], v[38:39], v[86:87]
    ds_write_b128 v1, a[108:111] offset:27648
    s_waitcnt lgkmcnt(14)
    v_pk_add_f32 v[32:33], v[32:33], v[88:89]
    v_pk_add_f32 v[34:35], v[34:35], v[90:91]
    v_pk_add_f32 v[36:37], v[36:37], v[92:93]
    v_pk_add_f32 v[38:39], v[38:39], v[94:95]
    ds_write_b128 v1, a[112:115] offset:28672
    v_cvt_pk_bf16_f32 v240, v32, v33
    v_cvt_pk_bf16_f32 v241, v34, v35
    v_cvt_pk_bf16_f32 v242, v36, v37
    v_cvt_pk_bf16_f32 v243, v38, v39
    ds_write_b128 v1, a[116:119] offset:29696
    buffer_store_dwordx4 v[240:243], v6, s[12:15], s42 offen offset:1024 sc1
    s_waitcnt lgkmcnt(14)
    v_pk_add_f32 v[40:41], v[40:41], v[160:161]
    v_pk_add_f32 v[42:43], v[42:43], v[162:163]
    v_pk_add_f32 v[44:45], v[44:45], v[164:165]
    v_pk_add_f32 v[46:47], v[46:47], v[166:167]
    ds_write_b128 v1, a[120:123] offset:30720
    s_waitcnt lgkmcnt(13)
    v_pk_add_f32 v[40:41], v[40:41], v[168:169]
    v_pk_add_f32 v[42:43], v[42:43], v[170:171]
    v_pk_add_f32 v[44:45], v[44:45], v[172:173]
    v_pk_add_f32 v[46:47], v[46:47], v[174:175]
    ds_write_b128 v1, a[124:127] offset:31744
    s_waitcnt lgkmcnt(12)
    v_pk_add_f32 v[40:41], v[40:41], v[184:185]
    v_pk_add_f32 v[42:43], v[42:43], v[186:187]
    v_pk_add_f32 v[44:45], v[44:45], v[188:189]
    v_pk_add_f32 v[46:47], v[46:47], v[190:191]
    ds_write_b128 v216, a[136:139] offset:2048
    v_cvt_pk_bf16_f32 v244, v40, v41
    v_cvt_pk_bf16_f32 v245, v42, v43
    v_cvt_pk_bf16_f32 v246, v44, v45
    v_cvt_pk_bf16_f32 v247, v46, v47
    ds_write_b128 v216, a[140:143] offset:3072
    buffer_store_dwordx4 v[244:247], v6, s[12:15], s42 offen offset:0 sc1
    s_waitcnt lgkmcnt(12)
    v_pk_add_f32 v[48:49], v[48:49], v[192:193]
    v_pk_add_f32 v[50:51], v[50:51], v[194:195]
    v_pk_add_f32 v[52:53], v[52:53], v[196:197]
    v_pk_add_f32 v[54:55], v[54:55], v[198:199]
    ds_write_b128 v216, a[144:147] offset:4096
    s_waitcnt lgkmcnt(11)
    v_pk_add_f32 v[48:49], v[48:49], v[200:201]
    v_pk_add_f32 v[50:51], v[50:51], v[202:203]
    v_pk_add_f32 v[52:53], v[52:53], v[204:205]
    v_pk_add_f32 v[54:55], v[54:55], v[206:207]
    ds_write_b128 v216, a[148:151] offset:5120
    s_waitcnt lgkmcnt(10)
    v_pk_add_f32 v[48:49], v[48:49], v[208:209]
    v_pk_add_f32 v[50:51], v[50:51], v[210:211]
    v_pk_add_f32 v[52:53], v[52:53], v[212:213]
    v_pk_add_f32 v[54:55], v[54:55], v[214:215]
    ds_write_b128 v216, a[152:155] offset:6144
    v_cvt_pk_bf16_f32 v248, v48, v49
    v_cvt_pk_bf16_f32 v249, v50, v51
    v_cvt_pk_bf16_f32 v250, v52, v53
    v_cvt_pk_bf16_f32 v251, v54, v55
    ds_write_b128 v216, a[156:159] offset:7168
    buffer_store_dwordx4 v[248:251], v7, s[12:15], s42 offen offset:0 sc1
    s_waitcnt lgkmcnt(0)
    s_barrier
    s_add_u32 s46, s46, 31
    s_lshr_b32 s46, s46, 5
    v_lshl_add_u32 v254, v25, 5, s45
    v_lshl_add_u32 v255, v25, 2, s45
    ds_read_b128 v[160:163], v254 offset:128
    ds_read_b128 v[164:167], v254 offset:144
    ds_read_b128 v[168:171], v254 offset:256
    ds_read_b128 v[172:175], v254 offset:272
    v_xor_b32 v200, 8192, v216
    v_xor_b32 v201, 16384, v216
    v_xor_b32 v202, 24576, v216
    ds_read_b128 v[96:99], v3 offset:26624
    ds_read_b128 v[100:103], v3 offset:27648
    ds_read_b128 v[104:107], v4 offset:28672
    ds_read_b128 v[108:111], v4 offset:29696
    ds_read_b128 v[112:115], v5 offset:30720
    ds_read_b128 v[116:119], v5 offset:31744
    ds_read_b128 v[120:123], v200 offset:2048
    ds_read_b128 v[124:127], v200 offset:3072
    ds_read_b128 v[128:131], v201 offset:4096
    ds_read_b128 v[132:135], v201 offset:5120
    ds_read_b128 v[136:139], v202 offset:6144
    ds_read_b128 v[140:143], v202 offset:7168
    v_lshlrev_b32 v11, 16, v27
    v_lshl_or_b32 v26, v26, 16, v26
    s_waitcnt lgkmcnt(12)
    v_accvgpr_read_b32 v56, a96
    s_cmp_gt_u32 s46, 1
    s_cselect_b32 s54, 2560000, 0
    s_add_u32 m0, s30, 8192
    v_bitop3_b32 v160, v160, v9, s7 bitop3:0x28
    buffer_load_dwordx4 v160, s[52:55], 0 offen sc1 lds
    v_accvgpr_read_b32 v57, a97
    v_accvgpr_read_b32 v58, a98
    v_accvgpr_read_b32 v59, a99
    v_accvgpr_read_b32 v60, a100
    v_accvgpr_read_b32 v61, a101
    s_add_u32 m0, s30, 9216
    v_bitop3_b32 v161, v161, v10, s7 bitop3:0x28
    buffer_load_dwordx4 v161, s[52:55], 0 offen sc1 lds
    v_accvgpr_read_b32 v62, a102
    v_accvgpr_read_b32 v63, a103
    v_accvgpr_read_b32 v64, a128
    v_accvgpr_read_b32 v65, a129
    v_accvgpr_read_b32 v66, a130
    v_accvgpr_read_b32 v67, a131
    s_add_u32 m0, s30, 10240
    v_bitop3_b32 v162, v162, v9, s7 bitop3:0x28
    buffer_load_dwordx4 v162, s[52:55], 0 offen sc1 lds
    v_accvgpr_read_b32 v68, a132
    v_accvgpr_read_b32 v69, a133
    v_accvgpr_read_b32 v70, a134
    v_accvgpr_read_b32 v71, a135
    s_waitcnt lgkmcnt(10)
    v_pk_add_f32 v[56:57], v[56:57], v[96:97]
    s_add_u32 m0, s30, 11264
    v_bitop3_b32 v163, v163, v10, s7 bitop3:0x28
    buffer_load_dwordx4 v163, s[52:55], 0 offen sc1 lds
    v_pk_add_f32 v[58:59], v[58:59], v[98:99]
    v_pk_add_f32 v[60:61], v[60:61], v[100:101]
    v_pk_add_f32 v[62:63], v[62:63], v[102:103]
    s_waitcnt lgkmcnt(8)
    v_pk_add_f32 v[56:57], v[56:57], v[104:105]
    v_pk_add_f32 v[58:59], v[58:59], v[106:107]
    s_add_u32 m0, s30, 12288
    v_bitop3_b32 v164, v164, v9, s7 bitop3:0x28
    buffer_load_dwordx4 v164, s[52:55], 0 offen sc1 lds
    v_pk_add_f32 v[60:61], v[60:61], v[108:109]
    v_pk_add_f32 v[62:63], v[62:63], v[110:111]
    s_waitcnt lgkmcnt(6)
    v_pk_add_f32 v[56:57], v[56:57], v[112:113]
    v_pk_add_f32 v[58:59], v[58:59], v[114:115]
    s_add_u32 m0, s30, 13312
    v_bitop3_b32 v165, v165, v10, s7 bitop3:0x28
    buffer_load_dwordx4 v165, s[52:55], 0 offen sc1 lds
    v_pk_add_f32 v[60:61], v[60:61], v[116:117]
    v_pk_add_f32 v[62:63], v[62:63], v[118:119]
    s_waitcnt lgkmcnt(4)
    v_pk_add_f32 v[64:65], v[64:65], v[120:121]
    v_pk_add_f32 v[66:67], v[66:67], v[122:123]
    v_pk_add_f32 v[68:69], v[68:69], v[124:125]
    s_add_u32 m0, s30, 14336
    v_bitop3_b32 v166, v166, v9, s7 bitop3:0x28
    buffer_load_dwordx4 v166, s[52:55], 0 offen sc1 lds
    v_pk_add_f32 v[70:71], v[70:71], v[126:127]
    s_waitcnt lgkmcnt(2)
    v_pk_add_f32 v[64:65], v[64:65], v[128:129]
    v_pk_add_f32 v[66:67], v[66:67], v[130:131]
    v_pk_add_f32 v[68:69], v[68:69], v[132:133]
    v_pk_add_f32 v[70:71], v[70:71], v[134:135]
    s_add_u32 m0, s30, 15360
    v_bitop3_b32 v167, v167, v10, s7 bitop3:0x28
    buffer_load_dwordx4 v167, s[52:55], 0 offen sc1 lds
    s_waitcnt lgkmcnt(0)
    v_pk_add_f32 v[64:65], v[64:65], v[136:137]
    v_pk_add_f32 v[66:67], v[66:67], v[138:139]
    v_pk_add_f32 v[68:69], v[68:69], v[140:141]
    v_pk_add_f32 v[70:71], v[70:71], v[142:143]
    s_barrier
    v_add_u32 v215, 133120, v20
    s_cmp_gt_u32 s46, 2
    s_cselect_b32 s54, 2560000, 0
    s_add_u32 m0, s30, 16384
    v_bitop3_b32 v168, v168, v9, s7 bitop3:0x28
    buffer_load_dwordx4 v168, s[52:55], 0 offen sc1 lds
    ds_read_b128 v[176:179], v254 offset:384
    ds_read_b128 v[180:183], v254 offset:400
    s_add_u32 m0, s30, 17408
    v_bitop3_b32 v169, v169, v10, s7 bitop3:0x28
    buffer_load_dwordx4 v169, s[52:55], 0 offen sc1 lds
    ds_read_b128 v[184:187], v254 offset:512
    ds_read_b128 v[188:191], v254 offset:528
    s_add_u32 m0, s30, 18432
    v_bitop3_b32 v170, v170, v9, s7 bitop3:0x28
    buffer_load_dwordx4 v170, s[52:55], 0 offen sc1 lds
    v_cmp_eq_u32 vcc, 0, v25
    v_mov_b32 v236, 0x3f80
    v_mov_b32 v237, 0
    s_add_u32 m0, s30, 19456
    v_bitop3_b32 v171, v171, v10, s7 bitop3:0x28
    buffer_load_dwordx4 v171, s[52:55], 0 offen sc1 lds
    v_mov_b32 v238, 0
    v_mov_b32 v239, 0
    s_add_u32 m0, s30, 20480
    v_bitop3_b32 v172, v172, v9, s7 bitop3:0x28
    buffer_load_dwordx4 v172, s[52:55], 0 offen sc1 lds
    v_cndmask_b32 v236, 0, v236, vcc
    s_lshl_b32 s57, s2, 7
    s_add_u32 m0, s30, 21504
    v_bitop3_b32 v173, v173, v10, s7 bitop3:0x28
    buffer_load_dwordx4 v173, s[52:55], 0 offen sc1 lds
    s_lshl_b32 s50, s3, 2
    s_add_u32 s50, s50, 2719744
    s_add_u32 s57, s57, s50
    s_add_u32 m0, s30, 22528
    v_bitop3_b32 v174, v174, v9, s7 bitop3:0x28
    buffer_load_dwordx4 v174, s[52:55], 0 offen sc1 lds
    s_lshl_b32 s51, s56, 7
    s_add_u32 s51, s51, s50
    s_add_u32 m0, s30, 23552
    v_bitop3_b32 v175, v175, v10, s7 bitop3:0x28
    buffer_load_dwordx4 v175, s[52:55], 0 offen sc1 lds
    s_mov_b32 s49, 0x40000
    v_mov_b32 v2, s59
    s_waitcnt vmcnt(16)
    buffer_store_dword v2, off, s[12:15], s57 sc1
    s_waitcnt lgkmcnt(0)
    ds_read2_b32 v[84:85], v255 offset0:0 offset1:8
    s_cmp_gt_u32 s46, 3
    s_cselect_b32 s54, 2560000, 0
    s_add_u32 m0, s30, 24576
    v_bitop3_b32 v176, v176, v9, s7 bitop3:0x28
    buffer_load_dwordx4 v176, s[52:55], 0 offen sc1 lds
    ds_read2_b32 v[86:87], v255 offset0:16 offset1:24
    ds_read2_b32 v[88:89], v255 offset0:4 offset1:12
    ds_read2_b32 v[90:91], v255 offset0:20 offset1:28
    ds_read_b128 v[160:163], v254 offset:640
    s_add_u32 m0, s30, 25600
    v_bitop3_b32 v177, v177, v10, s7 bitop3:0x28
    buffer_load_dwordx4 v177, s[52:55], 0 offen sc1 lds
    ds_read_b128 v[164:167], v254 offset:656
    ds_read_b64_tr_b16 a[96:97], v12 offset:0
    ds_read_b64_tr_b16 a[98:99], v12 offset:4096
    ds_read_b64_tr_b16 a[100:101], v13 offset:0
    ds_read_b64_tr_b16 a[102:103], v13 offset:4096
    s_add_u32 m0, s30, 26624
    v_bitop3_b32 v178, v178, v9, s7 bitop3:0x28
    buffer_load_dwordx4 v178, s[52:55], 0 offen sc1 lds
    ds_read_b64_tr_b16 a[104:105], v14 offset:0
    ds_read_b64_tr_b16 a[106:107], v14 offset:4096
    ds_read_b64_tr_b16 a[108:109], v15 offset:0
    ds_read_b64_tr_b16 a[110:111], v15 offset:4096
    s_waitcnt lgkmcnt(8)
    s_add_u32 m0, s30, 27648
    v_bitop3_b32 v179, v179, v10, s7 bitop3:0x28
    buffer_load_dwordx4 v179, s[52:55], 0 offen sc1 lds
    ds_read_b64_tr_b16 a[112:113], v16 offset:0
    v_lshlrev_b32 v92, v84, v27
    v_lshl_or_b32 v92, v11, v85, v92
    v_pk_ashrrev_i16 v92, 15, v92 op_sel_hi:[0,1]
    v_and_b32 v92, v26, v92
    s_add_u32 m0, s30, 28672
    v_bitop3_b32 v180, v180, v9, s7 bitop3:0x28
    buffer_load_dwordx4 v180, s[52:55], 0 offen sc1 lds
    ds_read_b64_tr_b16 a[114:115], v16 offset:4096
    v_lshlrev_b32 v93, v86, v27
    v_lshl_or_b32 v93, v11, v87, v93
    v_pk_ashrrev_i16 v93, 15, v93 op_sel_hi:[0,1]
    v_and_b32 v93, v26, v93
    s_add_u32 m0, s30, 29696
    v_bitop3_b32 v181, v181, v10, s7 bitop3:0x28
    buffer_load_dwordx4 v181, s[52:55], 0 offen sc1 lds
    ds_read_b64_tr_b16 a[116:117], v17 offset:0
    v_lshlrev_b32 v94, v88, v27
    v_lshl_or_b32 v94, v11, v89, v94
    v_pk_ashrrev_i16 v94, 15, v94 op_sel_hi:[0,1]
    v_and_b32 v94, v26, v94
    s_add_u32 m0, s30, 30720
    v_bitop3_b32 v182, v182, v9, s7 bitop3:0x28
    buffer_load_dwordx4 v182, s[52:55], 0 offen sc1 lds
    ds_read_b64_tr_b16 a[118:119], v17 offset:4096
    v_lshlrev_b32 v95, v90, v27
    v_lshl_or_b32 v95, v11, v91, v95
    v_pk_ashrrev_i16 v95, 15, v95 op_sel_hi:[0,1]
    v_and_b32 v95, v26, v95
    s_add_u32 m0, s30, 31744
    v_bitop3_b32 v183, v183, v10, s7 bitop3:0x28
    buffer_load_dwordx4 v183, s[52:55], 0 offen sc1 lds
    ds_read_b64_tr_b16 a[120:121], v18 offset:0
    ds_read_b64_tr_b16 a[122:123], v18 offset:4096
    ds_read_b64_tr_b16 a[124:125], v19 offset:0
    ds_read_b64_tr_b16 a[126:127], v19 offset:4096
    s_waitcnt lgkmcnt(0)
    v_mfma_f32_16x16x32_bf16 v[96:99], a[96:99], v[92:95], 0
    v_mfma_f32_16x16x32_bf16 v[100:103], a[100:103], v[92:95], 0
    s_cmp_gt_u32 s46, 4
    s_cselect_b32 s54, 2560000, 0
    s_add_u32 m0, s30, 0
    v_bitop3_b32 v184, v184, v9, s7 bitop3:0x28
    buffer_load_dwordx4 v184, s[52:55], 0 offen sc1 lds
    s_add_u32 m0, s30, 1024
    v_bitop3_b32 v185, v185, v10, s7 bitop3:0x28
    buffer_load_dwordx4 v185, s[52:55], 0 offen sc1 lds
    s_waitcnt vmcnt(19)
    ds_read2_b32 v[84:85], v255 offset0:32 offset1:40
    s_add_u32 m0, s30, 2048
    v_bitop3_b32 v186, v186, v9, s7 bitop3:0x28
    buffer_load_dwordx4 v186, s[52:55], 0 offen sc1 lds
    ds_read2_b32 v[86:87], v255 offset0:48 offset1:56
    v_mfma_f32_16x16x32_bf16 v[104:107], a[104:107], v[92:95], 0
    ds_read2_b32 v[88:89], v255 offset0:36 offset1:44
    ds_read2_b32 v[90:91], v255 offset0:52 offset1:60
    ds_read_b64_tr_b16 a[128:129], v12 offset:8192
    ds_read_b64_tr_b16 a[130:131], v12 offset:12288
    v_mfma_f32_16x16x32_bf16 v[108:111], a[108:111], v[92:95], 0
    s_add_u32 m0, s30, 3072
    v_bitop3_b32 v187, v187, v10, s7 bitop3:0x28
    buffer_load_dwordx4 v187, s[52:55], 0 offen sc1 lds
    ds_read_b64_tr_b16 a[132:133], v13 offset:8192
    ds_read_b64_tr_b16 a[134:135], v13 offset:12288
    ds_read_b64_tr_b16 a[136:137], v14 offset:8192
    ds_read_b64_tr_b16 a[138:139], v14 offset:12288
    v_mfma_f32_16x16x32_bf16 v[112:115], a[112:115], v[92:95], 0
    ds_read_b64_tr_b16 a[140:141], v15 offset:8192
    ds_read_b64_tr_b16 a[142:143], v15 offset:12288
    s_add_u32 m0, s30, 4096
    v_bitop3_b32 v188, v188, v9, s7 bitop3:0x28
    buffer_load_dwordx4 v188, s[52:55], 0 offen sc1 lds
    s_waitcnt lgkmcnt(8)
    ds_read_b64_tr_b16 a[144:145], v16 offset:8192
    v_mfma_f32_16x16x32_bf16 v[116:119], a[116:119], v[92:95], 0
    v_lshlrev_b32 v80, v84, v27
    v_lshl_or_b32 v80, v11, v85, v80
    v_pk_ashrrev_i16 v80, 15, v80 op_sel_hi:[0,1]
    v_and_b32 v80, v26, v80
    s_add_u32 m0, s30, 5120
    v_bitop3_b32 v189, v189, v10, s7 bitop3:0x28
    buffer_load_dwordx4 v189, s[52:55], 0 offen sc1 lds
    v_mfma_f32_16x16x32_bf16 v[120:123], a[120:123], v[92:95], 0
    ds_read_b64_tr_b16 a[146:147], v16 offset:12288
    v_lshlrev_b32 v81, v86, v27
    v_lshl_or_b32 v81, v11, v87, v81
    v_pk_ashrrev_i16 v81, 15, v81 op_sel_hi:[0,1]
    v_mfma_f32_16x16x32_bf16 v[124:127], a[124:127], v[92:95], 0
    v_and_b32 v81, v26, v81
    s_add_u32 m0, s30, 6144
    v_bitop3_b32 v190, v190, v9, s7 bitop3:0x28
    buffer_load_dwordx4 v190, s[52:55], 0 offen sc1 lds
    ds_read_b64_tr_b16 a[148:149], v17 offset:8192
    v_lshlrev_b32 v82, v88, v27
    v_lshl_or_b32 v82, v11, v89, v82
    v_pk_ashrrev_i16 v82, 15, v82 op_sel_hi:[0,1]
    v_and_b32 v82, v26, v82
    ds_read_b64_tr_b16 a[150:151], v17 offset:12288
    v_lshlrev_b32 v83, v90, v27
    s_add_u32 m0, s30, 7168
    v_bitop3_b32 v191, v191, v10, s7 bitop3:0x28
    buffer_load_dwordx4 v191, s[52:55], 0 offen sc1 lds
    v_lshl_or_b32 v83, v11, v91, v83
    v_pk_ashrrev_i16 v83, 15, v83 op_sel_hi:[0,1]
    v_and_b32 v83, v26, v83
    ds_read_b64_tr_b16 a[152:153], v18 offset:8192
    ds_read_b64_tr_b16 a[154:155], v18 offset:12288
    ds_read_b64_tr_b16 a[156:157], v19 offset:8192
    ds_read_b64_tr_b16 a[158:159], v19 offset:12288
    buffer_load_dword v232, off, s[12:15], s51 sc1
    s_waitcnt lgkmcnt(0)
    v_mfma_f32_16x16x32_bf16 v[96:99], a[128:131], v[80:83], v[96:99]
    v_mfma_f32_16x16x32_bf16 v[100:103], a[132:135], v[80:83], v[100:103]
    s_cmp_gt_u32 s46, 5
    s_cselect_b32 s54, 2560000, 0
    s_add_u32 m0, s30, 8192
    v_bitop3_b32 v160, v160, v9, s7 bitop3:0x28
    buffer_load_dwordx4 v160, s[52:55], 0 offen sc1 lds
    s_add_u32 m0, s30, 9216
    v_bitop3_b32 v161, v161, v10, s7 bitop3:0x28
    buffer_load_dwordx4 v161, s[52:55], 0 offen sc1 lds
    s_waitcnt vmcnt(20)
    ds_read2_b32 v[84:85], v255 offset0:64 offset1:72
    s_add_u32 m0, s30, 10240
    v_bitop3_b32 v162, v162, v9, s7 bitop3:0x28
    buffer_load_dwordx4 v162, s[52:55], 0 offen sc1 lds
    ds_read2_b32 v[86:87], v255 offset0:80 offset1:88
    v_mfma_f32_16x16x32_bf16 v[104:107], a[136:139], v[80:83], v[104:107]
    ds_read2_b32 v[88:89], v255 offset0:68 offset1:76
    ds_read2_b32 v[90:91], v255 offset0:84 offset1:92
    ds_read_b64_tr_b16 a[96:97], v12 offset:16384
    ds_read_b64_tr_b16 a[98:99], v12 offset:20480
    v_mfma_f32_16x16x32_bf16 v[108:111], a[140:143], v[80:83], v[108:111]
    s_add_u32 m0, s30, 11264
    v_bitop3_b32 v163, v163, v10, s7 bitop3:0x28
    buffer_load_dwordx4 v163, s[52:55], 0 offen sc1 lds
    ds_read_b64_tr_b16 a[100:101], v13 offset:16384
    ds_read_b64_tr_b16 a[102:103], v13 offset:20480
    ds_read_b64_tr_b16 a[104:105], v14 offset:16384
    ds_read_b64_tr_b16 a[106:107], v14 offset:20480
    v_mfma_f32_16x16x32_bf16 v[112:115], a[144:147], v[80:83], v[112:115]
    ds_read_b64_tr_b16 a[108:109], v15 offset:16384
    ds_read_b64_tr_b16 a[110:111], v15 offset:20480
    s_add_u32 m0, s30, 12288
    v_bitop3_b32 v164, v164, v9, s7 bitop3:0x28
    buffer_load_dwordx4 v164, s[52:55], 0 offen sc1 lds
    s_waitcnt lgkmcnt(8)
    ds_read_b64_tr_b16 a[112:113], v16 offset:16384
    v_mfma_f32_16x16x32_bf16 v[116:119], a[148:151], v[80:83], v[116:119]
    v_lshlrev_b32 v92, v84, v27
    v_lshl_or_b32 v92, v11, v85, v92
    v_pk_ashrrev_i16 v92, 15, v92 op_sel_hi:[0,1]
    v_and_b32 v92, v26, v92
    s_add_u32 m0, s30, 13312
    v_bitop3_b32 v165, v165, v10, s7 bitop3:0x28
    buffer_load_dwordx4 v165, s[52:55], 0 offen sc1 lds
    v_mfma_f32_16x16x32_bf16 v[120:123], a[152:155], v[80:83], v[120:123]
    ds_read_b64_tr_b16 a[114:115], v16 offset:20480
    v_lshlrev_b32 v93, v86, v27
    v_lshl_or_b32 v93, v11, v87, v93
    v_pk_ashrrev_i16 v93, 15, v93 op_sel_hi:[0,1]
    v_mfma_f32_16x16x32_bf16 v[124:127], a[156:159], v[80:83], v[124:127]
    v_and_b32 v93, v26, v93
    s_add_u32 m0, s30, 14336
    v_bitop3_b32 v166, v166, v9, s7 bitop3:0x28
    buffer_load_dwordx4 v166, s[52:55], 0 offen sc1 lds
    ds_read_b64_tr_b16 a[116:117], v17 offset:16384
    v_lshlrev_b32 v94, v88, v27
    v_lshl_or_b32 v94, v11, v89, v94
    v_pk_ashrrev_i16 v94, 15, v94 op_sel_hi:[0,1]
    v_and_b32 v94, v26, v94
    ds_read_b64_tr_b16 a[118:119], v17 offset:20480
    v_lshlrev_b32 v95, v90, v27
    s_add_u32 m0, s30, 15360
    v_bitop3_b32 v167, v167, v10, s7 bitop3:0x28
    buffer_load_dwordx4 v167, s[52:55], 0 offen sc1 lds
    v_lshl_or_b32 v95, v11, v91, v95
    v_pk_ashrrev_i16 v95, 15, v95 op_sel_hi:[0,1]
    v_and_b32 v95, v26, v95
    ds_read_b64_tr_b16 a[120:121], v18 offset:16384
    ds_read_b64_tr_b16 a[122:123], v18 offset:20480
    ds_read_b64_tr_b16 a[124:125], v19 offset:16384
    ds_read_b64_tr_b16 a[126:127], v19 offset:20480
    v_add_u32 v219, 8, v24
    v_lshlrev_b32 v219, 6, v219
    v_lshl_add_u32 v219, v25, 4, v219
    v_cmp_lt_u32 vcc, 7, v24
    v_subrev_u32 v218, 1024, v219
    s_mov_b32 s58, 0xffff0000
    v_cndmask_b32 v218, v31, v218, vcc
    v_add_u32 v210, -8, v24
    v_max_i32 v210, 0, v210
    v_mul_u32_u24 v211, 26, v210
    v_lshrrev_b32 v211, 8, v211
    v_mul_u32_u24 v212, 10, v211
    v_sub_u32 v210, v210, v212
    v_lshl_add_u32 v210, v25, 4, v210
    v_lshlrev_b32 v210, 4, v210
    v_lshl_add_u32 v206, v211, 15, v210
    v_add_u32 v210, 8, v24
    v_mul_u32_u24 v211, 26, v210
    v_lshrrev_b32 v211, 8, v211
    v_mul_u32_u24 v212, 10, v211
    v_sub_u32 v210, v210, v212
    v_lshl_add_u32 v210, v25, 4, v210
    v_lshlrev_b32 v210, 4, v210
    v_lshl_add_u32 v207, v211, 15, v210
    v_add_u32 v210, 24, v24
    v_mul_u32_u24 v211, 26, v210
    v_lshrrev_b32 v211, 8, v211
    v_mul_u32_u24 v212, 10, v211
    v_sub_u32 v210, v210, v212
    v_lshl_add_u32 v210, v25, 4, v210
    v_lshlrev_b32 v210, 4, v210
    v_lshl_add_u32 v208, v211, 15, v210
    s_lshl_b32 s41, s3, 10
    v_add_u32 v3, s41, v1
    v_xor_b32 v4, 1024, v3
    v_xor_b32 v5, 2048, v3
    v_xor_b32 v6, 3072, v3
    s_waitcnt vmcnt(8)
L2_poll:
    v_readfirstlane_b32 s50, v232
    s_nop 0
    s_cmp_eq_u32 s50, s59
    s_cbranch_scc1 L2_got
    buffer_load_dword v232, off, s[12:15], s51 sc1
    s_sub_u32 s49, s49, 1
    s_waitcnt vmcnt(0)
    s_cbranch_scc0 L2_poll
L2_got:
    buffer_load_dwordx4 v[32:35], v218, s[12:15], s43 offen offset:0 sc1
    buffer_load_dwordx4 v[36:39], v219, s[12:15], s43 offen offset:0 sc1
    buffer_load_dwordx4 v[40:43], v219, s[12:15], s43 offen offset:1024 sc1
    s_waitcnt lgkmcnt(0)
    v_mfma_f32_16x16x32_bf16 v[96:99], a[96:99], v[92:95], v[96:99]
    v_mfma_f32_16x16x32_bf16 v[100:103], a[100:103], v[92:95], v[100:103]
    s_waitcnt vmcnt(20)
    ds_read2_b32 v[84:85], v255 offset0:96 offset1:104
    ds_read2_b32 v[86:87], v255 offset0:112 offset1:120
    v_mfma_f32_16x16x32_bf16 v[104:107], a[104:107], v[92:95], v[104:107]
    ds_read2_b32 v[88:89], v255 offset0:100 offset1:108
    ds_read2_b32 v[90:91], v255 offset0:116 offset1:124
    ds_read_b64_tr_b16 a[128:129], v12 offset:24576
    ds_read_b64_tr_b16 a[130:131], v12 offset:28672
    v_mfma_f32_16x16x32_bf16 v[108:111], a[108:111], v[92:95], v[108:111]
    ds_read_b64_tr_b16 a[132:133], v13 offset:24576
    ds_read_b64_tr_b16 a[134:135], v13 offset:28672
    ds_read_b64_tr_b16 a[136:137], v14 offset:24576
    ds_read_b64_tr_b16 a[138:139], v14 offset:28672
    v_mfma_f32_16x16x32_bf16 v[112:115], a[112:115], v[92:95], v[112:115]
    ds_read_b64_tr_b16 a[140:141], v15 offset:24576
    ds_read_b64_tr_b16 a[142:143], v15 offset:28672
    s_waitcnt lgkmcnt(8)
    ds_read_b64_tr_b16 a[144:145], v16 offset:24576
    v_mfma_f32_16x16x32_bf16 v[116:119], a[116:119], v[92:95], v[116:119]
    v_lshlrev_b32 v80, v84, v27
    v_lshl_or_b32 v80, v11, v85, v80
    v_pk_ashrrev_i16 v80, 15, v80 op_sel_hi:[0,1]
    v_and_b32 v80, v26, v80
    v_mfma_f32_16x16x32_bf16 v[120:123], a[120:123], v[92:95], v[120:123]
    ds_read_b64_tr_b16 a[146:147], v16 offset:28672
    v_lshlrev_b32 v81, v86, v27
    v_lshl_or_b32 v81, v11, v87, v81
    v_pk_ashrrev_i16 v81, 15, v81 op_sel_hi:[0,1]
    v_mfma_f32_16x16x32_bf16 v[124:127], a[124:127], v[92:95], v[124:127]
    v_and_b32 v81, v26, v81
    ds_read_b64_tr_b16 a[148:149], v17 offset:24576
    v_lshlrev_b32 v82, v88, v27
    v_lshl_or_b32 v82, v11, v89, v82
    v_pk_ashrrev_i16 v82, 15, v82 op_sel_hi:[0,1]
    v_and_b32 v82, v26, v82
    ds_read_b64_tr_b16 a[150:151], v17 offset:28672
    v_lshlrev_b32 v83, v90, v27
    v_lshl_or_b32 v83, v11, v91, v83
    v_pk_ashrrev_i16 v83, 15, v83 op_sel_hi:[0,1]
    v_and_b32 v83, v26, v83
    ds_read_b64_tr_b16 a[152:153], v18 offset:24576
    ds_read_b64_tr_b16 a[154:155], v18 offset:28672
    ds_read_b64_tr_b16 a[156:157], v19 offset:24576
    ds_read_b64_tr_b16 a[158:159], v19 offset:28672
    s_cmp_le_u32 s46, 6
    s_cbranch_scc1 L2_no7a
    ds_read_b128 v[184:187], v254 offset:768
    ds_read_b128 v[188:191], v254 offset:784
    s_waitcnt lgkmcnt(0)
    s_cmp_gt_u32 s46, 6
    s_cselect_b32 s54, 2560000, 0
    s_add_u32 m0, s30, 16384
    v_bitop3_b32 v184, v184, v9, s7 bitop3:0x28
    buffer_load_dwordx4 v184, s[52:55], 0 offen sc1 lds
    s_add_u32 m0, s30, 17408
    v_bitop3_b32 v185, v185, v10, s7 bitop3:0x28
    buffer_load_dwordx4 v185, s[52:55], 0 offen sc1 lds
    s_add_u32 m0, s30, 18432
    v_bitop3_b32 v186, v186, v9, s7 bitop3:0x28
    buffer_load_dwordx4 v186, s[52:55], 0 offen sc1 lds
    s_add_u32 m0, s30, 19456
    v_bitop3_b32 v187, v187, v10, s7 bitop3:0x28
    buffer_load_dwordx4 v187, s[52:55], 0 offen sc1 lds
    s_add_u32 m0, s30, 20480
    v_bitop3_b32 v188, v188, v9, s7 bitop3:0x28
    buffer_load_dwordx4 v188, s[52:55], 0 offen sc1 lds
    s_add_u32 m0, s30, 21504
    v_bitop3_b32 v189, v189, v10, s7 bitop3:0x28
    buffer_load_dwordx4 v189, s[52:55], 0 offen sc1 lds
    s_add_u32 m0, s30, 22528
    v_bitop3_b32 v190, v190, v9, s7 bitop3:0x28
    buffer_load_dwordx4 v190, s[52:55], 0 offen sc1 lds
    s_add_u32 m0, s30, 23552
    v_bitop3_b32 v191, v191, v10, s7 bitop3:0x28
    buffer_load_dwordx4 v191, s[52:55], 0 offen sc1 lds
L2_no7a:
    s_waitcnt lgkmcnt(0)
    v_mfma_f32_16x16x32_bf16 v[96:99], a[128:131], v[80:83], v[96:99]
    v_mfma_f32_16x16x32_bf16 v[100:103], a[132:135], v[80:83], v[100:103]
    v_lshlrev_b32 v160, 16, v220
    v_and_b32 v161, s58, v220
    v_lshlrev_b32 v162, 16, v221
    v_and_b32 v163, s58, v221
    s_waitcnt vmcnt(12)
    ds_read2_b32 v[84:85], v255 offset0:128 offset1:136
    v_lshlrev_b32 v164, 16, v222
    v_and_b32 v165, s58, v222
    ds_read2_b32 v[86:87], v255 offset0:144 offset1:152
    v_mfma_f32_16x16x32_bf16 v[104:107], a[136:139], v[80:83], v[104:107]
    ds_read2_b32 v[88:89], v255 offset0:132 offset1:140
    ds_read2_b32 v[90:91], v255 offset0:148 offset1:156
    v_lshlrev_b32 v166, 16, v223
    v_and_b32 v167, s58, v223
    ds_read_b64_tr_b16 a[96:97], v12 offset:0
    ds_read_b64_tr_b16 a[98:99], v12 offset:4096
    v_mfma_f32_16x16x32_bf16 v[108:111], a[140:143], v[80:83], v[108:111]
    ds_read_b64_tr_b16 a[100:101], v13 offset:0
    v_lshlrev_b32 v168, 16, v224
    v_and_b32 v169, s58, v224
    ds_read_b64_tr_b16 a[102:103], v13 offset:4096
    ds_read_b64_tr_b16 a[104:105], v14 offset:0
    ds_read_b64_tr_b16 a[106:107], v14 offset:4096
    v_mfma_f32_16x16x32_bf16 v[112:115], a[144:147], v[80:83], v[112:115]
    v_lshlrev_b32 v170, 16, v225
    v_and_b32 v171, s58, v225
    ds_read_b64_tr_b16 a[108:109], v15 offset:0
    ds_read_b64_tr_b16 a[110:111], v15 offset:4096
    s_waitcnt lgkmcnt(8)
    ds_read_b64_tr_b16 a[112:113], v16 offset:0
    v_mfma_f32_16x16x32_bf16 v[116:119], a[148:151], v[80:83], v[116:119]
    v_lshlrev_b32 v172, 16, v226
    v_and_b32 v173, s58, v226
    v_lshlrev_b32 v92, v84, v27
    v_lshl_or_b32 v92, v11, v85, v92
    v_pk_ashrrev_i16 v92, 15, v92 op_sel_hi:[0,1]
    v_and_b32 v92, v26, v92
    v_lshlrev_b32 v174, 16, v227
    v_and_b32 v175, s58, v227
    v_mfma_f32_16x16x32_bf16 v[120:123], a[152:155], v[80:83], v[120:123]
    ds_read_b64_tr_b16 a[114:115], v16 offset:4096
    v_lshlrev_b32 v93, v86, v27
    v_lshl_or_b32 v93, v11, v87, v93
    v_lshlrev_b32 v176, 16, v228
    v_and_b32 v177, s58, v228
    v_pk_ashrrev_i16 v93, 15, v93 op_sel_hi:[0,1]
    v_mfma_f32_16x16x32_bf16 v[124:127], a[156:159], v[80:83], v[124:127]
    v_and_b32 v93, v26, v93
    ds_read_b64_tr_b16 a[116:117], v17 offset:0
    v_lshlrev_b32 v94, v88, v27
    v_lshlrev_b32 v178, 16, v229
    v_and_b32 v179, s58, v229
    v_lshl_or_b32 v94, v11, v89, v94
    v_pk_ashrrev_i16 v94, 15, v94 op_sel_hi:[0,1]
    v_and_b32 v94, v26, v94
    ds_read_b64_tr_b16 a[118:119], v17 offset:4096
    v_lshlrev_b32 v180, 16, v230
    v_and_b32 v181, s58, v230
    v_lshlrev_b32 v95, v90, v27
    v_lshl_or_b32 v95, v11, v91, v95
    v_pk_ashrrev_i16 v95, 15, v95 op_sel_hi:[0,1]
    v_and_b32 v95, v26, v95
    v_lshlrev_b32 v182, 16, v231
    v_and_b32 v183, s58, v231
    ds_read_b64_tr_b16 a[120:121], v18 offset:0
    ds_read_b64_tr_b16 a[122:123], v18 offset:4096
    ds_read_b64_tr_b16 a[124:125], v19 offset:0
    ds_read_b64_tr_b16 a[126:127], v19 offset:4096
    s_waitcnt lgkmcnt(0)
    v_mfma_f32_16x16x32_bf16 v[96:99], a[96:99], v[92:95], v[96:99]
    v_mfma_f32_16x16x32_bf16 v[100:103], a[100:103], v[92:95], v[100:103]
    s_waitcnt vmcnt(3)
    ds_read2_b32 v[84:85], v255 offset0:160 offset1:168
    ds_read2_b32 v[86:87], v255 offset0:176 offset1:184
    v_mfma_f32_16x16x32_bf16 v[104:107], a[104:107], v[92:95], v[104:107]
    ds_read2_b32 v[88:89], v255 offset0:164 offset1:172
    ds_read2_b32 v[90:91], v255 offset0:180 offset1:188
    ds_read_b64_tr_b16 a[128:129], v12 offset:8192
    ds_read_b64_tr_b16 a[130:131], v12 offset:12288
    v_mfma_f32_16x16x32_bf16 v[108:111], a[108:111], v[92:95], v[108:111]
    ds_read_b64_tr_b16 a[132:133], v13 offset:8192
    ds_read_b64_tr_b16 a[134:135], v13 offset:12288
    ds_read_b64_tr_b16 a[136:137], v14 offset:8192
    ds_read_b64_tr_b16 a[138:139], v14 offset:12288
    v_mfma_f32_16x16x32_bf16 v[112:115], a[112:115], v[92:95], v[112:115]
    ds_read_b64_tr_b16 a[140:141], v15 offset:8192
    ds_read_b64_tr_b16 a[142:143], v15 offset:12288
    s_waitcnt lgkmcnt(8)
    ds_read_b64_tr_b16 a[144:145], v16 offset:8192
    v_mfma_f32_16x16x32_bf16 v[116:119], a[116:119], v[92:95], v[116:119]
    v_lshlrev_b32 v80, v84, v27
    v_lshl_or_b32 v80, v11, v85, v80
    v_pk_ashrrev_i16 v80, 15, v80 op_sel_hi:[0,1]
    v_and_b32 v80, v26, v80
    v_mfma_f32_16x16x32_bf16 v[120:123], a[120:123], v[92:95], v[120:123]
    ds_read_b64_tr_b16 a[146:147], v16 offset:12288
    v_lshlrev_b32 v81, v86, v27
    v_lshl_or_b32 v81, v11, v87, v81
    v_pk_ashrrev_i16 v81, 15, v81 op_sel_hi:[0,1]
    v_mfma_f32_16x16x32_bf16 v[124:127], a[124:127], v[92:95], v[124:127]
    v_and_b32 v81, v26, v81
    ds_read_b64_tr_b16 a[148:149], v17 offset:8192
    v_lshlrev_b32 v82, v88, v27
    v_lshl_or_b32 v82, v11, v89, v82
    v_pk_ashrrev_i16 v82, 15, v82 op_sel_hi:[0,1]
    v_and_b32 v82, v26, v82
    ds_read_b64_tr_b16 a[150:151], v17 offset:12288
    v_lshlrev_b32 v83, v90, v27
    v_lshl_or_b32 v83, v11, v91, v83
    v_pk_ashrrev_i16 v83, 15, v83 op_sel_hi:[0,1]
    v_and_b32 v83, v26, v83
    ds_read_b64_tr_b16 a[152:153], v18 offset:8192
    ds_read_b64_tr_b16 a[154:155], v18 offset:12288
    ds_read_b64_tr_b16 a[156:157], v19 offset:8192
    ds_read_b64_tr_b16 a[158:159], v19 offset:12288
    s_waitcnt lgkmcnt(0)
    v_mfma_f32_16x16x32_bf16 v[96:99], a[128:131], v[80:83], v[96:99]
    v_mfma_f32_16x16x32_bf16 v[100:103], a[132:135], v[80:83], v[100:103]
    v_mfma_f32_16x16x32_bf16 v[104:107], a[136:139], v[80:83], v[104:107]
    v_mfma_f32_16x16x32_bf16 v[108:111], a[140:143], v[80:83], v[108:111]
    v_mfma_f32_16x16x32_bf16 v[112:115], a[144:147], v[80:83], v[112:115]
    v_mfma_f32_16x16x32_bf16 v[116:119], a[148:151], v[80:83], v[116:119]
    v_mfma_f32_16x16x32_bf16 v[120:123], a[152:155], v[80:83], v[120:123]
    v_mfma_f32_16x16x32_bf16 v[124:127], a[156:159], v[80:83], v[124:127]
    s_cmp_le_u32 s46, 6
    s_cbranch_scc1 L2_aggdone
    s_waitcnt vmcnt(0)
    ds_read2_b32 v[84:85], v255 offset0:192 offset1:200
    ds_read2_b32 v[86:87], v255 offset0:208 offset1:216
    ds_read2_b32 v[88:89], v255 offset0:196 offset1:204
    ds_read2_b32 v[90:91], v255 offset0:212 offset1:220
    ds_read_b64_tr_b16 a[96:97], v12 offset:16384
    ds_read_b64_tr_b16 a[98:99], v12 offset:20480
    ds_read_b64_tr_b16 a[100:101], v13 offset:16384
    ds_read_b64_tr_b16 a[102:103], v13 offset:20480
    ds_read_b64_tr_b16 a[104:105], v14 offset:16384
    ds_read_b64_tr_b16 a[106:107], v14 offset:20480
    ds_read_b64_tr_b16 a[108:109], v15 offset:16384
    ds_read_b64_tr_b16 a[110:111], v15 offset:20480
    s_waitcnt lgkmcnt(8)
    ds_read_b64_tr_b16 a[112:113], v16 offset:16384
    v_lshlrev_b32 v92, v84, v27
    v_lshl_or_b32 v92, v11, v85, v92
    v_pk_ashrrev_i16 v92, 15, v92 op_sel_hi:[0,1]
    v_and_b32 v92, v26, v92
    ds_read_b64_tr_b16 a[114:115], v16 offset:20480
    v_lshlrev_b32 v93, v86, v27
    v_lshl_or_b32 v93, v11, v87, v93
    v_pk_ashrrev_i16 v93, 15, v93 op_sel_hi:[0,1]
    v_and_b32 v93, v26, v93
    ds_read_b64_tr_b16 a[116:117], v17 offset:16384
    v_lshlrev_b32 v94, v88, v27
    v_lshl_or_b32 v94, v11, v89, v94
    v_pk_ashrrev_i16 v94, 15, v94 op_sel_hi:[0,1]
    v_and_b32 v94, v26, v94
    ds_read_b64_tr_b16 a[118:119], v17 offset:20480
    v_lshlrev_b32 v95, v90, v27
    v_lshl_or_b32 v95, v11, v91, v95
    v_pk_ashrrev_i16 v95, 15, v95 op_sel_hi:[0,1]
    v_and_b32 v95, v26, v95
    ds_read_b64_tr_b16 a[120:121], v18 offset:16384
    ds_read_b64_tr_b16 a[122:123], v18 offset:20480
    ds_read_b64_tr_b16 a[124:125], v19 offset:16384
    ds_read_b64_tr_b16 a[126:127], v19 offset:20480
    s_waitcnt lgkmcnt(0)
    v_mfma_f32_16x16x32_bf16 v[96:99], a[96:99], v[92:95], v[96:99]
    v_mfma_f32_16x16x32_bf16 v[100:103], a[100:103], v[92:95], v[100:103]
    v_mfma_f32_16x16x32_bf16 v[104:107], a[104:107], v[92:95], v[104:107]
    v_mfma_f32_16x16x32_bf16 v[108:111], a[108:111], v[92:95], v[108:111]
    v_mfma_f32_16x16x32_bf16 v[112:115], a[112:115], v[92:95], v[112:115]
    v_mfma_f32_16x16x32_bf16 v[116:119], a[116:119], v[92:95], v[116:119]
    v_mfma_f32_16x16x32_bf16 v[120:123], a[120:123], v[92:95], v[120:123]
    v_mfma_f32_16x16x32_bf16 v[124:127], a[124:127], v[92:95], v[124:127]
    s_mov_b32 s47, 7
    v_add_u32 v254, 896, v254
    v_add_u32 v255, 896, v255
L2_more:
    s_cmp_ge_u32 s47, s46
    s_cbranch_scc1 L2_aggdone
    ds_read_b128 v[184:187], v254 offset:0
    ds_read_b128 v[188:191], v254 offset:16
    s_waitcnt lgkmcnt(0)
    s_cmp_gt_u32 s46, 0
    s_cselect_b32 s54, 2560000, 0
    s_add_u32 m0, s30, 0
    v_bitop3_b32 v184, v184, v9, s7 bitop3:0x28
    buffer_load_dwordx4 v184, s[52:55], 0 offen sc1 lds
    s_add_u32 m0, s30, 1024
    v_bitop3_b32 v185, v185, v10, s7 bitop3:0x28
    buffer_load_dwordx4 v185, s[52:55], 0 offen sc1 lds
    s_add_u32 m0, s30, 2048
    v_bitop3_b32 v186, v186, v9, s7 bitop3:0x28
    buffer_load_dwordx4 v186, s[52:55], 0 offen sc1 lds
    s_add_u32 m0, s30, 3072
    v_bitop3_b32 v187, v187, v10, s7 bitop3:0x28
    buffer_load_dwordx4 v187, s[52:55], 0 offen sc1 lds
    s_add_u32 m0, s30, 4096
    v_bitop3_b32 v188, v188, v9, s7 bitop3:0x28
    buffer_load_dwordx4 v188, s[52:55], 0 offen sc1 lds
    s_add_u32 m0, s30, 5120
    v_bitop3_b32 v189, v189, v10, s7 bitop3:0x28
    buffer_load_dwordx4 v189, s[52:55], 0 offen sc1 lds
    s_add_u32 m0, s30, 6144
    v_bitop3_b32 v190, v190, v9, s7 bitop3:0x28
    buffer_load_dwordx4 v190, s[52:55], 0 offen sc1 lds
    s_add_u32 m0, s30, 7168
    v_bitop3_b32 v191, v191, v10, s7 bitop3:0x28
    buffer_load_dwordx4 v191, s[52:55], 0 offen sc1 lds
    s_waitcnt vmcnt(0)
    ds_read2_b32 v[84:85], v255 offset0:0 offset1:8
    ds_read2_b32 v[86:87], v255 offset0:16 offset1:24
    ds_read2_b32 v[88:89], v255 offset0:4 offset1:12
    ds_read2_b32 v[90:91], v255 offset0:20 offset1:28
    ds_read_b64_tr_b16 a[96:97], v12 offset:0
    ds_read_b64_tr_b16 a[98:99], v12 offset:4096
    ds_read_b64_tr_b16 a[100:101], v13 offset:0
    ds_read_b64_tr_b16 a[102:103], v13 offset:4096
    ds_read_b64_tr_b16 a[104:105], v14 offset:0
    ds_read_b64_tr_b16 a[106:107], v14 offset:4096
    ds_read_b64_tr_b16 a[108:109], v15 offset:0
    ds_read_b64_tr_b16 a[110:111], v15 offset:4096
    s_waitcnt lgkmcnt(8)
    ds_read_b64_tr_b16 a[112:113], v16 offset:0
    v_lshlrev_b32 v92, v84, v27
    v_lshl_or_b32 v92, v11, v85, v92
    v_pk_ashrrev_i16 v92, 15, v92 op_sel_hi:[0,1]
    v_and_b32 v92, v26, v92
    ds_read_b64_tr_b16 a[114:115], v16 offset:4096
    v_lshlrev_b32 v93, v86, v27
    v_lshl_or_b32 v93, v11, v87, v93
    v_pk_ashrrev_i16 v93, 15, v93 op_sel_hi:[0,1]
    v_and_b32 v93, v26, v93
    ds_read_b64_tr_b16 a[116:117], v17 offset:0
    v_lshlrev_b32 v94, v88, v27
    v_lshl_or_b32 v94, v11, v89, v94
    v_pk_ashrrev_i16 v94, 15, v94 op_sel_hi:[0,1]
    v_and_b32 v94, v26, v94
    ds_read_b64_tr_b16 a[118:119], v17 offset:4096
    v_lshlrev_b32 v95, v90, v27
    v_lshl_or_b32 v95, v11, v91, v95
    v_pk_ashrrev_i16 v95, 15, v95 op_sel_hi:[0,1]
    v_and_b32 v95, v26, v95
    ds_read_b64_tr_b16 a[120:121], v18 offset:0
    ds_read_b64_tr_b16 a[122:123], v18 offset:4096
    ds_read_b64_tr_b16 a[124:125], v19 offset:0
    ds_read_b64_tr_b16 a[126:127], v19 offset:4096
    s_waitcnt lgkmcnt(0)
    v_mfma_f32_16x16x32_bf16 v[96:99], a[96:99], v[92:95], v[96:99]
    v_mfma_f32_16x16x32_bf16 v[100:103], a[100:103], v[92:95], v[100:103]
    v_mfma_f32_16x16x32_bf16 v[104:107], a[104:107], v[92:95], v[104:107]
    v_mfma_f32_16x16x32_bf16 v[108:111], a[108:111], v[92:95], v[108:111]
    v_mfma_f32_16x16x32_bf16 v[112:115], a[112:115], v[92:95], v[112:115]
    v_mfma_f32_16x16x32_bf16 v[116:119], a[116:119], v[92:95], v[116:119]
    v_mfma_f32_16x16x32_bf16 v[120:123], a[120:123], v[92:95], v[120:123]
    v_mfma_f32_16x16x32_bf16 v[124:127], a[124:127], v[92:95], v[124:127]
    s_add_u32 s47, s47, 1
    v_add_u32 v254, 128, v254
    v_add_u32 v255, 128, v255
    s_branch L2_more
L2_aggdone:
    s_max_u32 s41, s84, s85
    s_max_u32 s41, s41, s86
    s_max_u32 s41, s41, s87
    s_max_u32 s41, s41, s88
    s_max_u32 s41, s41, s89
    s_cmp_le_u32 s41, 64
    s_cbranch_scc1 L2_aggend
    s_min_u32 s41, s84, 64
    s_sub_u32 s84, s84, s41
    s_add_u32 s90, s90, 256
    s_min_u32 s41, s85, 64
    s_sub_u32 s85, s85, s41
    s_add_u32 s91, s91, 256
    s_min_u32 s41, s86, 64
    s_sub_u32 s86, s86, s41
    s_add_u32 s92, s92, 256
    s_min_u32 s41, s87, 64
    s_sub_u32 s87, s87, s41
    s_add_u32 s93, s93, 256
    s_min_u32 s41, s88, 64
    s_sub_u32 s88, s88, s41
    s_add_u32 s94, s94, 256
    s_min_u32 s41, s89, 64
    s_sub_u32 s89, s89, s41
    s_add_u32 s95, s95, 256
    s_min_u32 s60, s84, 64
    s_mov_b32 s46, s60
    s_min_u32 s61, s85, 64
    s_lshl_b32 s42, s46, 2
    s_add_u32 s46, s46, s61
    s_min_u32 s62, s86, 64
    s_lshl_b32 s43, s46, 2
    s_add_u32 s46, s46, s62
    s_min_u32 s63, s87, 64
    s_lshl_b32 s44, s46, 2
    s_add_u32 s46, s46, s63
    s_min_u32 s50, s88, 64
    s_lshl_b32 s48, s46, 2
    s_add_u32 s46, s46, s50
    s_min_u32 s51, s89, 64
    s_lshl_b32 s49, s46, 2
    s_add_u32 s46, s46, s51
    s_waitcnt vmcnt(0)
    v_add_u32 v250, 1, v0
    v_add_u32 v251, s45, v23
    v_sub_u32 v244, v250, s60 clamp
    v_lshl_add_u32 v192, v244, 26, v23
    buffer_load_dword v184, v192, s[12:15], s90 offen sc1
    v_sub_u32 v245, v250, s61 clamp
    v_lshl_add_u32 v193, v245, 26, v23
    buffer_load_dword v185, v193, s[12:15], s91 offen sc1
    v_sub_u32 v246, v250, s62 clamp
    v_lshl_add_u32 v194, v246, 26, v23
    buffer_load_dword v186, v194, s[12:15], s92 offen sc1
    v_sub_u32 v247, v250, s63 clamp
    v_lshl_add_u32 v195, v247, 26, v23
    buffer_load_dword v187, v195, s[12:15], s93 offen sc1
    v_sub_u32 v248, v250, s50 clamp
    v_lshl_add_u32 v196, v248, 26, v23
    buffer_load_dword v188, v196, s[12:15], s94 offen sc1
    v_sub_u32 v249, v250, s51 clamp
    v_lshl_add_u32 v197, v249, 26, v23
    buffer_load_dword v189, v197, s[12:15], s95 offen sc1
    v_lshl_add_u32 v252, s46, 2, v251
    v_mov_b32 v253, 0x7fffff0f
    ds_write_b32 v252, v253
    s_waitcnt vmcnt(0)
    v_lshl_add_u32 v244, v244, 18, v251
    ds_write_b32 v244, v184
    v_lshl_add_u32 v245, v245, 18, v251
    v_add_u32 v245, s42, v245
    ds_write_b32 v245, v185
    v_lshl_add_u32 v246, v246, 18, v251
    v_add_u32 v246, s43, v246
    ds_write_b32 v246, v186
    v_lshl_add_u32 v247, v247, 18, v251
    v_add_u32 v247, s44, v247
    ds_write_b32 v247, v187
    v_lshl_add_u32 v248, v248, 18, v251
    v_add_u32 v248, s48, v248
    ds_write_b32 v248, v188
    v_lshl_add_u32 v249, v249, 18, v251
    v_add_u32 v249, s49, v249
    ds_write_b32 v249, v189
    s_add_u32 s46, s46, 31
    s_lshr_b32 s46, s46, 5
    v_lshl_add_u32 v254, v25, 5, s45
    v_lshl_add_u32 v255, v25, 2, s45
    s_mov_b32 s47, 0
    s_branch L2_more
L2_aggend:
    v_cvt_pk_bf16_f32 v128, v96, v97
    v_cvt_pk_bf16_f32 v129, v98, v99
    v_cvt_pk_bf16_f32 v130, v100, v101
    v_cvt_pk_bf16_f32 v131, v102, v103
    ds_write_b128 v3, v[128:131]
    v_cvt_pk_bf16_f32 v132, v104, v105
    v_cvt_pk_bf16_f32 v133, v106, v107
    v_cvt_pk_bf16_f32 v134, v108, v109
    v_cvt_pk_bf16_f32 v135, v110, v111
    ds_write_b128 v4, v[132:135]
    v_cvt_pk_bf16_f32 v136, v112, v113
    v_cvt_pk_bf16_f32 v137, v114, v115
    v_cvt_pk_bf16_f32 v138, v116, v117
    v_cvt_pk_bf16_f32 v139, v118, v119
    ds_write_b128 v5, v[136:139]
    v_cvt_pk_bf16_f32 v140, v120, v121
    v_cvt_pk_bf16_f32 v141, v122, v123
    v_cvt_pk_bf16_f32 v142, v124, v125
    v_cvt_pk_bf16_f32 v143, v126, v127
    ds_write_b128 v6, v[140:143]
    s_waitcnt vmcnt(0)
    s_mov_b32 s41, 0x3f80
    s_mov_b32 s42, 0x3f800000
    v_dot2_f32_bf16 v48, v32, s41, v48
    v_dot2_f32_bf16 v49, v32, s42, v49
    v_dot2_f32_bf16 v50, v33, s41, v50
    v_dot2_f32_bf16 v51, v33, s42, v51
    v_dot2_f32_bf16 v52, v34, s41, v52
    v_dot2_f32_bf16 v53, v34, s42, v53
    v_dot2_f32_bf16 v54, v35, s41, v54
    v_dot2_f32_bf16 v55, v35, s42, v55
    v_cvt_pk_bf16_f32 v240, v48, v49
    v_cvt_pk_bf16_f32 v241, v50, v51
    v_cvt_pk_bf16_f32 v242, v52, v53
    v_cvt_pk_bf16_f32 v243, v54, v55
    ds_write_b128 v216, v[240:243] offset:2048
    v_dot2_f32_bf16 v56, v36, s41, v56
    v_dot2_f32_bf16 v57, v36, s42, v57
    v_dot2_f32_bf16 v58, v37, s41, v58
    v_dot2_f32_bf16 v59, v37, s42, v59
    v_dot2_f32_bf16 v60, v38, s41, v60
    v_dot2_f32_bf16 v61, v38, s42, v61
    v_dot2_f32_bf16 v62, v39, s41, v62
    v_dot2_f32_bf16 v63, v39, s42, v63
    v_cvt_pk_bf16_f32 v244, v56, v57
    v_cvt_pk_bf16_f32 v245, v58, v59
    v_cvt_pk_bf16_f32 v246, v60, v61
    v_cvt_pk_bf16_f32 v247, v62, v63
    ds_write_b128 v216, v[244:247] offset:3072
    v_dot2_f32_bf16 v64, v40, s41, v64
    v_dot2_f32_bf16 v65, v40, s42, v65
    v_dot2_f32_bf16 v66, v41, s41, v66
    v_dot2_f32_bf16 v67, v41, s42, v67
    v_dot2_f32_bf16 v68, v42, s41, v68
    v_dot2_f32_bf16 v69, v42, s42, v69
    v_dot2_f32_bf16 v70, v43, s41, v70
    v_dot2_f32_bf16 v71, v43, s42, v71
    v_cvt_pk_bf16_f32 v248, v64, v65
    v_cvt_pk_bf16_f32 v249, v66, v67
    v_cvt_pk_bf16_f32 v250, v68, v69
    v_cvt_pk_bf16_f32 v251, v70, v71
    ds_write_b128 v216, v[248:251] offset:4096
    s_waitcnt lgkmcnt(0)
    s_barrier
    ds_read_b128 a[0:3], v215 offset:0
    ds_read_b128 a[4:7], v215 offset:8192
    ds_read_b128 a[8:11], v215 offset:16384
    ds_read_b128 a[12:15], v215 offset:24576
    ds_read_b128 v[96:99], v206 offset:0
    ds_read_b128 v[100:103], v206 offset:1024
    ds_read_b128 v[104:107], v206 offset:2048
    ds_read_b128 v[108:111], v206 offset:3072
    ds_read_b128 a[16:19], v215 offset:1024
    ds_read_b128 a[20:23], v215 offset:9216
    ds_read_b128 a[24:27], v215 offset:17408
    ds_read_b128 a[28:31], v215 offset:25600
    ds_read_b128 v[112:115], v207 offset:0
    ds_read_b128 v[116:119], v207 offset:1024
    ds_read_b128 v[120:123], v207 offset:2048
    ds_read_b128 v[124:127], v207 offset:3072
    ds_read_b128 a[32:35], v215 offset:2048
    ds_read_b128 a[36:39], v215 offset:10240
    ds_read_b128 a[40:43], v215 offset:18432
    ds_read_b128 a[44:47], v215 offset:26624
    ds_read_b128 v[128:131], v208 offset:0
    ds_read_b128 v[132:135], v208 offset:1024
    ds_read_b128 v[136:139], v208 offset:2048
    ds_read_b128 v[140:143], v208 offset:3072
    s_waitcnt lgkmcnt(15)
    v_mfma_f32_16x16x32_bf16 v[56:59], v[236:239], a[0:3], 0
    v_mfma_f32_16x16x32_bf16 v[32:35], a[160:163], a[0:3], 0
    v_mfma_f32_16x16x32_bf16 v[32:35], a[164:167], a[4:7], v[32:35]
    v_mfma_f32_16x16x32_bf16 v[32:35], a[168:171], a[8:11], v[32:35]
    v_mfma_f32_16x16x32_bf16 v[32:35], a[172:175], a[12:15], v[32:35]
    v_mfma_f32_16x16x32_bf16 v[36:39], a[176:179], a[0:3], 0
    v_mfma_f32_16x16x32_bf16 v[36:39], a[180:183], a[4:7], v[36:39]
    v_mfma_f32_16x16x32_bf16 v[36:39], a[184:187], a[8:11], v[36:39]
    v_mfma_f32_16x16x32_bf16 v[36:39], a[188:191], a[12:15], v[36:39]
    s_waitcnt lgkmcnt(15)
    v_mfma_f32_16x16x32_bf16 v[160:163], a[192:195], v[96:99], v[160:163]
    v_rcp_f32 v56, v56
    v_mfma_f32_16x16x32_bf16 v[160:163], a[196:199], v[100:103], v[160:163]
    v_mfma_f32_16x16x32_bf16 v[160:163], a[200:203], v[104:107], v[160:163]
    v_mfma_f32_16x16x32_bf16 v[160:163], a[204:207], v[108:111], v[160:163]
    v_mfma_f32_16x16x32_bf16 v[164:167], a[208:211], v[96:99], v[164:167]
    v_mfma_f32_16x16x32_bf16 v[164:167], a[212:215], v[100:103], v[164:167]
    v_mfma_f32_16x16x32_bf16 v[164:167], a[216:219], v[104:107], v[164:167]
    v_mfma_f32_16x16x32_bf16 v[164:167], a[220:223], v[108:111], v[164:167]
    s_waitcnt lgkmcnt(12)
    v_mfma_f32_16x16x32_bf16 v[60:63], v[236:239], a[16:19], 0
    v_mfma_f32_16x16x32_bf16 v[40:43], a[160:163], a[16:19], 0
    v_mfma_f32_16x16x32_bf16 v[40:43], a[164:167], a[20:23], v[40:43]
    v_fmac_f32 v160, v32, v56
    v_fmac_f32 v161, v33, v56
    v_mfma_f32_16x16x32_bf16 v[40:43], a[168:171], a[24:27], v[40:43]
    v_fmac_f32 v162, v34, v56
    v_fmac_f32 v163, v35, v56
    v_mfma_f32_16x16x32_bf16 v[40:43], a[172:175], a[28:31], v[40:43]
    v_fmac_f32 v164, v36, v56
    v_fmac_f32 v165, v37, v56
    v_mfma_f32_16x16x32_bf16 v[44:47], a[176:179], a[16:19], 0
    v_fmac_f32 v166, v38, v56
    v_fmac_f32 v167, v39, v56
    v_mfma_f32_16x16x32_bf16 v[44:47], a[180:183], a[20:23], v[44:47]
    v_cvt_pk_bf16_f32 v240, v160, v161
    v_cvt_pk_bf16_f32 v241, v162, v163
    v_mfma_f32_16x16x32_bf16 v[44:47], a[184:187], a[24:27], v[44:47]
    v_cvt_pk_bf16_f32 v242, v164, v165
    v_cvt_pk_bf16_f32 v243, v166, v167
    v_mfma_f32_16x16x32_bf16 v[44:47], a[188:191], a[28:31], v[44:47]
    buffer_store_dwordx4 v[240:243], v28, s[20:23], 0 offen sc1
    s_waitcnt lgkmcnt(8)
    v_mfma_f32_16x16x32_bf16 v[168:171], a[192:195], v[112:115], v[168:171]
    v_rcp_f32 v60, v60
    v_mfma_f32_16x16x32_bf16 v[168:171], a[196:199], v[116:119], v[168:171]
    v_mfma_f32_16x16x32_bf16 v[168:171], a[200:203], v[120:123], v[168:171]
    v_mfma_f32_16x16x32_bf16 v[168:171], a[204:207], v[124:127], v[168:171]
    v_mfma_f32_16x16x32_bf16 v[172:175], a[208:211], v[112:115], v[172:175]
    v_mfma_f32_16x16x32_bf16 v[172:175], a[212:215], v[116:119], v[172:175]
    v_mfma_f32_16x16x32_bf16 v[172:175], a[216:219], v[120:123], v[172:175]
    v_mfma_f32_16x16x32_bf16 v[172:175], a[220:223], v[124:127], v[172:175]
    s_waitcnt lgkmcnt(4)
    v_mfma_f32_16x16x32_bf16 v[64:67], v[236:239], a[32:35], 0
    v_mfma_f32_16x16x32_bf16 v[48:51], a[160:163], a[32:35], 0
    v_mfma_f32_16x16x32_bf16 v[48:51], a[164:167], a[36:39], v[48:51]
    v_fmac_f32 v168, v40, v60
    v_fmac_f32 v169, v41, v60
    v_mfma_f32_16x16x32_bf16 v[48:51], a[168:171], a[40:43], v[48:51]
    v_fmac_f32 v170, v42, v60
    v_fmac_f32 v171, v43, v60
    v_mfma_f32_16x16x32_bf16 v[48:51], a[172:175], a[44:47], v[48:51]
    v_fmac_f32 v172, v44, v60
    v_fmac_f32 v173, v45, v60
    v_mfma_f32_16x16x32_bf16 v[52:55], a[176:179], a[32:35], 0
    v_fmac_f32 v174, v46, v60
    v_fmac_f32 v175, v47, v60
    v_mfma_f32_16x16x32_bf16 v[52:55], a[180:183], a[36:39], v[52:55]
    v_cvt_pk_bf16_f32 v244, v168, v169
    v_cvt_pk_bf16_f32 v245, v170, v171
    v_mfma_f32_16x16x32_bf16 v[52:55], a[184:187], a[40:43], v[52:55]
    v_cvt_pk_bf16_f32 v246, v172, v173
    v_cvt_pk_bf16_f32 v247, v174, v175
    v_mfma_f32_16x16x32_bf16 v[52:55], a[188:191], a[44:47], v[52:55]
    buffer_store_dwordx4 v[244:247], v29, s[20:23], 0 offen sc1
    s_waitcnt lgkmcnt(0)
    v_mfma_f32_16x16x32_bf16 v[176:179], a[192:195], v[128:131], v[176:179]
    v_rcp_f32 v64, v64
    v_mfma_f32_16x16x32_bf16 v[176:179], a[196:199], v[132:135], v[176:179]
    v_mfma_f32_16x16x32_bf16 v[176:179], a[200:203], v[136:139], v[176:179]
    v_mfma_f32_16x16x32_bf16 v[176:179], a[204:207], v[140:143], v[176:179]
    v_mfma_f32_16x16x32_bf16 v[180:183], a[208:211], v[128:131], v[180:183]
    v_mfma_f32_16x16x32_bf16 v[180:183], a[212:215], v[132:135], v[180:183]
    v_mfma_f32_16x16x32_bf16 v[180:183], a[216:219], v[136:139], v[180:183]
    v_mfma_f32_16x16x32_bf16 v[180:183], a[220:223], v[140:143], v[180:183]
    s_nop 3
    v_fmac_f32 v176, v48, v64
    v_fmac_f32 v177, v49, v64
    v_fmac_f32 v178, v50, v64
    v_fmac_f32 v179, v51, v64
    v_fmac_f32 v180, v52, v64
    v_fmac_f32 v181, v53, v64
    v_fmac_f32 v182, v54, v64
    v_fmac_f32 v183, v55, v64
    v_cvt_pk_bf16_f32 v248, v176, v177
    v_cvt_pk_bf16_f32 v249, v178, v179
    v_cvt_pk_bf16_f32 v250, v180, v181
    v_cvt_pk_bf16_f32 v251, v182, v183
    buffer_store_dwordx4 v[248:251], v30, s[20:23], 0 offen sc1
    s_or_b32 s41, s2, s3
    s_cbranch_scc1 L2_notag
    s_mov_b32 s41, 2752512
    s_mov_b64 exec, 1
    buffer_store_dword v2, off, s[12:15], s41 sc1
    s_mov_b64 exec, -1
L2_notag:
L2_end:
    s_endpgm
LH:
    s_load_dwordx4 s[8:11], s[0:1], 8
    s_load_dwordx2 s[16:17], s[0:1], 32
    s_load_dwordx4 s[20:23], s[0:1], 56
    v_mov_b32 v63, v0
    v_lshrrev_b32 v1, 6, v0
    v_and_b32 v0, 63, v0
    s_sub_u32 s6, s2, 250
    v_readfirstlane_b32 s3, v1
    v_and_b32 v2, 15, v0
    v_lshrrev_b32 v3, 4, v0
    v_lshrrev_b32 v6, 1, v2
    v_xor_b32 v6, v6, v3
    v_lshlrev_b32 v6, 5, v6
    v_and_b32 v7, 1, v2
    v_lshl_or_b32 v6, v7, 4, v6
    v_lshl_or_b32 v56, v3, 8, v6
    v_xor_b32 v57, 0x80, v56
    s_lshl_b32 s34, s3, 13
    s_add_u32 s43, s34, 8192
    s_add_u32 s35, s34, 4096
    v_lshrrev_b32 v6, 1, v3
    v_and_b32 v7, 1, v3
    v_lshlrev_b32 v7, 4, v7
    v_lshl_add_u32 v7, v2, 8, v7
    v_add_u32 v7, s43, v7
    v_and_b32 v4, 7, v2
    v_add_u32 v5, 0, v6
    v_xor_b32 v5, v5, v4
    v_lshl_add_u32 v52, v5, 5, v7
    v_add_u32 v5, 2, v6
    v_xor_b32 v5, v5, v4
    v_lshl_add_u32 v53, v5, 5, v7
    v_add_u32 v5, 4, v6
    v_xor_b32 v5, v5, v4
    v_lshl_add_u32 v54, v5, 5, v7
    v_add_u32 v5, 6, v6
    v_xor_b32 v5, v5, v4
    v_lshl_add_u32 v55, v5, 5, v7
    v_lshrrev_b32 v5, 3, v2
    v_and_b32 v6, 3, v2
    v_lshl_add_u32 v5, v5, 2, v6
    v_bfe_u32 v6, v2, 2, 1
    v_lshlrev_b32 v6, 12, v6
    v_lshl_add_u32 v5, v5, 4, v6
    v_lshl_add_u32 v5, v3, 8, v5
    v_lshrrev_b32 v6, 2, v0
    v_lshlrev_b32 v6, 8, v6
    v_and_b32 v7, 3, v0
    v_lshl_add_u32 v58, v7, 3, v6
    s_lshl_b32 s36, s3, 10
    v_lshl_add_u32 v59, v0, 3, s36
    v_lshlrev_b32 v7, 8, v3
    v_lshl_add_u32 v60, v2, 3, v7
    s_lshl_b32 s36, s3, 8
    v_lshl_add_u32 v61, v0, 2, s36
    v_lshlrev_b32 v62, 2, v2
    v_add_u32 v62, 4096, v62
    s_waitcnt lgkmcnt(0)
    s_add_u32 s48, s4, 2752512
    s_addc_u32 s49, s5, 0
    s_load_dword s59, s[48:49], 0
    s_mov_b32 s12, s4
    s_mov_b32 s13, s5
    s_mov_b32 s14, 6094848
    s_mov_b32 s15, 0x00020000
    s_mov_b32 s24, s22
    s_mov_b32 s25, s23
    s_mov_b32 s26, 32768
    s_mov_b32 s27, 0x00020000
    s_mov_b32 s30, 32768
    s_mov_b32 s31, 0x00020000
    s_mov_b32 s7, s6
LH_task:
    s_cmp_lt_u32 s7, 8
    s_cselect_b32 s28, s20, s16
    s_cselect_b32 s29, s21, s17
    s_mov_b32 s33, 2654208
    s_cselect_b32 s33, 2621440, s33
    s_and_b32 s37, s7, 7
    s_lshl_b32 s38, s37, 5
    s_add_u32 s38, s38, s34
    s_add_u32 s39, s38, 4096
    buffer_load_dwordx2 v[8:9], v58, s[24:27], s38 offen
    buffer_load_dwordx2 v[10:11], v58, s[24:27], s39 offen
    s_add_u32 m0, s43, 0
    s_nop 0
    buffer_load_dwordx4 v56, s[28:31], s34 offen offset:0 lds
    buffer_load_dwordx4 v57, s[28:31], s34 offen offset:1024 lds
    buffer_load_dwordx4 v56, s[28:31], s34 offen offset:2048 lds
    buffer_load_dwordx4 v57, s[28:31], s34 offen offset:3072 lds
    s_add_u32 m0, s43, 4096
    s_nop 0
    buffer_load_dwordx4 v56, s[28:31], s35 offen offset:0 lds
    buffer_load_dwordx4 v57, s[28:31], s35 offen offset:1024 lds
    buffer_load_dwordx4 v56, s[28:31], s35 offen offset:2048 lds
    buffer_load_dwordx4 v57, s[28:31], s35 offen offset:3072 lds
    s_lshr_b32 s38, s37, 1
    s_lshl_b32 s38, s38, 13
    s_add_u32 s33, s33, s38
    s_and_b32 s38, s37, 1
    s_lshl_b32 s38, s38, 7
    s_add_u32 s33, s33, s38
    s_lshl_b32 s38, s3, 10
    s_add_u32 s33, s33, s38
    s_waitcnt vmcnt(8)
    ds_write_b64 v59, v[8:9]
    ds_write_b64 v59, v[10:11] offset:512
    s_waitcnt vmcnt(0) lgkmcnt(0)
    ds_read_b128 v[64:67], v52 offset:0
    ds_read_b128 v[68:71], v53 offset:0
    ds_read_b128 v[72:75], v54 offset:0
    ds_read_b128 v[76:79], v55 offset:0
    ds_read_b128 v[80:83], v52 offset:4096
    ds_read_b128 v[84:87], v53 offset:4096
    ds_read_b128 v[88:91], v54 offset:4096
    ds_read_b128 v[92:95], v55 offset:4096
    s_barrier
    ds_read_b64_tr_b16 v[16:17], v60 offset:0
    ds_read_b64_tr_b16 v[18:19], v60 offset:128
    ds_read_b64_tr_b16 v[20:21], v60 offset:1024
    ds_read_b64_tr_b16 v[22:23], v60 offset:1152
    ds_read_b64_tr_b16 v[24:25], v60 offset:2048
    ds_read_b64_tr_b16 v[26:27], v60 offset:2176
    ds_read_b64_tr_b16 v[28:29], v60 offset:3072
    ds_read_b64_tr_b16 v[30:31], v60 offset:3200
    s_waitcnt lgkmcnt(0)
    v_mfma_f32_16x16x32_bf16 v[40:43], v[64:67], v[16:19], 0
    v_mfma_f32_16x16x32_bf16 v[40:43], v[68:71], v[20:23], v[40:43]
    v_mfma_f32_16x16x32_bf16 v[40:43], v[72:75], v[24:27], v[40:43]
    v_mfma_f32_16x16x32_bf16 v[40:43], v[76:79], v[28:31], v[40:43]
    v_mfma_f32_16x16x32_bf16 v[44:47], v[80:83], v[16:19], 0
    v_mfma_f32_16x16x32_bf16 v[44:47], v[84:87], v[20:23], v[44:47]
    v_mfma_f32_16x16x32_bf16 v[44:47], v[88:91], v[24:27], v[44:47]
    v_mfma_f32_16x16x32_bf16 v[44:47], v[92:95], v[28:31], v[44:47]
    s_nop 3
    ds_write_b32 v61, v40 offset:4096
    s_waitcnt lgkmcnt(0)
    s_barrier
    ds_read_b32 v16, v62
    s_waitcnt lgkmcnt(0)
    v_sub_f32 v40, v40, v16
    v_sub_f32 v41, v41, v16
    v_sub_f32 v42, v42, v16
    v_sub_f32 v43, v43, v16
    v_sub_f32 v44, v44, v16
    v_sub_f32 v45, v45, v16
    v_sub_f32 v46, v46, v16
    v_sub_f32 v47, v47, v16
    v_cvt_pk_bf16_f32 v12, v40, v41
    v_cvt_pk_bf16_f32 v13, v42, v43
    v_cvt_pk_bf16_f32 v14, v44, v45
    v_cvt_pk_bf16_f32 v15, v46, v47
    buffer_store_dwordx4 v[12:15], v5, s[12:15], s33 offen sc1
    s_add_u32 s7, s7, 6
    s_cmp_lt_u32 s7, 16
    s_barrier
    s_cbranch_scc1 LH_task
    s_mov_b32 s16, s10
    s_mov_b32 s17, s11
    s_mov_b32 s18, 640000
    s_mov_b32 s19, 0x00020000
    s_mov_b32 s20, s8
    s_mov_b32 s21, s9
    s_mov_b32 s22, 640000
    s_mov_b32 s23, 0x00020000
    v_lshlrev_b32 v1, 4, v63
    v_mov_b32 v4, 0
    v_mov_b32 v5, 0
    v_mov_b32 v6, 0
    v_mov_b32 v7, 0
    ds_write_b128 v1, v[4:7]
    s_mul_i32 s33, s6, 26880
    v_lshlrev_b32 v2, 2, v63
    s_mov_b32 s40, 52429
    v_mov_b32 v8, 1
    v_lshrrev_b32 v3, 6, v63
    v_lshlrev_b32 v3, 2, v3
    v_mov_b32 v11, 1023
    s_waitcnt lgkmcnt(0)
    s_barrier
    s_mov_b32 s36, s33
    s_mov_b32 s37, 3
LH_count:
    s_lshl_b32 s38, s36, 2
    buffer_load_dword v64, v2, s[16:19], s38 offen offset:0
    buffer_load_dword v65, v2, s[16:19], s38 offen offset:1024
    buffer_load_dword v66, v2, s[16:19], s38 offen offset:2048
    buffer_load_dword v67, v2, s[16:19], s38 offen offset:3072
    s_add_u32 s38, s38, 4096
    buffer_load_dword v68, v2, s[16:19], s38 offen offset:0
    buffer_load_dword v69, v2, s[16:19], s38 offen offset:1024
    buffer_load_dword v70, v2, s[16:19], s38 offen offset:2048
    buffer_load_dword v71, v2, s[16:19], s38 offen offset:3072
    s_add_u32 s38, s38, 4096
    buffer_load_dword v72, v2, s[16:19], s38 offen offset:0
    buffer_load_dword v73, v2, s[16:19], s38 offen offset:1024
    buffer_load_dword v74, v2, s[16:19], s38 offen offset:2048
    buffer_load_dword v75, v2, s[16:19], s38 offen offset:3072
    s_add_u32 s38, s38, 4096
    buffer_load_dword v76, v2, s[16:19], s38 offen offset:0
    buffer_load_dword v77, v2, s[16:19], s38 offen offset:1024
    buffer_load_dword v78, v2, s[16:19], s38 offen offset:2048
    buffer_load_dword v79, v2, s[16:19], s38 offen offset:3072
    s_add_u32 s38, s38, 4096
    buffer_load_dword v80, v2, s[16:19], s38 offen offset:0
    buffer_load_dword v81, v2, s[16:19], s38 offen offset:1024
    buffer_load_dword v82, v2, s[16:19], s38 offen offset:2048
    buffer_load_dword v83, v2, s[16:19], s38 offen offset:3072
    s_add_u32 s38, s38, 4096
    buffer_load_dword v84, v2, s[16:19], s38 offen offset:0
    buffer_load_dword v85, v2, s[16:19], s38 offen offset:1024
    buffer_load_dword v86, v2, s[16:19], s38 offen offset:2048
    buffer_load_dword v87, v2, s[16:19], s38 offen offset:3072
    s_add_u32 s38, s38, 4096
    buffer_load_dword v88, v2, s[16:19], s38 offen offset:0
    buffer_load_dword v89, v2, s[16:19], s38 offen offset:1024
    buffer_load_dword v90, v2, s[16:19], s38 offen offset:2048
    buffer_load_dword v91, v2, s[16:19], s38 offen offset:3072
    s_add_u32 s38, s38, 4096
    buffer_load_dword v92, v2, s[16:19], s38 offen offset:0
    buffer_load_dword v93, v2, s[16:19], s38 offen offset:1024
    buffer_load_dword v94, v2, s[16:19], s38 offen offset:2048
    buffer_load_dword v95, v2, s[16:19], s38 offen offset:3072
    s_add_u32 s38, s38, 4096
    buffer_load_dword v96, v2, s[16:19], s38 offen offset:0
    buffer_load_dword v97, v2, s[16:19], s38 offen offset:1024
    buffer_load_dword v98, v2, s[16:19], s38 offen offset:2048
    v_add_u32 v9, s36, v63
    s_waitcnt vmcnt(0)
    v_mul_u32_u24 v144, s40, v64
    v_lshrrev_b32 v144, 19, v144
    v_cmp_gt_u32 vcc, 160000, v9
    s_nop 1
    v_cndmask_b32 v10, v11, v144, vcc
    v_lshlrev_b32 v10, 2, v10
    ds_add_u32 v10, v8
    v_mul_u32_u24 v145, s40, v65
    v_lshrrev_b32 v145, 19, v145
    v_cmp_gt_u32 vcc, 159744, v9
    s_nop 1
    v_cndmask_b32 v10, v11, v145, vcc
    v_lshlrev_b32 v10, 2, v10
    ds_add_u32 v10, v8
    v_mul_u32_u24 v146, s40, v66
    v_lshrrev_b32 v146, 19, v146
    v_cmp_gt_u32 vcc, 159488, v9
    s_nop 1
    v_cndmask_b32 v10, v11, v146, vcc
    v_lshlrev_b32 v10, 2, v10
    ds_add_u32 v10, v8
    v_mul_u32_u24 v147, s40, v67
    v_lshrrev_b32 v147, 19, v147
    v_cmp_gt_u32 vcc, 159232, v9
    s_nop 1
    v_cndmask_b32 v10, v11, v147, vcc
    v_lshlrev_b32 v10, 2, v10
    ds_add_u32 v10, v8
    v_mul_u32_u24 v148, s40, v68
    v_lshrrev_b32 v148, 19, v148
    v_cmp_gt_u32 vcc, 158976, v9
    s_nop 1
    v_cndmask_b32 v10, v11, v148, vcc
    v_lshlrev_b32 v10, 2, v10
    ds_add_u32 v10, v8
    v_mul_u32_u24 v149, s40, v69
    v_lshrrev_b32 v149, 19, v149
    v_cmp_gt_u32 vcc, 158720, v9
    s_nop 1
    v_cndmask_b32 v10, v11, v149, vcc
    v_lshlrev_b32 v10, 2, v10
    ds_add_u32 v10, v8
    v_mul_u32_u24 v150, s40, v70
    v_lshrrev_b32 v150, 19, v150
    v_cmp_gt_u32 vcc, 158464, v9
    s_nop 1
    v_cndmask_b32 v10, v11, v150, vcc
    v_lshlrev_b32 v10, 2, v10
    ds_add_u32 v10, v8
    v_mul_u32_u24 v151, s40, v71
    v_lshrrev_b32 v151, 19, v151
    v_cmp_gt_u32 vcc, 158208, v9
    s_nop 1
    v_cndmask_b32 v10, v11, v151, vcc
    v_lshlrev_b32 v10, 2, v10
    ds_add_u32 v10, v8
    v_mul_u32_u24 v152, s40, v72
    v_lshrrev_b32 v152, 19, v152
    v_cmp_gt_u32 vcc, 157952, v9
    s_nop 1
    v_cndmask_b32 v10, v11, v152, vcc
    v_lshlrev_b32 v10, 2, v10
    ds_add_u32 v10, v8
    v_mul_u32_u24 v153, s40, v73
    v_lshrrev_b32 v153, 19, v153
    v_cmp_gt_u32 vcc, 157696, v9
    s_nop 1
    v_cndmask_b32 v10, v11, v153, vcc
    v_lshlrev_b32 v10, 2, v10
    ds_add_u32 v10, v8
    v_mul_u32_u24 v154, s40, v74
    v_lshrrev_b32 v154, 19, v154
    v_cmp_gt_u32 vcc, 157440, v9
    s_nop 1
    v_cndmask_b32 v10, v11, v154, vcc
    v_lshlrev_b32 v10, 2, v10
    ds_add_u32 v10, v8
    v_mul_u32_u24 v155, s40, v75
    v_lshrrev_b32 v155, 19, v155
    v_cmp_gt_u32 vcc, 157184, v9
    s_nop 1
    v_cndmask_b32 v10, v11, v155, vcc
    v_lshlrev_b32 v10, 2, v10
    ds_add_u32 v10, v8
    v_mul_u32_u24 v156, s40, v76
    v_lshrrev_b32 v156, 19, v156
    v_cmp_gt_u32 vcc, 156928, v9
    s_nop 1
    v_cndmask_b32 v10, v11, v156, vcc
    v_lshlrev_b32 v10, 2, v10
    ds_add_u32 v10, v8
    v_mul_u32_u24 v157, s40, v77
    v_lshrrev_b32 v157, 19, v157
    v_cmp_gt_u32 vcc, 156672, v9
    s_nop 1
    v_cndmask_b32 v10, v11, v157, vcc
    v_lshlrev_b32 v10, 2, v10
    ds_add_u32 v10, v8
    v_mul_u32_u24 v158, s40, v78
    v_lshrrev_b32 v158, 19, v158
    v_cmp_gt_u32 vcc, 156416, v9
    s_nop 1
    v_cndmask_b32 v10, v11, v158, vcc
    v_lshlrev_b32 v10, 2, v10
    ds_add_u32 v10, v8
    v_mul_u32_u24 v159, s40, v79
    v_lshrrev_b32 v159, 19, v159
    v_cmp_gt_u32 vcc, 156160, v9
    s_nop 1
    v_cndmask_b32 v10, v11, v159, vcc
    v_lshlrev_b32 v10, 2, v10
    ds_add_u32 v10, v8
    v_mul_u32_u24 v160, s40, v80
    v_lshrrev_b32 v160, 19, v160
    v_cmp_gt_u32 vcc, 155904, v9
    s_nop 1
    v_cndmask_b32 v10, v11, v160, vcc
    v_lshlrev_b32 v10, 2, v10
    ds_add_u32 v10, v8
    v_mul_u32_u24 v161, s40, v81
    v_lshrrev_b32 v161, 19, v161
    v_cmp_gt_u32 vcc, 155648, v9
    s_nop 1
    v_cndmask_b32 v10, v11, v161, vcc
    v_lshlrev_b32 v10, 2, v10
    ds_add_u32 v10, v8
    v_mul_u32_u24 v162, s40, v82
    v_lshrrev_b32 v162, 19, v162
    v_cmp_gt_u32 vcc, 155392, v9
    s_nop 1
    v_cndmask_b32 v10, v11, v162, vcc
    v_lshlrev_b32 v10, 2, v10
    ds_add_u32 v10, v8
    v_mul_u32_u24 v163, s40, v83
    v_lshrrev_b32 v163, 19, v163
    v_cmp_gt_u32 vcc, 155136, v9
    s_nop 1
    v_cndmask_b32 v10, v11, v163, vcc
    v_lshlrev_b32 v10, 2, v10
    ds_add_u32 v10, v8
    v_mul_u32_u24 v164, s40, v84
    v_lshrrev_b32 v164, 19, v164
    v_cmp_gt_u32 vcc, 154880, v9
    s_nop 1
    v_cndmask_b32 v10, v11, v164, vcc
    v_lshlrev_b32 v10, 2, v10
    ds_add_u32 v10, v8
    v_mul_u32_u24 v165, s40, v85
    v_lshrrev_b32 v165, 19, v165
    v_cmp_gt_u32 vcc, 154624, v9
    s_nop 1
    v_cndmask_b32 v10, v11, v165, vcc
    v_lshlrev_b32 v10, 2, v10
    ds_add_u32 v10, v8
    v_mul_u32_u24 v166, s40, v86
    v_lshrrev_b32 v166, 19, v166
    v_cmp_gt_u32 vcc, 154368, v9
    s_nop 1
    v_cndmask_b32 v10, v11, v166, vcc
    v_lshlrev_b32 v10, 2, v10
    ds_add_u32 v10, v8
    v_mul_u32_u24 v167, s40, v87
    v_lshrrev_b32 v167, 19, v167
    v_cmp_gt_u32 vcc, 154112, v9
    s_nop 1
    v_cndmask_b32 v10, v11, v167, vcc
    v_lshlrev_b32 v10, 2, v10
    ds_add_u32 v10, v8
    v_mul_u32_u24 v168, s40, v88
    v_lshrrev_b32 v168, 19, v168
    v_cmp_gt_u32 vcc, 153856, v9
    s_nop 1
    v_cndmask_b32 v10, v11, v168, vcc
    v_lshlrev_b32 v10, 2, v10
    ds_add_u32 v10, v8
    v_mul_u32_u24 v169, s40, v89
    v_lshrrev_b32 v169, 19, v169
    v_cmp_gt_u32 vcc, 153600, v9
    s_nop 1
    v_cndmask_b32 v10, v11, v169, vcc
    v_lshlrev_b32 v10, 2, v10
    ds_add_u32 v10, v8
    v_mul_u32_u24 v170, s40, v90
    v_lshrrev_b32 v170, 19, v170
    v_cmp_gt_u32 vcc, 153344, v9
    s_nop 1
    v_cndmask_b32 v10, v11, v170, vcc
    v_lshlrev_b32 v10, 2, v10
    ds_add_u32 v10, v8
    v_mul_u32_u24 v171, s40, v91
    v_lshrrev_b32 v171, 19, v171
    v_cmp_gt_u32 vcc, 153088, v9
    s_nop 1
    v_cndmask_b32 v10, v11, v171, vcc
    v_lshlrev_b32 v10, 2, v10
    ds_add_u32 v10, v8
    v_mul_u32_u24 v172, s40, v92
    v_lshrrev_b32 v172, 19, v172
    v_cmp_gt_u32 vcc, 152832, v9
    s_nop 1
    v_cndmask_b32 v10, v11, v172, vcc
    v_lshlrev_b32 v10, 2, v10
    ds_add_u32 v10, v8
    v_mul_u32_u24 v173, s40, v93
    v_lshrrev_b32 v173, 19, v173
    v_cmp_gt_u32 vcc, 152576, v9
    s_nop 1
    v_cndmask_b32 v10, v11, v173, vcc
    v_lshlrev_b32 v10, 2, v10
    ds_add_u32 v10, v8
    v_mul_u32_u24 v174, s40, v94
    v_lshrrev_b32 v174, 19, v174
    v_cmp_gt_u32 vcc, 152320, v9
    s_nop 1
    v_cndmask_b32 v10, v11, v174, vcc
    v_lshlrev_b32 v10, 2, v10
    ds_add_u32 v10, v8
    v_mul_u32_u24 v175, s40, v95
    v_lshrrev_b32 v175, 19, v175
    v_cmp_gt_u32 vcc, 152064, v9
    s_nop 1
    v_cndmask_b32 v10, v11, v175, vcc
    v_lshlrev_b32 v10, 2, v10
    ds_add_u32 v10, v8
    v_mul_u32_u24 v176, s40, v96
    v_lshrrev_b32 v176, 19, v176
    v_cmp_gt_u32 vcc, 151808, v9
    s_nop 1
    v_cndmask_b32 v10, v11, v176, vcc
    v_lshlrev_b32 v10, 2, v10
    ds_add_u32 v10, v8
    v_mul_u32_u24 v177, s40, v97
    v_lshrrev_b32 v177, 19, v177
    v_cmp_gt_u32 vcc, 151552, v9
    s_nop 1
    v_cndmask_b32 v10, v11, v177, vcc
    v_lshlrev_b32 v10, 2, v10
    ds_add_u32 v10, v8
    v_mul_u32_u24 v178, s40, v98
    v_lshrrev_b32 v178, 19, v178
    v_cmp_gt_u32 vcc, 151296, v9
    s_nop 1
    v_cndmask_b32 v10, v11, v178, vcc
    v_lshlrev_b32 v10, 2, v10
    ds_add_u32 v10, v8
    s_add_u32 s36, s36, 8960
    s_sub_u32 s37, s37, 1
    s_cmp_lg_u32 s37, 0
    s_cbranch_scc1 LH_count
    s_waitcnt lgkmcnt(0)
    s_barrier
    ds_read_b128 v[4:7], v1
    s_waitcnt lgkmcnt(0)
    v_add_u32 v12, v4, v5
    v_add_u32 v13, v12, v6
    v_add_u32 v14, v13, v7
    v_mov_b32 v15, v14
    s_nop 1
    v_add_u32_dpp v15, v15, v15 row_shr:1 row_mask:0xf bank_mask:0xf bound_ctrl:1
    s_nop 1
    v_add_u32_dpp v15, v15, v15 row_shr:2 row_mask:0xf bank_mask:0xf bound_ctrl:1
    s_nop 1
    v_add_u32_dpp v15, v15, v15 row_shr:4 row_mask:0xf bank_mask:0xf bound_ctrl:1
    s_nop 1
    v_add_u32_dpp v15, v15, v15 row_shr:8 row_mask:0xf bank_mask:0xf bound_ctrl:1
    s_nop 1
    v_add_u32_dpp v15, v15, v15 row_bcast:15 row_mask:0xa bank_mask:0xf
    s_nop 1
    v_add_u32_dpp v15, v15, v15 row_bcast:31 row_mask:0xc bank_mask:0xf
    v_cmp_eq_u32 vcc, 63, v0
    s_nop 0
    s_and_saveexec_b64 s[44:45], vcc
    ds_write_b32 v3, v15 offset:4096
    s_mov_b64 exec, -1
    v_mov_b32 v9, 0
    v_sub_u32 v15, v15, v14
    s_waitcnt lgkmcnt(0)
    s_barrier
    ds_read_b128 v[16:19], v9 offset:4096
    s_waitcnt lgkmcnt(0)
    s_cmp_gt_u32 s3, 0
    s_cselect_b32 s39, 1, 0
    v_mad_u32_u24 v15, v16, s39, v15
    s_cmp_gt_u32 s3, 1
    s_cselect_b32 s39, 1, 0
    v_mad_u32_u24 v15, v17, s39, v15
    s_cmp_gt_u32 s3, 2
    s_cselect_b32 s39, 1, 0
    v_mad_u32_u24 v15, v18, s39, v15
    v_mov_b32 v16, v15
    v_add_u32 v17, v15, v4
    v_add_u32 v18, v15, v12
    v_add_u32 v19, v15, v13
    ds_write_b128 v1, v[16:19]
    v_lshlrev_b32 v9, 7, v63
    v_mov_b32 v10, 0x7fffff00
    v_cmp_gt_u32 vcc, 250, v63
    s_lshl_b32 s39, s6, 2
    s_add_u32 s39, s39, 2785280
    v_cndmask_b32 v9, v10, v9, vcc
    v_lshl_or_b32 v20, v4, 16, v16
    buffer_store_dword v20, v9, s[12:15], s39 offen offset:0 sc1
    v_lshl_or_b32 v21, v5, 16, v17
    buffer_store_dword v21, v9, s[12:15], s39 offen offset:32 sc1
    v_lshl_or_b32 v22, v6, 16, v18
    buffer_store_dword v22, v9, s[12:15], s39 offen offset:64 sc1
    v_lshl_or_b32 v23, v7, 16, v19
    buffer_store_dword v23, v9, s[12:15], s39 offen offset:96 sc1
    s_waitcnt lgkmcnt(0)
    s_barrier
    s_mov_b32 s36, s33
    s_mov_b32 s37, 3
LH_scatter:
    s_lshl_b32 s38, s36, 2
    buffer_load_dword v64, v2, s[16:19], s38 offen offset:0
    buffer_load_dword v104, v2, s[20:23], s38 offen offset:0
    buffer_load_dword v65, v2, s[16:19], s38 offen offset:1024
    buffer_load_dword v105, v2, s[20:23], s38 offen offset:1024
    buffer_load_dword v66, v2, s[16:19], s38 offen offset:2048
    buffer_load_dword v106, v2, s[20:23], s38 offen offset:2048
    buffer_load_dword v67, v2, s[16:19], s38 offen offset:3072
    buffer_load_dword v107, v2, s[20:23], s38 offen offset:3072
    s_add_u32 s38, s38, 4096
    buffer_load_dword v68, v2, s[16:19], s38 offen offset:0
    buffer_load_dword v108, v2, s[20:23], s38 offen offset:0
    buffer_load_dword v69, v2, s[16:19], s38 offen offset:1024
    buffer_load_dword v109, v2, s[20:23], s38 offen offset:1024
    buffer_load_dword v70, v2, s[16:19], s38 offen offset:2048
    buffer_load_dword v110, v2, s[20:23], s38 offen offset:2048
    buffer_load_dword v71, v2, s[16:19], s38 offen offset:3072
    buffer_load_dword v111, v2, s[20:23], s38 offen offset:3072
    s_add_u32 s38, s38, 4096
    buffer_load_dword v72, v2, s[16:19], s38 offen offset:0
    buffer_load_dword v112, v2, s[20:23], s38 offen offset:0
    buffer_load_dword v73, v2, s[16:19], s38 offen offset:1024
    buffer_load_dword v113, v2, s[20:23], s38 offen offset:1024
    buffer_load_dword v74, v2, s[16:19], s38 offen offset:2048
    buffer_load_dword v114, v2, s[20:23], s38 offen offset:2048
    buffer_load_dword v75, v2, s[16:19], s38 offen offset:3072
    buffer_load_dword v115, v2, s[20:23], s38 offen offset:3072
    s_add_u32 s38, s38, 4096
    buffer_load_dword v76, v2, s[16:19], s38 offen offset:0
    buffer_load_dword v116, v2, s[20:23], s38 offen offset:0
    buffer_load_dword v77, v2, s[16:19], s38 offen offset:1024
    buffer_load_dword v117, v2, s[20:23], s38 offen offset:1024
    buffer_load_dword v78, v2, s[16:19], s38 offen offset:2048
    buffer_load_dword v118, v2, s[20:23], s38 offen offset:2048
    buffer_load_dword v79, v2, s[16:19], s38 offen offset:3072
    buffer_load_dword v119, v2, s[20:23], s38 offen offset:3072
    s_add_u32 s38, s38, 4096
    buffer_load_dword v80, v2, s[16:19], s38 offen offset:0
    buffer_load_dword v120, v2, s[20:23], s38 offen offset:0
    buffer_load_dword v81, v2, s[16:19], s38 offen offset:1024
    buffer_load_dword v121, v2, s[20:23], s38 offen offset:1024
    buffer_load_dword v82, v2, s[16:19], s38 offen offset:2048
    buffer_load_dword v122, v2, s[20:23], s38 offen offset:2048
    buffer_load_dword v83, v2, s[16:19], s38 offen offset:3072
    buffer_load_dword v123, v2, s[20:23], s38 offen offset:3072
    s_add_u32 s38, s38, 4096
    buffer_load_dword v84, v2, s[16:19], s38 offen offset:0
    buffer_load_dword v124, v2, s[20:23], s38 offen offset:0
    buffer_load_dword v85, v2, s[16:19], s38 offen offset:1024
    buffer_load_dword v125, v2, s[20:23], s38 offen offset:1024
    buffer_load_dword v86, v2, s[16:19], s38 offen offset:2048
    buffer_load_dword v126, v2, s[20:23], s38 offen offset:2048
    buffer_load_dword v87, v2, s[16:19], s38 offen offset:3072
    buffer_load_dword v127, v2, s[20:23], s38 offen offset:3072
    s_add_u32 s38, s38, 4096
    buffer_load_dword v88, v2, s[16:19], s38 offen offset:0
    buffer_load_dword v128, v2, s[20:23], s38 offen offset:0
    buffer_load_dword v89, v2, s[16:19], s38 offen offset:1024
    buffer_load_dword v129, v2, s[20:23], s38 offen offset:1024
    buffer_load_dword v90, v2, s[16:19], s38 offen offset:2048
    buffer_load_dword v130, v2, s[20:23], s38 offen offset:2048
    buffer_load_dword v91, v2, s[16:19], s38 offen offset:3072
    buffer_load_dword v131, v2, s[20:23], s38 offen offset:3072
    s_add_u32 s38, s38, 4096
    buffer_load_dword v92, v2, s[16:19], s38 offen offset:0
    s_waitcnt vmcnt(40)
    buffer_load_dword v132, v2, s[20:23], s38 offen offset:0
    buffer_load_dword v93, v2, s[16:19], s38 offen offset:1024
    buffer_load_dword v133, v2, s[20:23], s38 offen offset:1024
    buffer_load_dword v94, v2, s[16:19], s38 offen offset:2048
    buffer_load_dword v134, v2, s[20:23], s38 offen offset:2048
    buffer_load_dword v95, v2, s[16:19], s38 offen offset:3072
    buffer_load_dword v135, v2, s[20:23], s38 offen offset:3072
    s_add_u32 s38, s38, 4096
    buffer_load_dword v96, v2, s[16:19], s38 offen offset:0
    buffer_load_dword v136, v2, s[20:23], s38 offen offset:0
    buffer_load_dword v97, v2, s[16:19], s38 offen offset:1024
    buffer_load_dword v137, v2, s[20:23], s38 offen offset:1024
    buffer_load_dword v98, v2, s[16:19], s38 offen offset:2048
    buffer_load_dword v138, v2, s[20:23], s38 offen offset:2048
    v_add_u32 v9, s36, v63
    s_waitcnt vmcnt(0)
    v_mul_u32_u24 v144, s40, v64
    v_lshrrev_b32 v144, 19, v144
    v_cmp_gt_u32 vcc, 160000, v9
    v_mul_u32_u24 v10, 10, v144
    v_sub_u32 v64, v64, v10
    v_cndmask_b32 v10, v11, v144, vcc
    v_lshlrev_b32 v10, 2, v10
    ds_add_rtn_u32 v144, v10, v8
    v_and_b32 v10, 7, v104
    v_lshl_or_b32 v64, v10, 5, v64
    v_lshl_or_b32 v64, v104, 8, v64
    v_mul_u32_u24 v145, s40, v65
    v_lshrrev_b32 v145, 19, v145
    v_cmp_gt_u32 vcc, 159744, v9
    v_mul_u32_u24 v10, 10, v145
    v_sub_u32 v65, v65, v10
    v_cndmask_b32 v10, v11, v145, vcc
    v_lshlrev_b32 v10, 2, v10
    ds_add_rtn_u32 v145, v10, v8
    v_and_b32 v10, 7, v105
    v_lshl_or_b32 v65, v10, 5, v65
    v_lshl_or_b32 v65, v105, 8, v65
    v_mul_u32_u24 v146, s40, v66
    v_lshrrev_b32 v146, 19, v146
    v_cmp_gt_u32 vcc, 159488, v9
    v_mul_u32_u24 v10, 10, v146
    v_sub_u32 v66, v66, v10
    v_cndmask_b32 v10, v11, v146, vcc
    v_lshlrev_b32 v10, 2, v10
    ds_add_rtn_u32 v146, v10, v8
    v_and_b32 v10, 7, v106
    v_lshl_or_b32 v66, v10, 5, v66
    v_lshl_or_b32 v66, v106, 8, v66
    v_mul_u32_u24 v147, s40, v67
    v_lshrrev_b32 v147, 19, v147
    v_cmp_gt_u32 vcc, 159232, v9
    v_mul_u32_u24 v10, 10, v147
    v_sub_u32 v67, v67, v10
    v_cndmask_b32 v10, v11, v147, vcc
    v_lshlrev_b32 v10, 2, v10
    ds_add_rtn_u32 v147, v10, v8
    v_and_b32 v10, 7, v107
    v_lshl_or_b32 v67, v10, 5, v67
    v_lshl_or_b32 v67, v107, 8, v67
    v_mul_u32_u24 v148, s40, v68
    v_lshrrev_b32 v148, 19, v148
    v_cmp_gt_u32 vcc, 158976, v9
    v_mul_u32_u24 v10, 10, v148
    v_sub_u32 v68, v68, v10
    v_cndmask_b32 v10, v11, v148, vcc
    v_lshlrev_b32 v10, 2, v10
    ds_add_rtn_u32 v148, v10, v8
    v_and_b32 v10, 7, v108
    v_lshl_or_b32 v68, v10, 5, v68
    v_lshl_or_b32 v68, v108, 8, v68
    v_mul_u32_u24 v149, s40, v69
    v_lshrrev_b32 v149, 19, v149
    v_cmp_gt_u32 vcc, 158720, v9
    v_mul_u32_u24 v10, 10, v149
    v_sub_u32 v69, v69, v10
    v_cndmask_b32 v10, v11, v149, vcc
    v_lshlrev_b32 v10, 2, v10
    ds_add_rtn_u32 v149, v10, v8
    v_and_b32 v10, 7, v109
    v_lshl_or_b32 v69, v10, 5, v69
    v_lshl_or_b32 v69, v109, 8, v69
    v_mul_u32_u24 v150, s40, v70
    v_lshrrev_b32 v150, 19, v150
    v_cmp_gt_u32 vcc, 158464, v9
    v_mul_u32_u24 v10, 10, v150
    v_sub_u32 v70, v70, v10
    v_cndmask_b32 v10, v11, v150, vcc
    v_lshlrev_b32 v10, 2, v10
    ds_add_rtn_u32 v150, v10, v8
    v_and_b32 v10, 7, v110
    v_lshl_or_b32 v70, v10, 5, v70
    v_lshl_or_b32 v70, v110, 8, v70
    v_mul_u32_u24 v151, s40, v71
    v_lshrrev_b32 v151, 19, v151
    v_cmp_gt_u32 vcc, 158208, v9
    v_mul_u32_u24 v10, 10, v151
    v_sub_u32 v71, v71, v10
    v_cndmask_b32 v10, v11, v151, vcc
    v_lshlrev_b32 v10, 2, v10
    ds_add_rtn_u32 v151, v10, v8
    v_and_b32 v10, 7, v111
    v_lshl_or_b32 v71, v10, 5, v71
    v_lshl_or_b32 v71, v111, 8, v71
    v_mul_u32_u24 v152, s40, v72
    v_lshrrev_b32 v152, 19, v152
    v_cmp_gt_u32 vcc, 157952, v9
    v_mul_u32_u24 v10, 10, v152
    v_sub_u32 v72, v72, v10
    v_cndmask_b32 v10, v11, v152, vcc
    v_lshlrev_b32 v10, 2, v10
    ds_add_rtn_u32 v152, v10, v8
    v_and_b32 v10, 7, v112
    v_lshl_or_b32 v72, v10, 5, v72
    v_lshl_or_b32 v72, v112, 8, v72
    v_mul_u32_u24 v153, s40, v73
    v_lshrrev_b32 v153, 19, v153
    v_cmp_gt_u32 vcc, 157696, v9
    v_mul_u32_u24 v10, 10, v153
    v_sub_u32 v73, v73, v10
    v_cndmask_b32 v10, v11, v153, vcc
    v_lshlrev_b32 v10, 2, v10
    ds_add_rtn_u32 v153, v10, v8
    v_and_b32 v10, 7, v113
    v_lshl_or_b32 v73, v10, 5, v73
    v_lshl_or_b32 v73, v113, 8, v73
    v_mul_u32_u24 v154, s40, v74
    v_lshrrev_b32 v154, 19, v154
    v_cmp_gt_u32 vcc, 157440, v9
    v_mul_u32_u24 v10, 10, v154
    v_sub_u32 v74, v74, v10
    v_cndmask_b32 v10, v11, v154, vcc
    v_lshlrev_b32 v10, 2, v10
    ds_add_rtn_u32 v154, v10, v8
    v_and_b32 v10, 7, v114
    v_lshl_or_b32 v74, v10, 5, v74
    v_lshl_or_b32 v74, v114, 8, v74
    v_mul_u32_u24 v155, s40, v75
    v_lshrrev_b32 v155, 19, v155
    v_cmp_gt_u32 vcc, 157184, v9
    v_mul_u32_u24 v10, 10, v155
    v_sub_u32 v75, v75, v10
    v_cndmask_b32 v10, v11, v155, vcc
    v_lshlrev_b32 v10, 2, v10
    ds_add_rtn_u32 v155, v10, v8
    v_and_b32 v10, 7, v115
    v_lshl_or_b32 v75, v10, 5, v75
    v_lshl_or_b32 v75, v115, 8, v75
    v_mul_u32_u24 v156, s40, v76
    v_lshrrev_b32 v156, 19, v156
    v_cmp_gt_u32 vcc, 156928, v9
    v_mul_u32_u24 v10, 10, v156
    v_sub_u32 v76, v76, v10
    v_cndmask_b32 v10, v11, v156, vcc
    v_lshlrev_b32 v10, 2, v10
    ds_add_rtn_u32 v156, v10, v8
    v_and_b32 v10, 7, v116
    v_lshl_or_b32 v76, v10, 5, v76
    v_lshl_or_b32 v76, v116, 8, v76
    v_mul_u32_u24 v157, s40, v77
    v_lshrrev_b32 v157, 19, v157
    v_cmp_gt_u32 vcc, 156672, v9
    v_mul_u32_u24 v10, 10, v157
    v_sub_u32 v77, v77, v10
    v_cndmask_b32 v10, v11, v157, vcc
    v_lshlrev_b32 v10, 2, v10
    ds_add_rtn_u32 v157, v10, v8
    v_and_b32 v10, 7, v117
    v_lshl_or_b32 v77, v10, 5, v77
    v_lshl_or_b32 v77, v117, 8, v77
    v_mul_u32_u24 v158, s40, v78
    v_lshrrev_b32 v158, 19, v158
    v_cmp_gt_u32 vcc, 156416, v9
    v_mul_u32_u24 v10, 10, v158
    v_sub_u32 v78, v78, v10
    v_cndmask_b32 v10, v11, v158, vcc
    v_lshlrev_b32 v10, 2, v10
    ds_add_rtn_u32 v158, v10, v8
    v_and_b32 v10, 7, v118
    v_lshl_or_b32 v78, v10, 5, v78
    v_lshl_or_b32 v78, v118, 8, v78
    v_mul_u32_u24 v159, s40, v79
    v_lshrrev_b32 v159, 19, v159
    v_cmp_gt_u32 vcc, 156160, v9
    v_mul_u32_u24 v10, 10, v159
    v_sub_u32 v79, v79, v10
    v_cndmask_b32 v10, v11, v159, vcc
    v_lshlrev_b32 v10, 2, v10
    ds_add_rtn_u32 v159, v10, v8
    v_and_b32 v10, 7, v119
    v_lshl_or_b32 v79, v10, 5, v79
    v_lshl_or_b32 v79, v119, 8, v79
    v_mul_u32_u24 v160, s40, v80
    v_lshrrev_b32 v160, 19, v160
    v_cmp_gt_u32 vcc, 155904, v9
    v_mul_u32_u24 v10, 10, v160
    v_sub_u32 v80, v80, v10
    v_cndmask_b32 v10, v11, v160, vcc
    v_lshlrev_b32 v10, 2, v10
    ds_add_rtn_u32 v160, v10, v8
    v_and_b32 v10, 7, v120
    v_lshl_or_b32 v80, v10, 5, v80
    v_lshl_or_b32 v80, v120, 8, v80
    v_mul_u32_u24 v161, s40, v81
    v_lshrrev_b32 v161, 19, v161
    v_cmp_gt_u32 vcc, 155648, v9
    v_mul_u32_u24 v10, 10, v161
    v_sub_u32 v81, v81, v10
    v_cndmask_b32 v10, v11, v161, vcc
    v_lshlrev_b32 v10, 2, v10
    ds_add_rtn_u32 v161, v10, v8
    v_and_b32 v10, 7, v121
    v_lshl_or_b32 v81, v10, 5, v81
    v_lshl_or_b32 v81, v121, 8, v81
    v_mul_u32_u24 v162, s40, v82
    v_lshrrev_b32 v162, 19, v162
    v_cmp_gt_u32 vcc, 155392, v9
    v_mul_u32_u24 v10, 10, v162
    v_sub_u32 v82, v82, v10
    v_cndmask_b32 v10, v11, v162, vcc
    v_lshlrev_b32 v10, 2, v10
    ds_add_rtn_u32 v162, v10, v8
    v_and_b32 v10, 7, v122
    v_lshl_or_b32 v82, v10, 5, v82
    v_lshl_or_b32 v82, v122, 8, v82
    v_mul_u32_u24 v163, s40, v83
    v_lshrrev_b32 v163, 19, v163
    v_cmp_gt_u32 vcc, 155136, v9
    v_mul_u32_u24 v10, 10, v163
    v_sub_u32 v83, v83, v10
    v_cndmask_b32 v10, v11, v163, vcc
    v_lshlrev_b32 v10, 2, v10
    ds_add_rtn_u32 v163, v10, v8
    v_and_b32 v10, 7, v123
    v_lshl_or_b32 v83, v10, 5, v83
    v_lshl_or_b32 v83, v123, 8, v83
    v_mul_u32_u24 v164, s40, v84
    v_lshrrev_b32 v164, 19, v164
    v_cmp_gt_u32 vcc, 154880, v9
    v_mul_u32_u24 v10, 10, v164
    v_sub_u32 v84, v84, v10
    v_cndmask_b32 v10, v11, v164, vcc
    v_lshlrev_b32 v10, 2, v10
    ds_add_rtn_u32 v164, v10, v8
    v_and_b32 v10, 7, v124
    v_lshl_or_b32 v84, v10, 5, v84
    v_lshl_or_b32 v84, v124, 8, v84
    v_mul_u32_u24 v165, s40, v85
    v_lshrrev_b32 v165, 19, v165
    v_cmp_gt_u32 vcc, 154624, v9
    v_mul_u32_u24 v10, 10, v165
    v_sub_u32 v85, v85, v10
    v_cndmask_b32 v10, v11, v165, vcc
    v_lshlrev_b32 v10, 2, v10
    ds_add_rtn_u32 v165, v10, v8
    v_and_b32 v10, 7, v125
    v_lshl_or_b32 v85, v10, 5, v85
    v_lshl_or_b32 v85, v125, 8, v85
    v_mul_u32_u24 v166, s40, v86
    v_lshrrev_b32 v166, 19, v166
    v_cmp_gt_u32 vcc, 154368, v9
    v_mul_u32_u24 v10, 10, v166
    v_sub_u32 v86, v86, v10
    v_cndmask_b32 v10, v11, v166, vcc
    v_lshlrev_b32 v10, 2, v10
    ds_add_rtn_u32 v166, v10, v8
    v_and_b32 v10, 7, v126
    v_lshl_or_b32 v86, v10, 5, v86
    v_lshl_or_b32 v86, v126, 8, v86
    v_mul_u32_u24 v167, s40, v87
    v_lshrrev_b32 v167, 19, v167
    v_cmp_gt_u32 vcc, 154112, v9
    v_mul_u32_u24 v10, 10, v167
    v_sub_u32 v87, v87, v10
    v_cndmask_b32 v10, v11, v167, vcc
    v_lshlrev_b32 v10, 2, v10
    ds_add_rtn_u32 v167, v10, v8
    v_and_b32 v10, 7, v127
    v_lshl_or_b32 v87, v10, 5, v87
    v_lshl_or_b32 v87, v127, 8, v87
    v_mul_u32_u24 v168, s40, v88
    v_lshrrev_b32 v168, 19, v168
    v_cmp_gt_u32 vcc, 153856, v9
    v_mul_u32_u24 v10, 10, v168
    v_sub_u32 v88, v88, v10
    v_cndmask_b32 v10, v11, v168, vcc
    v_lshlrev_b32 v10, 2, v10
    ds_add_rtn_u32 v168, v10, v8
    v_and_b32 v10, 7, v128
    v_lshl_or_b32 v88, v10, 5, v88
    v_lshl_or_b32 v88, v128, 8, v88
    v_mul_u32_u24 v169, s40, v89
    v_lshrrev_b32 v169, 19, v169
    v_cmp_gt_u32 vcc, 153600, v9
    v_mul_u32_u24 v10, 10, v169
    v_sub_u32 v89, v89, v10
    v_cndmask_b32 v10, v11, v169, vcc
    v_lshlrev_b32 v10, 2, v10
    ds_add_rtn_u32 v169, v10, v8
    v_and_b32 v10, 7, v129
    v_lshl_or_b32 v89, v10, 5, v89
    v_lshl_or_b32 v89, v129, 8, v89
    v_mul_u32_u24 v170, s40, v90
    v_lshrrev_b32 v170, 19, v170
    v_cmp_gt_u32 vcc, 153344, v9
    v_mul_u32_u24 v10, 10, v170
    v_sub_u32 v90, v90, v10
    v_cndmask_b32 v10, v11, v170, vcc
    v_lshlrev_b32 v10, 2, v10
    ds_add_rtn_u32 v170, v10, v8
    v_and_b32 v10, 7, v130
    v_lshl_or_b32 v90, v10, 5, v90
    v_lshl_or_b32 v90, v130, 8, v90
    v_mul_u32_u24 v171, s40, v91
    v_lshrrev_b32 v171, 19, v171
    v_cmp_gt_u32 vcc, 153088, v9
    v_mul_u32_u24 v10, 10, v171
    v_sub_u32 v91, v91, v10
    v_cndmask_b32 v10, v11, v171, vcc
    v_lshlrev_b32 v10, 2, v10
    ds_add_rtn_u32 v171, v10, v8
    v_and_b32 v10, 7, v131
    v_lshl_or_b32 v91, v10, 5, v91
    v_lshl_or_b32 v91, v131, 8, v91
    v_mul_u32_u24 v172, s40, v92
    v_lshrrev_b32 v172, 19, v172
    v_cmp_gt_u32 vcc, 152832, v9
    v_mul_u32_u24 v10, 10, v172
    v_sub_u32 v92, v92, v10
    v_cndmask_b32 v10, v11, v172, vcc
    v_lshlrev_b32 v10, 2, v10
    ds_add_rtn_u32 v172, v10, v8
    v_and_b32 v10, 7, v132
    v_lshl_or_b32 v92, v10, 5, v92
    v_lshl_or_b32 v92, v132, 8, v92
    v_mul_u32_u24 v173, s40, v93
    v_lshrrev_b32 v173, 19, v173
    v_cmp_gt_u32 vcc, 152576, v9
    v_mul_u32_u24 v10, 10, v173
    v_sub_u32 v93, v93, v10
    v_cndmask_b32 v10, v11, v173, vcc
    v_lshlrev_b32 v10, 2, v10
    ds_add_rtn_u32 v173, v10, v8
    v_and_b32 v10, 7, v133
    v_lshl_or_b32 v93, v10, 5, v93
    v_lshl_or_b32 v93, v133, 8, v93
    v_mul_u32_u24 v174, s40, v94
    v_lshrrev_b32 v174, 19, v174
    v_cmp_gt_u32 vcc, 152320, v9
    v_mul_u32_u24 v10, 10, v174
    v_sub_u32 v94, v94, v10
    v_cndmask_b32 v10, v11, v174, vcc
    v_lshlrev_b32 v10, 2, v10
    ds_add_rtn_u32 v174, v10, v8
    v_and_b32 v10, 7, v134
    v_lshl_or_b32 v94, v10, 5, v94
    v_lshl_or_b32 v94, v134, 8, v94
    v_mul_u32_u24 v175, s40, v95
    v_lshrrev_b32 v175, 19, v175
    v_cmp_gt_u32 vcc, 152064, v9
    v_mul_u32_u24 v10, 10, v175
    v_sub_u32 v95, v95, v10
    v_cndmask_b32 v10, v11, v175, vcc
    v_lshlrev_b32 v10, 2, v10
    ds_add_rtn_u32 v175, v10, v8
    v_and_b32 v10, 7, v135
    v_lshl_or_b32 v95, v10, 5, v95
    v_lshl_or_b32 v95, v135, 8, v95
    v_mul_u32_u24 v176, s40, v96
    v_lshrrev_b32 v176, 19, v176
    v_cmp_gt_u32 vcc, 151808, v9
    v_mul_u32_u24 v10, 10, v176
    v_sub_u32 v96, v96, v10
    v_cndmask_b32 v10, v11, v176, vcc
    v_lshlrev_b32 v10, 2, v10
    ds_add_rtn_u32 v176, v10, v8
    v_and_b32 v10, 7, v136
    v_lshl_or_b32 v96, v10, 5, v96
    v_lshl_or_b32 v96, v136, 8, v96
    v_mul_u32_u24 v177, s40, v97
    v_lshrrev_b32 v177, 19, v177
    v_cmp_gt_u32 vcc, 151552, v9
    v_mul_u32_u24 v10, 10, v177
    v_sub_u32 v97, v97, v10
    v_cndmask_b32 v10, v11, v177, vcc
    v_lshlrev_b32 v10, 2, v10
    ds_add_rtn_u32 v177, v10, v8
    v_and_b32 v10, 7, v137
    v_lshl_or_b32 v97, v10, 5, v97
    v_lshl_or_b32 v97, v137, 8, v97
    v_mul_u32_u24 v178, s40, v98
    v_lshrrev_b32 v178, 19, v178
    v_cmp_gt_u32 vcc, 151296, v9
    v_mul_u32_u24 v10, 10, v178
    v_sub_u32 v98, v98, v10
    v_cndmask_b32 v10, v11, v178, vcc
    v_lshlrev_b32 v10, 2, v10
    ds_add_rtn_u32 v178, v10, v8
    v_and_b32 v10, 7, v138
    v_lshl_or_b32 v98, v10, 5, v98
    v_lshl_or_b32 v98, v138, 8, v98
    s_waitcnt lgkmcnt(0)
    v_lshlrev_b32 v144, 2, v144
    ds_write_b32 v144, v64 offset:8192
    v_lshlrev_b32 v145, 2, v145
    ds_write_b32 v145, v65 offset:8192
    v_lshlrev_b32 v146, 2, v146
    ds_write_b32 v146, v66 offset:8192
    v_lshlrev_b32 v147, 2, v147
    ds_write_b32 v147, v67 offset:8192
    v_lshlrev_b32 v148, 2, v148
    ds_write_b32 v148, v68 offset:8192
    v_lshlrev_b32 v149, 2, v149
    ds_write_b32 v149, v69 offset:8192
    v_lshlrev_b32 v150, 2, v150
    ds_write_b32 v150, v70 offset:8192
    v_lshlrev_b32 v151, 2, v151
    ds_write_b32 v151, v71 offset:8192
    v_lshlrev_b32 v152, 2, v152
    ds_write_b32 v152, v72 offset:8192
    v_lshlrev_b32 v153, 2, v153
    ds_write_b32 v153, v73 offset:8192
    v_lshlrev_b32 v154, 2, v154
    ds_write_b32 v154, v74 offset:8192
    v_lshlrev_b32 v155, 2, v155
    ds_write_b32 v155, v75 offset:8192
    v_lshlrev_b32 v156, 2, v156
    ds_write_b32 v156, v76 offset:8192
    v_lshlrev_b32 v157, 2, v157
    ds_write_b32 v157, v77 offset:8192
    v_lshlrev_b32 v158, 2, v158
    ds_write_b32 v158, v78 offset:8192
    v_lshlrev_b32 v159, 2, v159
    ds_write_b32 v159, v79 offset:8192
    v_lshlrev_b32 v160, 2, v160
    ds_write_b32 v160, v80 offset:8192
    v_lshlrev_b32 v161, 2, v161
    ds_write_b32 v161, v81 offset:8192
    v_lshlrev_b32 v162, 2, v162
    ds_write_b32 v162, v82 offset:8192
    v_lshlrev_b32 v163, 2, v163
    ds_write_b32 v163, v83 offset:8192
    v_lshlrev_b32 v164, 2, v164
    ds_write_b32 v164, v84 offset:8192
    v_lshlrev_b32 v165, 2, v165
    ds_write_b32 v165, v85 offset:8192
    v_lshlrev_b32 v166, 2, v166
    ds_write_b32 v166, v86 offset:8192
    v_lshlrev_b32 v167, 2, v167
    ds_write_b32 v167, v87 offset:8192
    v_lshlrev_b32 v168, 2, v168
    ds_write_b32 v168, v88 offset:8192
    v_lshlrev_b32 v169, 2, v169
    ds_write_b32 v169, v89 offset:8192
    v_lshlrev_b32 v170, 2, v170
    ds_write_b32 v170, v90 offset:8192
    v_lshlrev_b32 v171, 2, v171
    ds_write_b32 v171, v91 offset:8192
    v_lshlrev_b32 v172, 2, v172
    ds_write_b32 v172, v92 offset:8192
    v_lshlrev_b32 v173, 2, v173
    ds_write_b32 v173, v93 offset:8192
    v_lshlrev_b32 v174, 2, v174
    ds_write_b32 v174, v94 offset:8192
    v_lshlrev_b32 v175, 2, v175
    ds_write_b32 v175, v95 offset:8192
    v_lshlrev_b32 v176, 2, v176
    ds_write_b32 v176, v96 offset:8192
    v_lshlrev_b32 v177, 2, v177
    ds_write_b32 v177, v97 offset:8192
    v_lshlrev_b32 v178, 2, v178
    ds_write_b32 v178, v98 offset:8192
    s_add_u32 s36, s36, 8960
    s_sub_u32 s37, s37, 1
    s_cmp_lg_u32 s37, 0
    s_cbranch_scc1 LH_scatter
    s_waitcnt lgkmcnt(0)
    s_barrier
    s_mul_i32 s38, s6, 107520
    s_add_u32 s38, s38, 2818048
    v_mov_b32 v10, 0x7fffff00
    v_cmp_gt_u32 vcc, 64, v63
    v_add_u32 v2, 65536, v1
    s_nop 0
    v_cndmask_b32 v9, v10, v1, vcc
    ds_read_b128 v[64:67], v1 offset:8192
    ds_read_b128 v[68:71], v1 offset:12288
    ds_read_b128 v[72:75], v1 offset:16384
    ds_read_b128 v[76:79], v1 offset:20480
    ds_read_b128 v[80:83], v1 offset:24576
    ds_read_b128 v[84:87], v1 offset:28672
    ds_read_b128 v[88:91], v1 offset:32768
    ds_read_b128 v[92:95], v1 offset:36864
    ds_read_b128 v[96:99], v1 offset:40960
    ds_read_b128 v[100:103], v1 offset:45056
    ds_read_b128 v[104:107], v1 offset:49152
    ds_read_b128 v[108:111], v1 offset:53248
    ds_read_b128 v[112:115], v1 offset:57344
    ds_read_b128 v[116:119], v1 offset:61440
    ds_read_b128 v[120:123], v2 offset:0
    ds_read_b128 v[124:127], v2 offset:4096
    ds_read_b128 v[128:131], v2 offset:8192
    ds_read_b128 v[132:135], v2 offset:12288
    ds_read_b128 v[136:139], v2 offset:16384
    ds_read_b128 v[140:143], v2 offset:20480
    ds_read_b128 v[144:147], v2 offset:24576
    ds_read_b128 v[148:151], v2 offset:28672
    ds_read_b128 v[152:155], v2 offset:32768
    ds_read_b128 v[156:159], v2 offset:36864
    ds_read_b128 v[160:163], v2 offset:40960
    ds_read_b128 v[164:167], v2 offset:45056
    ds_read_b128 v[168:171], v2 offset:49152
    s_waitcnt lgkmcnt(0)
    buffer_store_dwordx4 v[64:67], v1, s[12:15], s38 offen sc1
    s_add_u32 s38, s38, 4096
    buffer_store_dwordx4 v[68:71], v1, s[12:15], s38 offen sc1
    s_add_u32 s38, s38, 4096
    buffer_store_dwordx4 v[72:75], v1, s[12:15], s38 offen sc1
    s_add_u32 s38, s38, 4096
    buffer_store_dwordx4 v[76:79], v1, s[12:15], s38 offen sc1
    s_add_u32 s38, s38, 4096
    buffer_store_dwordx4 v[80:83], v1, s[12:15], s38 offen sc1
    s_add_u32 s38, s38, 4096
    buffer_store_dwordx4 v[84:87], v1, s[12:15], s38 offen sc1
    s_add_u32 s38, s38, 4096
    buffer_store_dwordx4 v[88:91], v1, s[12:15], s38 offen sc1
    s_add_u32 s38, s38, 4096
    buffer_store_dwordx4 v[92:95], v1, s[12:15], s38 offen sc1
    s_add_u32 s38, s38, 4096
    buffer_store_dwordx4 v[96:99], v1, s[12:15], s38 offen sc1
    s_add_u32 s38, s38, 4096
    buffer_store_dwordx4 v[100:103], v1, s[12:15], s38 offen sc1
    s_add_u32 s38, s38, 4096
    buffer_store_dwordx4 v[104:107], v1, s[12:15], s38 offen sc1
    s_add_u32 s38, s38, 4096
    buffer_store_dwordx4 v[108:111], v1, s[12:15], s38 offen sc1
    s_add_u32 s38, s38, 4096
    buffer_store_dwordx4 v[112:115], v1, s[12:15], s38 offen sc1
    s_add_u32 s38, s38, 4096
    buffer_store_dwordx4 v[116:119], v1, s[12:15], s38 offen sc1
    s_add_u32 s38, s38, 4096
    buffer_store_dwordx4 v[120:123], v1, s[12:15], s38 offen sc1
    s_add_u32 s38, s38, 4096
    buffer_store_dwordx4 v[124:127], v1, s[12:15], s38 offen sc1
    s_add_u32 s38, s38, 4096
    buffer_store_dwordx4 v[128:131], v1, s[12:15], s38 offen sc1
    s_add_u32 s38, s38, 4096
    buffer_store_dwordx4 v[132:135], v1, s[12:15], s38 offen sc1
    s_add_u32 s38, s38, 4096
    buffer_store_dwordx4 v[136:139], v1, s[12:15], s38 offen sc1
    s_add_u32 s38, s38, 4096
    buffer_store_dwordx4 v[140:143], v1, s[12:15], s38 offen sc1
    s_add_u32 s38, s38, 4096
    buffer_store_dwordx4 v[144:147], v1, s[12:15], s38 offen sc1
    s_add_u32 s38, s38, 4096
    buffer_store_dwordx4 v[148:151], v1, s[12:15], s38 offen sc1
    s_add_u32 s38, s38, 4096
    buffer_store_dwordx4 v[152:155], v1, s[12:15], s38 offen sc1
    s_add_u32 s38, s38, 4096
    buffer_store_dwordx4 v[156:159], v1, s[12:15], s38 offen sc1
    s_add_u32 s38, s38, 4096
    buffer_store_dwordx4 v[160:163], v1, s[12:15], s38 offen sc1
    s_add_u32 s38, s38, 4096
    buffer_store_dwordx4 v[164:167], v1, s[12:15], s38 offen sc1
    s_add_u32 s38, s38, 4096
    buffer_store_dwordx4 v[168:171], v9, s[12:15], s38 offen sc1
    s_add_u32 s38, s38, 4096
    s_lshl_b32 s38, s2, 7
    s_lshl_b32 s39, s3, 2
    s_add_u32 s38, s38, s39
    s_add_u32 s38, s38, 2686976
    s_add_u32 s59, s59, 0x9e3779b1
    v_mov_b32 v1, s59
    s_waitcnt vmcnt(0)
    s_mov_b64 exec, 1
    buffer_store_dword v1, off, s[12:15], s38 sc1
    s_endpgm
.section .rodata,"a"
.p2align 6
.amdhsa_kernel gather_scatter__hybrid_graph_tf_graphgps__graph_kernel
  .amdhsa_next_free_vgpr 512
  .amdhsa_next_free_sgpr 102
  .amdhsa_accum_offset 256
  .amdhsa_group_segment_fixed_size 0
  .amdhsa_kernarg_size 96
  .amdhsa_user_sgpr_count 2
  .amdhsa_user_sgpr_kernarg_segment_ptr 1
  .amdhsa_system_sgpr_workgroup_id_x 1
.end_amdhsa_kernel
```
